```python
import torch

def _softmax(x, axis=-1):
    return torch.softmax(x, dim=axis)
def _gelu(x):
    return torch.nn.functional.gelu(x, approximate="tanh")
def _silu(x):
    return torch.nn.functional.silu(x)
def _sigmoid(x):
    return torch.sigmoid(x)
def _layernorm(x, axis=-1, eps=1e-5):
    m = x.mean(dim=axis, keepdim=True)
    v = x.var(dim=axis, keepdim=True, unbiased=False)
    return (x - m) / torch.sqrt(v + eps)
def _scatter_add(tgt, idx, src, axis=0):
    return tgt.clone().index_add_(axis, idx, src)
def _segment_sum(src, seg, n):
    out = torch.zeros((n,) + src.shape[1:], dtype=src.dtype)
    return out.index_add_(0, seg, src)
def _pad(x, pw):
    flat = tuple(v for pair in reversed(pw) for v in pair)
    return torch.nn.functional.pad(x, flat)

kernel_name = 'interleave_layers__linear_kernel_hedgehog__glu_gated_reglu__prompt'

def setup_inputs():

    _w = (lambda a: (lambda t: t.to(torch.bfloat16) if t.is_floating_point() else t)(torch.as_tensor(a)))
    def _A_setup():
        B, S, D, H = 1, 2048, 512, 32
        Dh = D // H
        return {
            "x": _w((lambda *s: torch.randn(*s, dtype=torch.bfloat16) * 0.05)(B, S, D)),
            "wqkv": _w((lambda *s: torch.randn(*s, dtype=torch.bfloat16) * 0.4)(D, 3 * D)),
            "w_phi": _w((lambda *s: torch.randn(*s, dtype=torch.bfloat16) * 0.4)(H, Dh, Dh) * (Dh ** -0.5)),
            "wo": _w((lambda *s: torch.randn(*s, dtype=torch.bfloat16) * 0.05)(D, D)),
        }
    _A_in = _A_setup()

    def _B_setup():
        B, S, D, F = 1, 2048, 512, 1792
        return {
            "x": _w((lambda *s: torch.randn(*s, dtype=torch.bfloat16) * 0.05)(B, S, D)),
            "W_gate": _w((lambda *s: torch.randn(*s, dtype=torch.bfloat16) * 0.8)(D, F) * (2.0 / D) ** 0.5),
            "W_up": _w((lambda *s: torch.randn(*s, dtype=torch.bfloat16) * 0.8)(D, F) * (2.0 / D) ** 0.5),
            "W_down": _w((lambda *s: torch.randn(*s, dtype=torch.bfloat16) * 0.8)(F, D) * (1.0 / F) ** 0.5),
        }
    _B_in = _B_setup()

    return {
        "A_x": _A_in["x"],
        "A_wqkv": _A_in["wqkv"],
        "A_w_phi": _A_in["w_phi"],
        "A_wo": _A_in["wo"],
        "B_x": _B_in["x"],
        "B_W_gate": _B_in["W_gate"],
        "B_W_up": _B_in["W_up"],
        "B_W_down": _B_in["W_down"],
    }

def reference(A_x, A_wqkv, A_w_phi, A_wo, B_x, B_W_gate, B_W_up, B_W_down):
    def _A_ref(x, wqkv, w_phi, wo):
        B, S, D = x.shape
        H = 32; Dh = D // H
        qkv = (lambda x, *d: x.permute(*d))((x @ wqkv).reshape(B, S, 3, H, Dh), 2, 0, 3, 1, 4)
        q, k, v = qkv[0], qkv[1], qkv[2]
        pq = torch.einsum("bhsd,hdf->bhsf", q, w_phi)
        pk = torch.einsum("bhsd,hdf->bhsf", k, w_phi)
        phi_q = torch.concatenate([_softmax(pq, axis=-1), _softmax(-pq, axis=-1)], axis=-1)
        phi_k = torch.concatenate([_softmax(pk, axis=-1), _softmax(-pk, axis=-1)], axis=-1)
        kv = torch.einsum("bhsf,bhsd->bhfd", phi_k, v)
        z  = torch.einsum("bhsf->bhf", phi_k)
        num = torch.einsum("bhqf,bhfd->bhqd", phi_q, kv)
        den = torch.einsum("bhqf,bhf->bhq", phi_q, z)[..., None] + 1e-6
        o = num / den
        return (lambda x, *d: x.permute(*d))(o, 0, 2, 1, 3).reshape(B, S, D) @ wo

    def _B_ref(x, W_gate, W_up, W_down):
        gate = torch.einsum("bsd,df->bsf", x, W_gate)
        up = torch.einsum("bsd,df->bsf", x, W_up)
        gate = gate * (lambda x, dt: x.to(dt))(gate > 0, gate.dtype)
        h = gate * up
        return torch.einsum("bsf,fd->bsd", h, W_down)

    x = A_x
    x = x + _A_ref(_layernorm(x, axis=-1), A_wqkv, A_w_phi, A_wo)
    x = x + _B_ref(_layernorm(x, axis=-1), B_W_gate, B_W_up, B_W_down)
    x = x + _A_ref(_layernorm(x, axis=-1), A_wqkv, A_w_phi, A_wo)
    x = x + _B_ref(_layernorm(x, axis=-1), B_W_gate, B_W_up, B_W_down)
    return x
```

```asm
; @launch grid=(256,1,1) block=(256,1,1) lds=163840
.amdgcn_target "amdgcn-amd-amdhsa--gfx950"
.text
.globl interleave_layers__linear_kernel_hedgehog__glu_gated_reglu__prompt_kernel
.p2align 12

.p2align 8
.type interleave_layers__linear_kernel_hedgehog__glu_gated_reglu__prompt_kernel,@function
interleave_layers__linear_kernel_hedgehog__glu_gated_reglu__prompt_kernel:
    s_cmp_ge_u32 s2, 256
    s_cbranch_scc1 END
    s_getpc_b64 s[50:51]
PC0:
    s_load_dwordx2 s[8:9], s[0:1], 0
    s_load_dwordx2 s[4:5], s[0:1], 80
    s_load_dwordx2 s[24:25], s[0:1], 16
    s_load_dwordx2 s[44:45], s[0:1], 56
    s_load_dwordx2 s[12:13], s[0:1], 64
    s_load_dwordx2 s[16:17], s[0:1], 72
    s_and_b32 s3, s2, 7
    s_lshr_b32 s58, s2, 3
    s_and_b32 s29, s58, 15
    s_sub_u32 s58, s58, 1
    s_cmp_lt_u32 s3, 4
    s_cselect_b32 s33, 40, 48
    s_cmp_lt_u32 s58, 20
    s_cselect_b32 s33, s33, 24
    s_cmp_lt_u32 s58, 6
    s_cselect_b32 s33, 8, s33
    s_load_dwordx2 s[20:21], s[0:1], s33
    s_and_b32 s34, s2, 0xf8
    v_lshrrev_b32 v1, 5, v0
    v_add_lshl_u32 v1, v1, s34, 7
    v_min_u32 v1, CODE_END-PC0-4, v1
    v_mov_b32 v61, s51
    v_add_co_u32 v60, vcc, s50, v1
    s_nop 1
    v_addc_co_u32 v61, vcc, 0, v61, vcc
    global_load_dword v63, v[60:61], off
    v_add_u32 v1, 0x8000, v1
    v_min_u32 v1, CODE_END-PC0-4, v1
    v_mov_b32 v59, s51
    v_add_co_u32 v58, vcc, s50, v1
    s_nop 1
    v_addc_co_u32 v59, vcc, 0, v59, vcc
    global_load_dword v63, v[58:59], off
    v_lshrrev_b32 v7, 6, v0
    v_and_b32 v0, 63, v0
    v_readfirstlane_b32 s30, v7
    v_lshlrev_b32 v1, 4, v0
    v_lshlrev_b32 v2, 2, v0
    v_and_b32 v8, 31, v0
    v_lshrrev_b32 v9, 5, v0
    v_and_b32 v14, 15, v8
    s_lshl_b32 s28, s3, 1
    s_lshr_b32 s33, s2, 7
    s_add_u32 s28, s28, s33
    s_lshr_b32 s100, s29, 3
    s_lshl_b32 s100, s100, 1
    s_lshr_b32 s33, s30, 1
    s_add_u32 s100, s100, s33
    s_and_b32 s101, s29, 7
    s_lshl_b32 s101, s101, 1
    s_and_b32 s33, s30, 1
    s_add_u32 s101, s101, s33
    s_lshr_b32 s33, s29, 3
    s_xor_b32 s101, s101, s33
    s_lshl_b32 s69, s28, 17
    s_lshl_b32 s33, s100, 15
    s_add_u32 s69, s69, s33
    s_lshl_b32 s34, s101, 6
    s_add_u32 s69, s69, s34
    v_lshrrev_b32 v10, 4, v0
    v_xor_b32 v10, v10, v0
    v_and_b32 v10, 3, v10
    v_lshlrev_b32 v10, 4, v10
    v_lshrrev_b32 v11, 2, v0
    v_lshl_add_u32 v12, v11, 10, v10
    s_lshl_b32 s68, s30, 12
    s_mov_b32 s10, 0x200000
    s_mov_b32 s11, 0x20000
    s_mov_b32 s6, 0x10000000
    s_mov_b32 s7, 0x20000
    s_mov_b32 s26, 0x4000
    s_mov_b32 s27, 0x20000
    s_mov_b32 s23, 0x20000
    v_mov_b32 v40, v1
    s_mov_b32 s98, 0xbb000000
    s_mov_b32 s99, 0x8000
    s_cmp_lt_u32 s58, 6
    s_cbranch_scc1 JOB_QKV
    s_cmp_lt_u32 s58, 20
    s_cbranch_scc1 JOB_GU
    s_mov_b32 s98, 0
    s_mov_b32 s59, 1024
    s_lshl_b32 s35, s3, 1
    s_and_b32 s33, s30, 1
    s_add_u32 s35, s35, s33
    s_sub_u32 s34, s58, 20
    s_min_u32 s34, s34, 2
    s_lshl_b32 s95, s3, 1
    s_add_u32 s95, s95, s34
    s_add_u32 s95, s95, 160
    s_lshl_b32 s97, s35, 15
    s_add_u32 s97, s97, 0x180000
    s_lshl_b32 s34, s34, 1
    s_lshr_b32 s33, s30, 1
    s_add_u32 s34, s34, s33
    s_lshl_b32 s33, s34, 13
    s_add_u32 s97, s97, s33
    s_lshl_b32 s96, s34, 17
    s_lshl_b32 s33, s35, 6
    s_add_u32 s96, s96, s33
    s_cmp_ge_u32 s58, 22
    s_cselect_b32 s95, -1, s95
    s_cselect_b32 s97, 0x10000000, s97
    s_branch JOB_GO
JOB_GU:
    s_mov_b32 s59, 3584
    s_and_b32 s35, s3, 3
    s_mul_i32 s35, s35, 14
    s_add_u32 s35, s35, s58
    s_sub_u32 s35, s35, 6
    s_lshl_b32 s97, s35, 16
    s_lshr_b32 s33, s3, 2
    s_mul_i32 s95, s33, 56
    s_add_u32 s95, s95, s35
    s_add_u32 s95, s95, 48
    s_lshl_b32 s33, s33, 8
    s_add_u32 s97, s97, s33
    s_add_u32 s97, s97, 0x200000
    v_lshrrev_b32 v40, 4, v8
    v_lshlrev_b32 v40, 15, v40
    v_lshl_add_u32 v40, v9, 9, v40
    v_lshl_add_u32 v40, v14, 4, v40
    s_branch JOB_COL
JOB_QKV:
    s_mov_b32 s59, 3072
    s_mul_i32 s35, s3, 6
    s_add_u32 s35, s35, s58
    s_mov_b32 s95, s35
    s_lshr_b32 s33, s35, 4
    s_and_b32 s34, s35, 15
    s_lshl_b32 s97, s34, 10
    s_cmp_lt_u32 s33, 2
    s_cselect_b32 s99, s97, s99
    s_sub_u32 s33, s33, 1
    s_cselect_b32 s33, 2, s33
    s_mul_i32 s34, s34, 3
    s_add_u32 s34, s34, s33
    s_lshl_b32 s97, s34, 15
JOB_COL:
    s_lshl_b32 s33, s30, 13
    s_add_u32 s97, s97, s33
    s_mul_i32 s96, s30, s59
    s_lshl_b32 s96, s96, 7
    s_lshl_b32 s33, s35, 6
    s_add_u32 s96, s96, s33
JOB_GO:
    v_mad_u32_u24 v11, v11, s59, v10
    s_lshl_b32 s22, s59, 9
    s_lshl_b32 s59, s59, 4
    s_sub_u32 s59, s59, 1024
    s_add_u32 m0, s68, 49152
    s_add_u32 s35, s69, 15360
    v_and_b32 v13, 19, v8
    v_bfe_u32 v10, v8, 2, 1
    v_lshl_add_u32 v13, v10, 3, v13
    v_bfe_u32 v10, v8, 3, 1
    v_lshl_add_u32 v13, v10, 2, v13
    v_lshlrev_b32 v13, 5, v13
    v_lshl_add_u32 v13, v9, 4, v13
    s_waitcnt lgkmcnt(0)
    s_mov_b32 s31, 0
    s_cmp_ge_u32 s2, 8
    s_cbranch_scc1 NOZERO
    v_mov_b32 v20, 0
    v_mov_b32 v21, 0
    v_mov_b32 v22, 0
    v_mov_b32 v23, 0
    s_lshl_b32 s33, s2, 13
    s_lshl_b32 s34, s30, 11
    s_add_u32 s33, s33, s34
    s_add_u32 s33, s33, 0x6a0000
    buffer_store_dwordx4 v[20:23], v1, s[4:7], s33 offen offset:0 sc1
    buffer_store_dwordx4 v[20:23], v1, s[4:7], s33 offen offset:1024 sc1
NOZERO:
    buffer_load_dwordx4 v12, s[8:11], s69 offen offset:0 lds
    buffer_load_dwordx4 v12, s[8:11], s35 offen offset:1024 lds
    buffer_load_dwordx4 v[16:19], v13, s[24:27], s99 offen
    s_add_u32 m0, s68, 16384
    s_nop 0
    buffer_load_dwordx4 v11, s[20:23], s96 offen offset:0 lds
    s_add_u32 s96, s96, s59
    buffer_load_dwordx4 v11, s[20:23], s96 offen offset:1024 lds
    s_add_u32 s96, s96, s59
    buffer_load_dwordx4 v11, s[20:23], s96 offen offset:2048 lds
    s_add_u32 s96, s96, s59
    buffer_load_dwordx4 v11, s[20:23], s96 offen offset:3072 lds
    s_add_u32 s96, s96, s59
    s_add_u32 s96, s96, 4096
    s_add_u32 m0, s68, 32768
    s_nop 0
    buffer_load_dwordx4 v11, s[20:23], s96 offen offset:0 lds
    s_add_u32 s96, s96, s59
    buffer_load_dwordx4 v11, s[20:23], s96 offen offset:1024 lds
    s_add_u32 s96, s96, s59
    buffer_load_dwordx4 v11, s[20:23], s96 offen offset:2048 lds
    s_add_u32 s96, s96, s59
    buffer_load_dwordx4 v11, s[20:23], s96 offen offset:3072 lds
    s_mov_b32 s18, 0x100
    s_mov_b32 s19, 0x20000
    s_mov_b32 s46, 0x1c0000
    s_mov_b32 s47, 0x20000
    s_mov_b32 s14, 0x200000
    s_mov_b32 s15, 0x20000
    s_mov_b32 s74, 0
    s_mul_i32 s32, s28, 0xa0000
    s_add_u32 s32, s32, 0x880000
    s_lshl_b32 s33, s100, 15
    s_lshl_b32 s34, s101, 11
    s_add_u32 s70, s33, s34
    s_add_u32 s70, s70, s32
    v_bfe_u32 v42, v0, 4, 1
    v_lshlrev_b32 v42, 2, v42
    v_and_b32 v43, 7, v0
    v_xor_b32 v42, v42, v43
    v_lshrrev_b32 v41, 3, v0
    v_lshlrev_b32 v41, 10, v41
    v_lshl_add_u32 v41, v42, 4, v41
    s_mul_i32 s43, s30, 458752
    s_and_b32 s33, s29, 7
    s_lshl_b32 s33, s33, 7
    s_add_u32 s43, s43, s33
    s_mov_b32 s42, s43
    s_lshr_b32 s33, s2, 3
    s_mul_i32 s33, s33, 14336
    s_mul_i32 s34, s30, 458752
    s_add_u32 s33, s33, s34
    v_lshlrev_b32 v62, 10, v0
    s_mov_b64 exec, 0x3fff
    buffer_load_dword v62, v62, s[44:47], s33 offen offset:384
    s_mov_b64 exec, -1
    v_lshrrev_b32 v3, 4, v0
    v_and_b32 v42, 0xf0, v1
    v_lshl_add_u32 v3, v3, 2, v42
    s_lshl_b32 s33, s100, 12
    s_lshl_b32 s34, s101, 8
    s_add_u32 s71, s33, s34
    s_add_u32 s71, s71, s32
    s_add_u32 s71, s71, 0x20000
    s_lshl_b32 s86, s29, 15
    s_add_u32 s86, s86, 0x580000
    s_lshl_b32 s34, s30, 14
    s_add_u32 s85, s86, s34
    s_lshl_b32 s34, s28, 10
    s_add_u32 s85, s85, s34
    s_lshl_b32 s88, s29, 12
    s_add_u32 s88, s88, 0x680000
    s_lshl_b32 s34, s28, 8
    s_add_u32 s87, s88, s34
    s_cmp_eq_u32 s30, 2
    s_cselect_b32 s50, s87, 0x10000000
    s_cmp_lt_u32 s30, 2
    s_cselect_b32 s50, s85, s50
    s_cselect_b32 s51, 8, 1
    s_cselect_b64 s[56:57], -1, 0xffff
    s_lshl_b32 s51, s51, 16
    s_add_u32 s51, s51, s50
    v_lshlrev_b32 v24, 3, v9
    v_sub_u32 v24, v14, v24
    v_and_b32 v26, 1, v24
    v_lshlrev_b32 v26, 4, v26
    s_movk_i32 s33, 0x3f80
    v_lshlrev_b32 v26, v26, s33
    v_lshrrev_b32 v27, 1, v24
    v_cmp_eq_u32 vcc, 0, v27
    s_nop 1
    v_cndmask_b32 v28, 0, v26, vcc
    v_cmp_eq_u32 vcc, 1, v27
    s_nop 1
    v_cndmask_b32 v29, 0, v26, vcc
    v_cmp_eq_u32 vcc, 2, v27
    s_nop 1
    v_cndmask_b32 v30, 0, v26, vcc
    v_cmp_eq_u32 vcc, 3, v27
    s_nop 1
    v_cndmask_b32 v31, 0, v26, vcc
    v_cmp_gt_u32 vcc, 16, v8
    s_nop 1
    v_cndmask_b32 v32, 0, v28, vcc
    v_cndmask_b32 v36, v28, 0, vcc
    v_cndmask_b32 v33, 0, v29, vcc
    v_cndmask_b32 v37, v29, 0, vcc
    v_cndmask_b32 v34, 0, v30, vcc
    v_cndmask_b32 v38, v30, 0, vcc
    v_cndmask_b32 v35, 0, v31, vcc
    v_cndmask_b32 v39, v31, 0, vcc
    v_lshrrev_b32 v42, 2, v14
    v_xor_b32 v42, v42, v9
    v_lshlrev_b32 v42, 4, v42
    v_lshl_add_u32 v42, v8, 6, v42
    v_add_u32 v42, s68, v42
    v_xor_b32 v43, 32, v42
    s_waitcnt vmcnt(9)
    ds_read_b128 v[80:83], v42 offset:49152
    ds_read_b128 v[84:87], v43 offset:49152
    s_cmp_ge_u32 s2, 8
    s_cbranch_scc1 NOGO
    s_barrier
    s_cmp_lg_u32 s30, 0
    s_cbranch_scc1 NOGO
    s_lshl_b32 s33, s2, 2
    v_mov_b32 v7, 1
    s_mov_b64 exec, 1
    buffer_store_dword v7, off, s[16:19], s33 sc1
    s_mov_b64 exec, -1
NOGO:
    v_mfma_f32_32x32x16_bf16 v[160:175], v[16:19], v[28:31], 0
    s_waitcnt lgkmcnt(0)
    v_permlane32_swap_b32 v80, v82
    v_permlane32_swap_b32 v81, v83
    v_permlane32_swap_b32 v84, v86
    v_permlane32_swap_b32 v85, v87
    v_lshlrev_b32 v64, 16, v80
    v_and_b32 v65, 0xffff0000, v80
    v_lshlrev_b32 v66, 16, v81
    v_and_b32 v67, 0xffff0000, v81
    v_lshlrev_b32 v68, 16, v82
    v_and_b32 v69, 0xffff0000, v82
    v_lshlrev_b32 v70, 16, v83
    v_and_b32 v71, 0xffff0000, v83
    v_lshlrev_b32 v72, 16, v84
    v_and_b32 v73, 0xffff0000, v84
    v_lshlrev_b32 v74, 16, v85
    v_and_b32 v75, 0xffff0000, v85
    v_lshlrev_b32 v76, 16, v86
    v_and_b32 v77, 0xffff0000, v86
    v_lshlrev_b32 v78, 16, v87
    v_and_b32 v79, 0xffff0000, v87
    s_cmp_eq_u32 s99, 0x8000
    s_cbranch_scc1 NOPHI
    v_cvt_pk_bf16_f32 v32, v160, v161
    v_cvt_pk_bf16_f32 v33, v162, v163
    v_cvt_pk_bf16_f32 v34, v164, v165
    v_cvt_pk_bf16_f32 v35, v166, v167
    v_cvt_pk_bf16_f32 v36, v168, v169
    v_cvt_pk_bf16_f32 v37, v170, v171
    v_cvt_pk_bf16_f32 v38, v172, v173
    v_cvt_pk_bf16_f32 v39, v174, v175
    v_cndmask_b32 v32, 0, v32, vcc
    v_cndmask_b32 v36, v36, 0, vcc
    v_cndmask_b32 v33, 0, v33, vcc
    v_cndmask_b32 v37, v37, 0, vcc
    v_cndmask_b32 v34, 0, v34, vcc
    v_cndmask_b32 v38, v38, 0, vcc
    v_cndmask_b32 v35, 0, v35, vcc
    v_cndmask_b32 v39, v39, 0, vcc
NOPHI:
    s_add_u32 s33, s70, 0x0
    buffer_store_dwordx4 v[80:83], v1, s[4:7], s33 offen offset:0 sc1
    buffer_store_dwordx4 v[84:87], v1, s[4:7], s33 offen offset:1024 sc1
    v_pk_add_f32 v[8:9], v[64:65], v[66:67]
    v_pk_mul_f32 v[10:11], v[64:65], v[64:65]
    v_pk_fma_f32 v[10:11], v[66:67], v[66:67], v[10:11]
    v_pk_add_f32 v[8:9], v[8:9], v[68:69]
    v_pk_fma_f32 v[10:11], v[68:69], v[68:69], v[10:11]
    v_pk_add_f32 v[8:9], v[8:9], v[70:71]
    v_pk_fma_f32 v[10:11], v[70:71], v[70:71], v[10:11]
    v_pk_add_f32 v[8:9], v[8:9], v[72:73]
    v_pk_fma_f32 v[10:11], v[72:73], v[72:73], v[10:11]
    v_pk_add_f32 v[8:9], v[8:9], v[74:75]
    v_pk_fma_f32 v[10:11], v[74:75], v[74:75], v[10:11]
    v_pk_add_f32 v[8:9], v[8:9], v[76:77]
    v_pk_fma_f32 v[10:11], v[76:77], v[76:77], v[10:11]
    v_pk_add_f32 v[8:9], v[8:9], v[78:79]
    v_pk_fma_f32 v[10:11], v[78:79], v[78:79], v[10:11]
    v_add_f32 v8, v8, v9
    v_add_f32 v10, v10, v11
    s_add_u32 s34, s71, 0x0
    s_nop 0
    v_permlane32_swap_b32 v8, v10
    v_add_f32 v8, v8, v10
    buffer_store_dword v8, v3, s[4:7], s34 offen sc1
    v_mov_b32 v20, -1
    v_mov_b32 v21, -1
    v_mov_b32 v22, -1
    v_mov_b32 v23, -1
    s_mov_b64 exec, s[56:57]
    buffer_store_dwordx4 v[20:23], v1, s[4:7], s50 offen offset:0 sc1
    s_mov_b64 exec, -1
    s_mov_b64 exec, 0
    s_cmp_eq_u32 s30, 0
    s_cbranch_scc1 WZ0
    s_cmp_eq_u32 s30, 1
    s_cbranch_scc1 WZ1
    s_cmp_eq_u32 s30, 2
    s_cbranch_scc1 WZ2
    s_branch WZ3
WZRET:
    s_mov_b64 exec, -1
    s_waitcnt vmcnt(11)
    ds_read_b128 v[128:131], v42 offset:16384
    ds_read_b128 v[132:135], v43 offset:16384
    s_waitcnt vmcnt(9)
    ds_read_b128 v[136:139], v42 offset:18432
    ds_read_b128 v[140:143], v43 offset:18432
    s_waitcnt vmcnt(7)
    ds_read_b128 v[144:147], v42 offset:32768
    ds_read_b128 v[148:151], v43 offset:32768
    s_waitcnt vmcnt(5)
    ds_read_b128 v[152:155], v42 offset:34816
    ds_read_b128 v[156:159], v43 offset:34816
    v_accvgpr_write_b32 a224, v64
    v_accvgpr_write_b32 a225, v65
    v_accvgpr_write_b32 a226, v66
    v_accvgpr_write_b32 a227, v67
    v_accvgpr_write_b32 a228, v68
    v_accvgpr_write_b32 a229, v69
    v_accvgpr_write_b32 a230, v70
    v_accvgpr_write_b32 a231, v71
    v_accvgpr_write_b32 a232, v72
    v_accvgpr_write_b32 a233, v73
    v_accvgpr_write_b32 a234, v74
    v_accvgpr_write_b32 a235, v75
    v_accvgpr_write_b32 a236, v76
    v_accvgpr_write_b32 a237, v77
    v_accvgpr_write_b32 a238, v78
    v_accvgpr_write_b32 a239, v79
    s_waitcnt lgkmcnt(6)
    v_mfma_f32_32x32x16_bf16 v[160:175], v[128:131], v[32:35], 0
    v_mfma_f32_32x32x16_bf16 v[160:175], v[132:135], v[36:39], v[160:175]
    s_waitcnt lgkmcnt(4)
    v_mfma_f32_32x32x16_bf16 v[176:191], v[136:139], v[32:35], 0
    v_mfma_f32_32x32x16_bf16 v[176:191], v[140:143], v[36:39], v[176:191]
    s_waitcnt lgkmcnt(2)
    v_mfma_f32_32x32x16_bf16 v[192:207], v[144:147], v[32:35], 0
    v_mfma_f32_32x32x16_bf16 v[192:207], v[148:151], v[36:39], v[192:207]
    s_waitcnt lgkmcnt(0)
    v_mfma_f32_32x32x16_bf16 v[208:223], v[152:155], v[32:35], 0
    v_mfma_f32_32x32x16_bf16 v[208:223], v[156:159], v[36:39], v[208:223]
    v_pk_add_f32 v[16:17], v[160:161], v[162:163]
    v_pk_add_f32 v[18:19], v[164:165], v[166:167]
    v_pk_add_f32 v[16:17], v[16:17], v[168:169]
    v_pk_add_f32 v[18:19], v[18:19], v[170:171]
    v_pk_add_f32 v[16:17], v[16:17], v[172:173]
    v_pk_add_f32 v[18:19], v[18:19], v[174:175]
    v_pk_add_f32 v[16:17], v[16:17], v[176:177]
    v_pk_add_f32 v[18:19], v[18:19], v[178:179]
    v_pk_add_f32 v[16:17], v[16:17], v[180:181]
    v_pk_add_f32 v[18:19], v[18:19], v[182:183]
    v_pk_add_f32 v[16:17], v[16:17], v[184:185]
    v_pk_add_f32 v[18:19], v[18:19], v[186:187]
    v_pk_add_f32 v[16:17], v[16:17], v[188:189]
    v_pk_add_f32 v[18:19], v[18:19], v[190:191]
    s_add_u32 m0, s68, 0x10000
    s_nop 0
    buffer_load_dwordx4 v41, s[44:47], s43 offen lds
    s_add_u32 s43, s43, 8192
    v_pk_add_f32 v[16:17], v[16:17], v[192:193]
    v_pk_add_f32 v[18:19], v[18:19], v[194:195]
    v_pk_add_f32 v[16:17], v[16:17], v[196:197]
    v_pk_add_f32 v[18:19], v[18:19], v[198:199]
    v_pk_add_f32 v[16:17], v[16:17], v[200:201]
    v_pk_add_f32 v[18:19], v[18:19], v[202:203]
    v_pk_add_f32 v[16:17], v[16:17], v[204:205]
    v_pk_add_f32 v[18:19], v[18:19], v[206:207]
    v_pk_add_f32 v[16:17], v[16:17], v[208:209]
    v_pk_add_f32 v[18:19], v[18:19], v[210:211]
    v_pk_add_f32 v[16:17], v[16:17], v[212:213]
    v_pk_add_f32 v[18:19], v[18:19], v[214:215]
    v_pk_add_f32 v[16:17], v[16:17], v[216:217]
    v_pk_add_f32 v[18:19], v[18:19], v[218:219]
    s_add_u32 m0, s68, 0x10400
    s_nop 0
    buffer_load_dwordx4 v41, s[44:47], s43 offen lds
    s_add_u32 s43, s43, 8192
    v_pk_add_f32 v[16:17], v[16:17], v[220:221]
    v_pk_add_f32 v[18:19], v[18:19], v[222:223]
    v_pk_add_f32 v[16:17], v[16:17], v[18:19]
    v_add_f32 v16, v16, v17
    v_mov_b32 v17, v16
    s_nop 1
    v_permlane32_swap_b32 v16, v17
    v_add_f32 v16, v16, v17
    s_lshl_b32 s33, s30, 8
    v_add_u32 v17, s33, v2
    v_add_u32 v20, s68, v2
    ds_write_b32 v17, v16 offset:0
    ds_write_b32 v17, v16 offset:4096
    ds_write_b32 v17, v16 offset:8192
    ds_write_b32 v17, v16 offset:12288
    s_waitcnt lgkmcnt(0)
    s_barrier
    ds_read_b32 v16, v20 offset:0
    ds_read_b32 v17, v20 offset:256
    ds_read_b32 v18, v20 offset:512
    ds_read_b32 v19, v20 offset:768
    s_waitcnt lgkmcnt(0)
    v_add_f32 v16, v16, v17
    s_add_u32 m0, s68, 0x10800
    s_nop 0
    buffer_load_dwordx4 v41, s[44:47], s43 offen lds
    s_add_u32 s43, s43, 8192
    v_add_f32 v18, v18, v19
    v_add_f32 v16, v16, v18
    v_mul_f32 v16, s98, v16
    s_add_u32 s34, s97, 4096
    v_pk_add_f32 v[160:161], v[160:161], v[16:17] op_sel_hi:[1,0]
    v_pk_add_f32 v[162:163], v[162:163], v[16:17] op_sel_hi:[1,0]
    v_pk_add_f32 v[164:165], v[164:165], v[16:17] op_sel_hi:[1,0]
    v_pk_add_f32 v[166:167], v[166:167], v[16:17] op_sel_hi:[1,0]
    v_cvt_pk_bf16_f32 v128, v160, v161
    v_cvt_pk_bf16_f32 v129, v162, v163
    v_cvt_pk_bf16_f32 v130, v164, v165
    v_cvt_pk_bf16_f32 v131, v166, v167
    buffer_store_dwordx4 v[128:131], v40, s[4:7], s97 offen offset:0 sc1
    v_pk_add_f32 v[168:169], v[168:169], v[16:17] op_sel_hi:[1,0]
    s_add_u32 m0, s68, 0x10c00
    s_nop 0
    buffer_load_dwordx4 v41, s[44:47], s43 offen lds
    s_add_u32 s43, s43, 8192
    v_pk_add_f32 v[170:171], v[170:171], v[16:17] op_sel_hi:[1,0]
    v_pk_add_f32 v[172:173], v[172:173], v[16:17] op_sel_hi:[1,0]
    v_pk_add_f32 v[174:175], v[174:175], v[16:17] op_sel_hi:[1,0]
    v_cvt_pk_bf16_f32 v132, v168, v169
    v_cvt_pk_bf16_f32 v133, v170, v171
    v_cvt_pk_bf16_f32 v134, v172, v173
    v_cvt_pk_bf16_f32 v135, v174, v175
    buffer_store_dwordx4 v[132:135], v40, s[4:7], s97 offen offset:1024 sc1
    v_pk_add_f32 v[176:177], v[176:177], v[16:17] op_sel_hi:[1,0]
    v_pk_add_f32 v[178:179], v[178:179], v[16:17] op_sel_hi:[1,0]
    v_pk_add_f32 v[180:181], v[180:181], v[16:17] op_sel_hi:[1,0]
    v_pk_add_f32 v[182:183], v[182:183], v[16:17] op_sel_hi:[1,0]
    v_cvt_pk_bf16_f32 v136, v176, v177
    v_cvt_pk_bf16_f32 v137, v178, v179
    v_cvt_pk_bf16_f32 v138, v180, v181
    v_cvt_pk_bf16_f32 v139, v182, v183
    buffer_store_dwordx4 v[136:139], v40, s[4:7], s97 offen offset:2048 sc1
    v_pk_add_f32 v[184:185], v[184:185], v[16:17] op_sel_hi:[1,0]
    v_pk_add_f32 v[186:187], v[186:187], v[16:17] op_sel_hi:[1,0]
    v_pk_add_f32 v[188:189], v[188:189], v[16:17] op_sel_hi:[1,0]
    v_pk_add_f32 v[190:191], v[190:191], v[16:17] op_sel_hi:[1,0]
    v_cvt_pk_bf16_f32 v140, v184, v185
    v_cvt_pk_bf16_f32 v141, v186, v187
    v_cvt_pk_bf16_f32 v142, v188, v189
    v_cvt_pk_bf16_f32 v143, v190, v191
    buffer_store_dwordx4 v[140:143], v40, s[4:7], s97 offen offset:3072 sc1
    v_pk_add_f32 v[192:193], v[192:193], v[16:17] op_sel_hi:[1,0]
    v_pk_add_f32 v[194:195], v[194:195], v[16:17] op_sel_hi:[1,0]
    v_pk_add_f32 v[196:197], v[196:197], v[16:17] op_sel_hi:[1,0]
    v_pk_add_f32 v[198:199], v[198:199], v[16:17] op_sel_hi:[1,0]
    v_cvt_pk_bf16_f32 v144, v192, v193
    v_cvt_pk_bf16_f32 v145, v194, v195
    v_cvt_pk_bf16_f32 v146, v196, v197
    v_cvt_pk_bf16_f32 v147, v198, v199
    buffer_store_dwordx4 v[144:147], v40, s[4:7], s34 offen offset:0 sc1
    v_pk_add_f32 v[200:201], v[200:201], v[16:17] op_sel_hi:[1,0]
    v_pk_add_f32 v[202:203], v[202:203], v[16:17] op_sel_hi:[1,0]
    v_pk_add_f32 v[204:205], v[204:205], v[16:17] op_sel_hi:[1,0]
    v_pk_add_f32 v[206:207], v[206:207], v[16:17] op_sel_hi:[1,0]
    v_cvt_pk_bf16_f32 v148, v200, v201
    v_cvt_pk_bf16_f32 v149, v202, v203
    v_cvt_pk_bf16_f32 v150, v204, v205
    v_cvt_pk_bf16_f32 v151, v206, v207
    buffer_store_dwordx4 v[148:151], v40, s[4:7], s34 offen offset:1024 sc1
    v_pk_add_f32 v[208:209], v[208:209], v[16:17] op_sel_hi:[1,0]
    v_pk_add_f32 v[210:211], v[210:211], v[16:17] op_sel_hi:[1,0]
    v_pk_add_f32 v[212:213], v[212:213], v[16:17] op_sel_hi:[1,0]
    v_pk_add_f32 v[214:215], v[214:215], v[16:17] op_sel_hi:[1,0]
    v_cvt_pk_bf16_f32 v152, v208, v209
    v_cvt_pk_bf16_f32 v153, v210, v211
    s_branch WZ0
.p2align 12
WZ0:
    s_cbranch_execz WZ4
    v_cvt_pk_bf16_f32 v154, v212, v213
    v_cvt_pk_bf16_f32 v155, v214, v215
    buffer_store_dwordx4 v[152:155], v40, s[4:7], s34 offen offset:2048 sc1
    v_pk_add_f32 v[216:217], v[216:217], v[16:17] op_sel_hi:[1,0]
    v_pk_add_f32 v[218:219], v[218:219], v[16:17] op_sel_hi:[1,0]
    v_pk_add_f32 v[220:221], v[220:221], v[16:17] op_sel_hi:[1,0]
    v_pk_add_f32 v[222:223], v[222:223], v[16:17] op_sel_hi:[1,0]
    v_cvt_pk_bf16_f32 v156, v216, v217
    v_cvt_pk_bf16_f32 v157, v218, v219
    v_cvt_pk_bf16_f32 v158, v220, v221
    v_cvt_pk_bf16_f32 v159, v222, v223
    buffer_store_dwordx4 v[156:159], v40, s[4:7], s34 offen offset:3072 sc1
    buffer_load_dword v7, v2, s[16:19], 0 offen sc1
    v_and_b32 v8, 31, v0
    s_add_u32 m0, s68, 0x14000
    s_nop 0
    buffer_load_dwordx4 v41, s[44:47], s43 offen lds
    s_add_u32 s43, s43, 8192
    v_lshrrev_b32 v9, 5, v0
    v_and_b32 v14, 15, v8
    s_mul_i32 s89, s30, 114688
    s_add_u32 s89, s89, s32
    s_mov_b32 s34, s29
    s_lshl_b32 s34, s34, 10
    s_add_u32 s92, s89, s34
    s_add_u32 s92, s92, 0x30000
    v_add_u32 v4, 65536, v1
    v_add_u32 v5, 131072, v1
    s_mov_b32 s83, s68
    s_add_u32 s84, s68, 65536
    s_add_u32 s41, s68, 131072
    s_getreg_b32 s40, hwreg(HW_REG_XCC_ID)
    s_and_b32 s40, s40, 15
    s_or_b32 s40, s40, 16
    s_lshl_b32 s75, s28, 9
    s_add_u32 m0, s68, 0x14400
    s_nop 0
    buffer_load_dwordx4 v41, s[44:47], s43 offen lds
    s_add_u32 s43, s43, 8192
    s_add_u32 s75, s75, 0x6ae000
    s_lshl_b32 s33, s100, 5
    s_add_u32 s33, s33, s101
    s_lshl2_add_u32 s62, s33, s75
    s_add_u32 s62, s62, 64
    s_lshr_b32 s33, s29, 2
    s_lshr_b32 s34, s30, 1
    s_lshl2_add_u32 s33, s33, s34
    s_and_b32 s34, s29, 3
    s_lshl2_add_u32 s33, s33, s34
    s_and_b32 s34, s30, 1
    s_lshl1_add_u32 s33, s33, s34
    s_lshl2_add_u32 s76, s33, s75
    s_lshl_b32 s33, s30, 7
    s_add_u32 m0, s68, 0x14800
    s_nop 0
    buffer_load_dwordx4 v41, s[44:47], s43 offen lds
    s_add_u32 s43, s43, 8192
    s_add_u32 s75, s75, s33
    s_lshl_b32 s34, s30, 2
    s_lshl_b32 s77, s29, 11
    s_add_u32 s77, s77, 0x6a0000
    s_add_u32 s35, s30, 1
    s_and_b32 s35, s35, 4
    s_add_u32 s34, s34, s35
    s_lshl_b32 s33, s28, 7
    s_add_u32 s78, s77, s33
    s_add_u32 s78, s78, s34
    s_lshl_b32 s72, s30, 15
    s_add_u32 s72, s72, s32
    s_add_u32 s73, s68, s32
    s_add_u32 s73, s73, 0x20000
    s_mul_i32 s79, s29, 98304
    s_add_u32 m0, s68, 0x14c00
    s_nop 0
    buffer_load_dwordx4 v41, s[44:47], s43 offen lds
    s_add_u32 s43, s43, 8192
    s_add_u32 s79, s79, s68
    s_mul_i32 s80, s29, 229376
    s_add_u32 s80, s80, s68
    s_add_u32 s80, s80, 0x200000
    s_lshl_b32 s33, s30, 13
    s_lshl_b32 s81, s101, 15
    s_add_u32 s81, s81, s33
    s_add_u32 s81, s81, 0x180000
    s_xor_b32 s82, s81, 0x8000
    s_add_u32 s86, s86, s33
    s_xor_b32 s34, s100, 0
    s_mul_i32 s34, s34, 114688
    s_add_u32 m0, s68, 0x18000
    s_nop 0
    buffer_load_dwordx4 v41, s[44:47], s43 offen lds
    s_add_u32 s43, s43, 8192
    s_add_u32 s34, s34, s32
    s_add_u32 s93, s34, s68
    s_add_u32 s93, s93, 0x30000
    s_add_u32 s90, s34, s33
    s_add_u32 s90, s90, 0x30000
    s_xor_b32 s34, s100, 1
    s_mul_i32 s34, s34, 114688
    s_add_u32 s34, s34, s32
    s_add_u32 s94, s34, s68
    s_add_u32 s94, s94, 0x30000
    s_add_u32 s91, s34, s33
    s_add_u32 s91, s91, 0x30000
    s_lshr_b32 s34, s30, 1
    s_add_u32 m0, s68, 0x18400
    s_nop 0
    buffer_load_dwordx4 v41, s[44:47], s43 offen lds
    s_add_u32 s43, s43, 8192
    s_lshl_b32 s34, s34, 7
    s_add_u32 s88, s88, s34
    s_and_b32 s34, s30, 1
    s_lshl_b32 s34, s34, 11
    s_add_u32 s88, s88, s34
    s_lshl_b32 s34, s29, 11
    s_add_u32 s89, s89, s34
    s_add_u32 s89, s89, 0x30000
    s_add_u32 s55, s72, 0x0
    s_and_b32 s33, s28, 1
    s_lshl_b32 s34, s33, 14
    s_lshl_b32 s33, s33, 12
    s_add_u32 m0, s68, 0x18800
    s_nop 0
    buffer_load_dwordx4 v41, s[44:47], s43 offen lds
    s_add_u32 s43, s43, 8192
    s_add_u32 s72, s72, s34
    s_add_u32 s79, s79, s34
    s_add_u32 s81, s81, s33
    s_add_u32 s82, s82, s33
    s_add_u32 s90, s90, s33
    s_add_u32 s91, s91, s33
    s_add_u32 s86, s86, s33
    s_xor_b32 s48, s79, 0x4000
    s_xor_b32 s49, s80, 0x4000
    s_add_u32 s63, s80, 163840
    s_add_u32 s99, s49, 163840
    s_and_b32 s33, s29, 8
    s_lshl_b32 s60, 0xff, s33
    s_add_u32 m0, s68, 0x18c00
    s_nop 0
    buffer_load_dwordx4 v41, s[44:47], s43 offen lds
    s_add_u32 s43, s43, 8192
    s_mov_b32 s61, 0
    s_and_b32 s33, s30, 1
    s_lshr_b32 s34, s30, 1
    s_lshl_b32 s64, 0x11111111, s34
    s_or_b32 s64, s64, 0x44444444
    s_mov_b32 s65, 0
    s_lshl_b32 s33, s33, 5
    s_lshl_b64 s[64:65], s[64:65], s33
    s_mov_b32 s38, 0x03000ff7
    s_mov_b32 s39, -1
    v_bfe_u32 v42, v0, 2, 2
    v_lshl_add_u32 v43, v9, 2, v42
    s_add_u32 m0, s68, 0x1c000
    s_nop 0
    buffer_load_dwordx4 v41, s[44:47], s43 offen lds
    s_add_u32 s43, s43, 8192
    v_lshlrev_b32 v43, 7, v43
    v_lshrrev_b32 v42, 1, v42
    s_and_b32 s33, s101, 1
    v_xor_b32 v42, s33, v42
    v_lshl_add_u32 v43, v42, 6, v43
    v_bfe_u32 v42, v0, 4, 1
    v_lshl_add_u32 v43, v42, 5, v43
    v_and_b32 v42, 3, v0
    v_lshl_add_u32 v43, v42, 3, v43
    v_add_u32 v46, s68, v43
    v_xor_b32 v47, 64, v46
    v_add_u32 v48, 65536, v46
    s_add_u32 m0, s68, 0x1c400
    s_nop 0
    buffer_load_dwordx4 v41, s[44:47], s43 offen lds
    s_add_u32 s43, s43, 8192
    v_add_u32 v49, 65536, v47
    v_add_u32 v50, 131072, v46
    v_add_u32 v51, 131072, v47
    v_lshrrev_b32 v12, 4, v0
    v_lshl_add_u32 v12, v12, 28, v2
    v_lshlrev_b32 v13, 4, v0
    v_add_u32 v13, s29, v13
    s_mul_i32 s33, s29, 7
    s_lshr_b32 s33, s33, 1
    s_and_b32 s35, s29, 7
    s_add_u32 s34, s33, 44
    v_add_u32 v42, s34, v0
    s_add_u32 m0, s68, 0x1c800
    s_nop 0
    buffer_load_dwordx4 v41, s[44:47], s43 offen lds
    s_add_u32 s43, s43, 8192
    v_cmp_le_u32 vcc, 4, v0
    s_nop 1
    v_cndmask_b32 v13, v13, v42, vcc
    s_add_u32 s34, s33, 96
    v_add_u32 v42, s34, v0
    v_cmp_le_u32 vcc, 8, v0
    s_nop 1
    v_cndmask_b32 v13, v13, v42, vcc
    s_lshl_b32 s34, s35, 1
    s_add_u32 s34, s34, 136
    v_add_u32 v42, s34, v0
    v_cmp_le_u32 vcc, 24, v0
    s_nop 1
    v_cndmask_b32 v13, v13, v42, vcc
    v_lshlrev_b32 v13, 7, v13
    s_add_u32 m0, s68, 0x1cc00
    s_nop 0
    buffer_load_dwordx4 v41, s[44:47], s43 offen lds
    s_add_u32 s43, s43, 8192
    v_add_u32 v13, 0x6a8000, v13
    s_lshl_b32 s33, s28, 7
    s_add_u32 s33, s33, 0x69000c
    v_lshlrev_b32 v42, 11, v0
    v_add_u32 v42, s33, v42
    v_cmp_le_u32 vcc, 32, v0
    s_nop 1
    v_cndmask_b32 v13, v13, v42, vcc
    s_add_u32 s33, s77, 0xffffe80c
    v_lshlrev_b32 v42, 7, v0
    v_add_u32 v42, s33, v42
    v_cmp_le_u32 vcc, 48, v0
    s_nop 1
    v_cndmask_b32 v13, v13, v42, vcc
    s_add_u32 m0, s68, 0x20000
    s_nop 0
    buffer_load_dwordx4 v41, s[44:47], s43 offen lds
    s_add_u32 s43, s43, 8192
    s_lshl_b32 s33, s28, 7
    s_add_u32 s33, s33, s77
    s_add_u32 s33, s33, 12
    s_lshl_b32 s34, s95, 7
    s_add_u32 s34, s34, 0x6a8000
    v_mov_b32 v45, s33
    v_writelane_b32 v45, s34, 1
    v_lshrrev_b32 v24, 3, v14
    v_and_b32 v25, 3, v14
    v_lshl_add_u32 v24, v24, 2, v25
    v_bfe_u32 v25, v14, 2, 1
    v_cmp_eq_u32 vcc, v25, v9
    s_add_u32 m0, s68, 0x20400
    s_nop 0
    buffer_load_dwordx4 v41, s[44:47], s43 offen lds
    s_add_u32 s43, s43, 8192
    v_cndmask_b32 v24, 15, v24, vcc
    v_and_b32 v26, 1, v24
    v_lshlrev_b32 v26, 4, v26
    s_movk_i32 s33, 0x3f80
    v_lshlrev_b32 v26, v26, s33
    v_lshrrev_b32 v27, 1, v24
    v_cmp_eq_u32 vcc, 0, v27
    s_nop 1
    v_cndmask_b32 v28, 0, v26, vcc
    v_cmp_eq_u32 vcc, 1, v27
    s_nop 1
    v_cndmask_b32 v29, 0, v26, vcc
    v_cmp_eq_u32 vcc, 2, v27
    s_nop 1
    v_cndmask_b32 v30, 0, v26, vcc
    s_add_u32 m0, s68, 0x20800
    s_nop 0
    buffer_load_dwordx4 v41, s[44:47], s43 offen lds
    s_add_u32 s43, s43, 8192
    v_cmp_eq_u32 vcc, 3, v27
    s_nop 1
    v_cndmask_b32 v31, 0, v26, vcc
    v_cmp_gt_u32 vcc, 16, v8
    v_mov_b32 v25, 0x3f803f80
    s_nop 0
    v_cndmask_b32 v32, 0, v28, vcc
    v_cndmask_b32 v33, v28, 0, vcc
    v_cndmask_b32 v34, v25, 0, vcc
    v_accvgpr_write_b32 a248, v28
    v_accvgpr_write_b32 a240, v32
    v_accvgpr_write_b32 a244, v33
    v_accvgpr_write_b32 a252, v34
    v_cndmask_b32 v32, 0, v29, vcc
    s_add_u32 m0, s68, 0x20c00
    s_nop 0
    buffer_load_dwordx4 v41, s[44:47], s43 offen lds
    s_add_u32 s43, s43, 8192
    v_cndmask_b32 v33, v29, 0, vcc
    v_cndmask_b32 v34, v25, 0, vcc
    v_accvgpr_write_b32 a249, v29
    v_accvgpr_write_b32 a241, v32
    v_accvgpr_write_b32 a245, v33
    v_accvgpr_write_b32 a253, v34
    v_cndmask_b32 v32, 0, v30, vcc
    v_cndmask_b32 v33, v30, 0, vcc
    v_cndmask_b32 v34, v25, 0, vcc
    v_accvgpr_write_b32 a250, v30
    v_accvgpr_write_b32 a242, v32
    v_accvgpr_write_b32 a246, v33
    v_accvgpr_write_b32 a254, v34
    v_cndmask_b32 v32, 0, v31, vcc
    v_cndmask_b32 v33, v31, 0, vcc
    v_cndmask_b32 v34, v25, 0, vcc
    v_accvgpr_write_b32 a251, v31
    v_accvgpr_write_b32 a243, v32
    v_accvgpr_write_b32 a247, v33
    v_accvgpr_write_b32 a255, v34
    s_waitcnt vmcnt(16)
    v_cmp_eq_u32 vcc, 0, v7
    s_and_b64 vcc, vcc, 0xff
    s_cbranch_scc1 GO_SPIN
GO_OK:
    s_barrier
    s_cmp_lg_u32 s30, 0
    s_cbranch_scc1 G_NOSIG
    v_mov_b32 v7, s40
    s_cmp_lt_i32 s95, 0
    s_cselect_b64 exec, 1, 3
    buffer_store_dword v7, v45, s[4:7], 0 offen sc1
    s_mov_b64 exec, -1
G_NOSIG:
    v_lshlrev_b32 v56, 5, v0
    buffer_load_dword v56, v56, s[4:7], s70 offen sc1
    buffer_load_dword v57, v2, s[4:7], s71 offen sc1
    s_add_u32 m0, s68, 0x24000
    s_nop 0
    buffer_load_dwordx4 v41, s[44:47], s43 offen lds
    s_add_u32 s43, s43, 8192
    s_add_u32 m0, s68, 0x24400
    s_nop 0
    buffer_load_dwordx4 v41, s[44:47], s43 offen lds
    s_add_u32 s43, s43, 8192
    s_add_u32 m0, s68, 0x24800
    s_nop 0
    buffer_load_dwordx4 v41, s[44:47], s43 offen lds
    s_add_u32 s43, s43, 8192
    s_add_u32 m0, s68, 0x24c00
    s_nop 0
    buffer_load_dwordx4 v41, s[44:47], s43 offen lds
    s_add_u32 s43, s43, 8192
    s_add_u32 m0, s68, 0x0
    s_nop 0
    buffer_load_dwordx4 v41, s[44:47], s43 offen lds
    s_add_u32 s43, s43, 8192
    s_add_u32 m0, s68, 0x400
    s_nop 0
    buffer_load_dwordx4 v41, s[44:47], s43 offen lds
    s_add_u32 s43, s43, 8192
    s_add_u32 m0, s68, 0x800
    s_nop 0
    buffer_load_dwordx4 v41, s[44:47], s43 offen lds
    s_add_u32 s43, s43, 8192
    s_add_u32 m0, s68, 0xc00
    s_nop 0
    buffer_load_dwordx4 v41, s[44:47], s43 offen lds
    s_add_u32 s43, s43, 8192
    s_add_u32 m0, s68, 0x4000
    s_nop 0
    buffer_load_dwordx4 v41, s[44:47], s43 offen lds
    s_add_u32 s43, s43, 8192
    s_add_u32 m0, s68, 0x4400
    s_nop 0
    buffer_load_dwordx4 v41, s[44:47], s43 offen lds
    s_add_u32 s43, s43, 8192
    s_add_u32 m0, s68, 0x4800
    s_nop 0
    buffer_load_dwordx4 v41, s[44:47], s43 offen lds
    s_add_u32 s43, s43, 8192
    s_add_u32 m0, s68, 0x4c00
    s_nop 0
    buffer_load_dwordx4 v41, s[44:47], s43 offen lds
    s_add_u32 s43, s43, 8192
    s_add_u32 m0, s68, 0x8000
    s_nop 0
    buffer_load_dwordx4 v41, s[44:47], s43 offen lds
    s_add_u32 s43, s43, 8192
    s_add_u32 m0, s68, 0x8400
    s_nop 0
    buffer_load_dwordx4 v41, s[44:47], s43 offen lds
    s_add_u32 s43, s43, 8192
    s_add_u32 m0, s68, 0x8800
    s_nop 0
    buffer_load_dwordx4 v41, s[44:47], s43 offen lds
    s_add_u32 s43, s43, 8192
    s_add_u32 m0, s68, 0x8c00
    s_nop 0
    buffer_load_dwordx4 v41, s[44:47], s43 offen lds
    s_add_u32 s43, s43, 8192
    s_add_u32 m0, s68, 0xc000
    s_nop 0
    buffer_load_dwordx4 v41, s[44:47], s43 offen lds
    s_add_u32 s43, s43, 8192
    s_add_u32 m0, s68, 0xc400
    s_nop 0
    buffer_load_dwordx4 v41, s[44:47], s43 offen lds
    s_add_u32 s43, s43, 8192
    s_add_u32 m0, s68, 0xc800
    s_nop 0
    buffer_load_dwordx4 v41, s[44:47], s43 offen lds
    s_add_u32 s43, s43, 8192
    s_add_u32 m0, s68, 0xcc00
    s_nop 0
    buffer_load_dwordx4 v41, s[44:47], s43 offen lds
    s_add_u32 s43, s43, 8192
    s_waitcnt vmcnt(16)
    ds_read_b64_tr_b16 a[0:1], v48 offset:0
    ds_read_b64_tr_b16 a[2:3], v48 offset:1024
    ds_read_b64_tr_b16 a[112:113], v49 offset:0
    ds_read_b64_tr_b16 a[114:115], v49 offset:1024
    ds_read_b64_tr_b16 a[4:5], v48 offset:2048
    ds_read_b64_tr_b16 a[6:7], v48 offset:3072
    ds_read_b64_tr_b16 a[116:117], v49 offset:2048
    ds_read_b64_tr_b16 a[118:119], v49 offset:3072
    ds_read_b64_tr_b16 a[8:9], v48 offset:16384
    ds_read_b64_tr_b16 a[10:11], v48 offset:17408
    ds_read_b64_tr_b16 a[120:121], v49 offset:16384
    ds_read_b64_tr_b16 a[122:123], v49 offset:17408
    ds_read_b64_tr_b16 a[12:13], v48 offset:18432
    ds_read_b64_tr_b16 a[14:15], v48 offset:19456
    ds_read_b64_tr_b16 a[124:125], v49 offset:18432
    ds_read_b64_tr_b16 a[126:127], v49 offset:19456
    ds_read_b64_tr_b16 a[16:17], v48 offset:32768
    ds_read_b64_tr_b16 a[18:19], v48 offset:33792
    ds_read_b64_tr_b16 a[128:129], v49 offset:32768
    ds_read_b64_tr_b16 a[130:131], v49 offset:33792
    ds_read_b64_tr_b16 a[20:21], v48 offset:34816
    ds_read_b64_tr_b16 a[22:23], v48 offset:35840
    ds_read_b64_tr_b16 a[132:133], v49 offset:34816
    ds_read_b64_tr_b16 a[134:135], v49 offset:35840
    ds_read_b64_tr_b16 a[24:25], v48 offset:49152
    ds_read_b64_tr_b16 a[26:27], v48 offset:50176
    ds_read_b64_tr_b16 a[136:137], v49 offset:49152
    ds_read_b64_tr_b16 a[138:139], v49 offset:50176
    ds_read_b64_tr_b16 a[28:29], v48 offset:51200
    ds_read_b64_tr_b16 a[30:31], v48 offset:52224
    ds_read_b64_tr_b16 a[140:141], v49 offset:51200
    ds_read_b64_tr_b16 a[142:143], v49 offset:52224
    ds_read_b64_tr_b16 a[32:33], v50 offset:0
    ds_read_b64_tr_b16 a[34:35], v50 offset:1024
    ds_read_b64_tr_b16 a[144:145], v51 offset:0
    ds_read_b64_tr_b16 a[146:147], v51 offset:1024
    ds_read_b64_tr_b16 a[36:37], v50 offset:2048
    ds_read_b64_tr_b16 a[38:39], v50 offset:3072
    ds_read_b64_tr_b16 a[148:149], v51 offset:2048
    ds_read_b64_tr_b16 a[150:151], v51 offset:3072
    ds_read_b64_tr_b16 a[40:41], v50 offset:16384
    ds_read_b64_tr_b16 a[42:43], v50 offset:17408
    ds_read_b64_tr_b16 a[152:153], v51 offset:16384
    ds_read_b64_tr_b16 a[154:155], v51 offset:17408
    ds_read_b64_tr_b16 a[44:45], v50 offset:18432
    ds_read_b64_tr_b16 a[46:47], v50 offset:19456
    ds_read_b64_tr_b16 a[156:157], v51 offset:18432
    ds_read_b64_tr_b16 a[158:159], v51 offset:19456
    s_waitcnt lgkmcnt(0)
    s_add_u32 m0, s68, 0x20000
    s_nop 0
    buffer_load_dwordx4 v41, s[44:47], s43 offen lds
    s_add_u32 s43, s43, 8192
    s_add_u32 m0, s68, 0x20400
    s_nop 0
    buffer_load_dwordx4 v41, s[44:47], s43 offen lds
    s_add_u32 s43, s43, 8192
    s_add_u32 m0, s68, 0x20800
    s_nop 0
    buffer_load_dwordx4 v41, s[44:47], s43 offen lds
    s_add_u32 s43, s43, 8192
    s_add_u32 m0, s68, 0x20c00
    s_nop 0
    buffer_load_dwordx4 v41, s[44:47], s43 offen lds
    s_add_u32 s43, s43, 8192
    s_add_u32 m0, s68, 0x24000
    s_nop 0
    buffer_load_dwordx4 v41, s[44:47], s43 offen lds
    s_add_u32 s43, s43, 8192
    s_add_u32 m0, s68, 0x24400
    s_nop 0
    buffer_load_dwordx4 v41, s[44:47], s43 offen lds
    s_add_u32 s43, s43, 8192
    s_add_u32 m0, s68, 0x24800
    s_nop 0
    buffer_load_dwordx4 v41, s[44:47], s43 offen lds
    s_add_u32 s43, s43, 8192
    s_add_u32 m0, s68, 0x24c00
    s_nop 0
    buffer_load_dwordx4 v41, s[44:47], s43 offen lds
    s_add_u32 s43, s43, 8192
    s_waitcnt vmcnt(16)
    ds_read_b64_tr_b16 a[48:49], v46 offset:0
    ds_read_b64_tr_b16 a[50:51], v46 offset:1024
    ds_read_b64_tr_b16 a[160:161], v47 offset:0
    ds_read_b64_tr_b16 a[162:163], v47 offset:1024
    ds_read_b64_tr_b16 a[52:53], v46 offset:2048
    ds_read_b64_tr_b16 a[54:55], v46 offset:3072
    ds_read_b64_tr_b16 a[164:165], v47 offset:2048
    ds_read_b64_tr_b16 a[166:167], v47 offset:3072
    ds_read_b64_tr_b16 a[56:57], v46 offset:16384
    ds_read_b64_tr_b16 a[58:59], v46 offset:17408
    ds_read_b64_tr_b16 a[168:169], v47 offset:16384
    ds_read_b64_tr_b16 a[170:171], v47 offset:17408
    ds_read_b64_tr_b16 a[60:61], v46 offset:18432
    ds_read_b64_tr_b16 a[62:63], v46 offset:19456
    ds_read_b64_tr_b16 a[172:173], v47 offset:18432
    ds_read_b64_tr_b16 a[174:175], v47 offset:19456
    s_waitcnt lgkmcnt(0)
    s_add_u32 m0, s68, 0x0
    s_nop 0
    buffer_load_dwordx4 v41, s[44:47], s43 offen lds
    s_add_u32 s43, s43, 8192
    s_add_u32 m0, s68, 0x400
    s_nop 0
    buffer_load_dwordx4 v41, s[44:47], s43 offen lds
    s_add_u32 s43, s43, 8192
    s_getpc_b64 s[34:35]
PC_1:
    s_and_b32 s33, s2, 0xf8
    s_lshl1_add_u32 s33, s30, s33
    v_lshrrev_b32 v58, 5, v0
    v_add_lshl_u32 v58, v58, s33, 7
    v_min_u32 v58, CODE_END-PC_1-4, v58
    v_mov_b32 v59, 0
    v_lshl_add_u64 v[58:59], v[58:59], 0, s[34:35]
    global_load_dword v58, v[58:59], off
    s_add_u32 m0, s68, 0x800
    s_nop 0
    buffer_load_dwordx4 v41, s[44:47], s43 offen lds
    s_add_u32 s43, s43, 8192
    s_add_u32 m0, s68, 0xc00
    s_nop 0
    buffer_load_dwordx4 v41, s[44:47], s43 offen lds
    s_add_u32 s43, s43, 8192
    s_add_u32 m0, s68, 0x4000
    s_nop 0
    buffer_load_dwordx4 v41, s[44:47], s43 offen lds
    s_add_u32 s43, s43, 8192
    s_add_u32 m0, s68, 0x4400
    s_nop 0
    buffer_load_dwordx4 v41, s[44:47], s43 offen lds
    s_add_u32 s43, s43, 8192
    s_add_u32 m0, s68, 0x4800
    s_nop 0
    buffer_load_dwordx4 v41, s[44:47], s43 offen lds
    s_add_u32 s43, s43, 8192
    s_mov_b64 exec, s[38:39]
    buffer_load_dword v60, v13, s[4:7], 0 offen sc1
    s_mov_b64 exec, -1
    s_add_u32 m0, s68, 0x4c00
    s_nop 0
    buffer_load_dwordx4 v41, s[44:47], s43 offen lds
    s_add_u32 s43, s43, 8192
    s_mov_b32 s95, 0
    s_waitcnt vmcnt(1)
    v_cmp_ne_u32 s[36:37], s40, v60
    v_cmp_eq_u32 vcc, 0, v60
    s_and_b64 vcc, vcc, s[38:39]
    s_cbranch_scc1 P0_SPIN
P0_OK:
    s_and_b32 s36, s37, 0xffff
    s_mov_b32 s37, 0
    s_add_u32 s97, s79, 0x0
    s_add_u32 m0, s84, 0x0
    s_nop 0
    buffer_load_dwordx4 v1, s[4:7], s97 offen offset:0 sc1  lds
    buffer_load_dwordx4 v1, s[4:7], s97 offen offset:1024 sc1  lds
    buffer_load_dwordx4 v1, s[4:7], s97 offen offset:2048 sc1  lds
    buffer_load_dwordx4 v1, s[4:7], s97 offen offset:3072 sc1  lds
    s_add_u32 s97, s79, 0x8000
    s_add_u32 m0, s84, 0x8000
    s_nop 0
    buffer_load_dwordx4 v1, s[4:7], s97 offen offset:0 sc1  lds
    buffer_load_dwordx4 v1, s[4:7], s97 offen offset:1024 sc1  lds
    buffer_load_dwordx4 v1, s[4:7], s97 offen offset:2048 sc1  lds
    buffer_load_dwordx4 v1, s[4:7], s97 offen offset:3072 sc1  lds
    s_add_u32 s97, s48, 0x0
    s_add_u32 m0, s84, 0x4000
    s_nop 0
    buffer_load_dwordx4 v1, s[4:7], s97 offen offset:0 sc1  lds
    buffer_load_dwordx4 v1, s[4:7], s97 offen offset:1024 sc1  lds
    buffer_load_dwordx4 v1, s[4:7], s97 offen offset:2048 sc1  lds
    buffer_load_dwordx4 v1, s[4:7], s97 offen offset:3072 sc1  lds
    s_add_u32 s97, s48, 0x8000
    s_add_u32 m0, s84, 0xc000
    s_nop 0
    buffer_load_dwordx4 v1, s[4:7], s97 offen offset:0 sc1  lds
    buffer_load_dwordx4 v1, s[4:7], s97 offen offset:1024 sc1  lds
    buffer_load_dwordx4 v1, s[4:7], s97 offen offset:2048 sc1  lds
    buffer_load_dwordx4 v1, s[4:7], s97 offen offset:3072 sc1  lds
    ds_read_b64_tr_b16 a[64:65], v46 offset:32768
    ds_read_b64_tr_b16 a[66:67], v46 offset:33792
    ds_read_b64_tr_b16 a[176:177], v47 offset:32768
    ds_read_b64_tr_b16 a[178:179], v47 offset:33792
    ds_read_b64_tr_b16 a[68:69], v46 offset:34816
    ds_read_b64_tr_b16 a[70:71], v46 offset:35840
    ds_read_b64_tr_b16 a[180:181], v47 offset:34816
    ds_read_b64_tr_b16 a[182:183], v47 offset:35840
    ds_read_b64_tr_b16 a[72:73], v46 offset:49152
    ds_read_b64_tr_b16 a[74:75], v46 offset:50176
    ds_read_b64_tr_b16 a[184:185], v47 offset:49152
    ds_read_b64_tr_b16 a[186:187], v47 offset:50176
    ds_read_b64_tr_b16 a[76:77], v46 offset:51200
    ds_read_b64_tr_b16 a[78:79], v46 offset:52224
    ds_read_b64_tr_b16 a[188:189], v47 offset:51200
    ds_read_b64_tr_b16 a[190:191], v47 offset:52224
    ds_read_b64_tr_b16 a[80:81], v50 offset:0
    ds_read_b64_tr_b16 a[82:83], v50 offset:1024
    ds_read_b64_tr_b16 a[192:193], v51 offset:0
    ds_read_b64_tr_b16 a[194:195], v51 offset:1024
    ds_read_b64_tr_b16 a[84:85], v50 offset:2048
    ds_read_b64_tr_b16 a[86:87], v50 offset:3072
    ds_read_b64_tr_b16 a[196:197], v51 offset:2048
    ds_read_b64_tr_b16 a[198:199], v51 offset:3072
    ds_read_b64_tr_b16 a[88:89], v50 offset:16384
    ds_read_b64_tr_b16 a[90:91], v50 offset:17408
    ds_read_b64_tr_b16 a[200:201], v51 offset:16384
    ds_read_b64_tr_b16 a[202:203], v51 offset:17408
    ds_read_b64_tr_b16 a[92:93], v50 offset:18432
    ds_read_b64_tr_b16 a[94:95], v50 offset:19456
    ds_read_b64_tr_b16 a[204:205], v51 offset:18432
    ds_read_b64_tr_b16 a[206:207], v51 offset:19456
    s_waitcnt vmcnt(16)
    ds_read_b64_tr_b16 a[96:97], v46 offset:0
    ds_read_b64_tr_b16 a[98:99], v46 offset:1024
    ds_read_b64_tr_b16 a[208:209], v47 offset:0
    ds_read_b64_tr_b16 a[210:211], v47 offset:1024
    ds_read_b64_tr_b16 a[100:101], v46 offset:2048
    ds_read_b64_tr_b16 a[102:103], v46 offset:3072
    ds_read_b64_tr_b16 a[212:213], v47 offset:2048
    ds_read_b64_tr_b16 a[214:215], v47 offset:3072
    ds_read_b64_tr_b16 a[104:105], v46 offset:16384
    ds_read_b64_tr_b16 a[106:107], v46 offset:17408
    ds_read_b64_tr_b16 a[216:217], v47 offset:16384
    ds_read_b64_tr_b16 a[218:219], v47 offset:17408
    ds_read_b64_tr_b16 a[108:109], v46 offset:18432
    ds_read_b64_tr_b16 a[110:111], v46 offset:19456
    ds_read_b64_tr_b16 a[220:221], v47 offset:18432
    ds_read_b64_tr_b16 a[222:223], v47 offset:19456
    s_waitcnt lgkmcnt(0)
    s_xor_b32 s96, s72, 0x0
    buffer_load_dwordx4 v[128:131], v1, s[4:7], s96 offen offset:0 sc1
    buffer_load_dwordx4 v[132:135], v1, s[4:7], s96 offen offset:1024 sc1
    buffer_load_dwordx4 v[136:139], v1, s[4:7], s96 offen offset:2048 sc1
    buffer_load_dwordx4 v[140:143], v1, s[4:7], s96 offen offset:3072 sc1
    s_xor_b32 s96, s72, 0x1000
WZ1:
    s_cbranch_execz WZ5
    buffer_load_dwordx4 v[144:147], v1, s[4:7], s96 offen offset:0 sc1
    buffer_load_dwordx4 v[148:151], v1, s[4:7], s96 offen offset:1024 sc1
    s_waitcnt vmcnt(6)
    s_barrier
    ds_read_b128 v[80:83], v4 offset:0
    ds_read_b128 v[84:87], v4 offset:32768
    ds_read_b128 v[88:91], v4 offset:1024
    s_waitcnt vmcnt(5) lgkmcnt(2)
    v_mfma_f32_32x32x16_bf16 v[96:111], v[80:83], v[128:131], 0
    ds_read_b128 v[92:95], v4 offset:33792
    buffer_load_dwordx4 v[152:155], v1, s[4:7], s96 offen offset:2048 sc1
    s_waitcnt lgkmcnt(2)
    v_mfma_f32_32x32x16_bf16 v[112:127], v[84:87], v[128:131], 0
    ds_read_b128 v[80:83], v4 offset:2048
    s_waitcnt vmcnt(5) lgkmcnt(2)
    v_mfma_f32_32x32x16_bf16 v[96:111], v[88:91], v[132:135], v[96:111]
    ds_read_b128 v[84:87], v4 offset:34816
    buffer_load_dwordx4 v[156:159], v1, s[4:7], s96 offen offset:3072 sc1
    s_waitcnt lgkmcnt(2)
    v_mfma_f32_32x32x16_bf16 v[112:127], v[92:95], v[132:135], v[112:127]
    ds_read_b128 v[88:91], v4 offset:3072
    s_waitcnt vmcnt(5) lgkmcnt(2)
    v_mfma_f32_32x32x16_bf16 v[96:111], v[80:83], v[136:139], v[96:111]
    ds_read_b128 v[92:95], v4 offset:35840
    s_xor_b32 s96, s72, 0x2000
    buffer_load_dwordx4 v[160:163], v1, s[4:7], s96 offen offset:0 sc1
    s_waitcnt lgkmcnt(2)
    v_mfma_f32_32x32x16_bf16 v[112:127], v[84:87], v[136:139], v[112:127]
    ds_read_b128 v[80:83], v4 offset:4096
    s_waitcnt vmcnt(5) lgkmcnt(2)
    v_mfma_f32_32x32x16_bf16 v[96:111], v[88:91], v[140:143], v[96:111]
    ds_read_b128 v[84:87], v4 offset:36864
    buffer_load_dwordx4 v[164:167], v1, s[4:7], s96 offen offset:1024 sc1
    s_waitcnt lgkmcnt(2)
    v_mfma_f32_32x32x16_bf16 v[112:127], v[92:95], v[140:143], v[112:127]
    ds_read_b128 v[88:91], v4 offset:5120
    s_waitcnt vmcnt(5) lgkmcnt(2)
    v_mfma_f32_32x32x16_bf16 v[96:111], v[80:83], v[144:147], v[96:111]
    ds_read_b128 v[92:95], v4 offset:37888
    buffer_load_dwordx4 v[168:171], v1, s[4:7], s96 offen offset:2048 sc1
    s_waitcnt lgkmcnt(2)
    v_mfma_f32_32x32x16_bf16 v[112:127], v[84:87], v[144:147], v[112:127]
    ds_read_b128 v[80:83], v4 offset:6144
    s_waitcnt vmcnt(5) lgkmcnt(2)
    v_mfma_f32_32x32x16_bf16 v[96:111], v[88:91], v[148:151], v[96:111]
    ds_read_b128 v[84:87], v4 offset:38912
    buffer_load_dwordx4 v[172:175], v1, s[4:7], s96 offen offset:3072 sc1
    s_waitcnt lgkmcnt(2)
    v_mfma_f32_32x32x16_bf16 v[112:127], v[92:95], v[148:151], v[112:127]
    ds_read_b128 v[88:91], v4 offset:7168
    s_waitcnt vmcnt(5) lgkmcnt(2)
    v_mfma_f32_32x32x16_bf16 v[96:111], v[80:83], v[152:155], v[96:111]
    ds_read_b128 v[92:95], v4 offset:39936
    s_xor_b32 s96, s72, 0x3000
    buffer_load_dwordx4 v[176:179], v1, s[4:7], s96 offen offset:0 sc1
    s_waitcnt lgkmcnt(2)
    v_mfma_f32_32x32x16_bf16 v[112:127], v[84:87], v[152:155], v[112:127]
    ds_read_b128 v[80:83], v4 offset:8192
    s_waitcnt vmcnt(5) lgkmcnt(2)
    v_mfma_f32_32x32x16_bf16 v[96:111], v[88:91], v[156:159], v[96:111]
    ds_read_b128 v[84:87], v4 offset:40960
    buffer_load_dwordx4 v[180:183], v1, s[4:7], s96 offen offset:1024 sc1
    s_waitcnt lgkmcnt(2)
    v_mfma_f32_32x32x16_bf16 v[112:127], v[92:95], v[156:159], v[112:127]
    ds_read_b128 v[88:91], v4 offset:9216
    s_waitcnt vmcnt(5) lgkmcnt(2)
    v_mfma_f32_32x32x16_bf16 v[96:111], v[80:83], v[160:163], v[96:111]
    ds_read_b128 v[92:95], v4 offset:41984
    buffer_load_dwordx4 v[184:187], v1, s[4:7], s96 offen offset:2048 sc1
    s_waitcnt lgkmcnt(2)
    v_mfma_f32_32x32x16_bf16 v[112:127], v[84:87], v[160:163], v[112:127]
    ds_read_b128 v[80:83], v4 offset:10240
    s_waitcnt vmcnt(5) lgkmcnt(2)
    v_mfma_f32_32x32x16_bf16 v[96:111], v[88:91], v[164:167], v[96:111]
    ds_read_b128 v[84:87], v4 offset:43008
    buffer_load_dwordx4 v[188:191], v1, s[4:7], s96 offen offset:3072 sc1
    s_waitcnt lgkmcnt(2)
    v_mfma_f32_32x32x16_bf16 v[112:127], v[92:95], v[164:167], v[112:127]
    ds_read_b128 v[88:91], v4 offset:11264
    s_waitcnt vmcnt(5) lgkmcnt(2)
    v_mfma_f32_32x32x16_bf16 v[96:111], v[80:83], v[168:171], v[96:111]
    ds_read_b128 v[92:95], v4 offset:44032
    s_xor_b32 s96, s72, 0x4000
    buffer_load_dwordx4 v[192:195], v1, s[4:7], s96 offen offset:0 sc1
    v_mfma_f32_32x32x16_bf16 v[48:63], a[248:251], a[252:255], 0
    s_waitcnt lgkmcnt(2)
    v_mfma_f32_32x32x16_bf16 v[112:127], v[84:87], v[168:171], v[112:127]
    ds_read_b128 v[80:83], v4 offset:12288
    s_waitcnt vmcnt(5) lgkmcnt(2)
    v_mfma_f32_32x32x16_bf16 v[96:111], v[88:91], v[172:175], v[96:111]
    ds_read_b128 v[84:87], v4 offset:45056
    buffer_load_dwordx4 v[196:199], v1, s[4:7], s96 offen offset:1024 sc1
    s_waitcnt lgkmcnt(2)
    v_mfma_f32_32x32x16_bf16 v[112:127], v[92:95], v[172:175], v[112:127]
    ds_read_b128 v[88:91], v4 offset:13312
    s_waitcnt vmcnt(5) lgkmcnt(2)
    v_mfma_f32_32x32x16_bf16 v[96:111], v[80:83], v[176:179], v[96:111]
    ds_read_b128 v[92:95], v4 offset:46080
    buffer_load_dwordx4 v[200:203], v1, s[4:7], s96 offen offset:2048 sc1
    s_waitcnt lgkmcnt(2)
    v_mfma_f32_32x32x16_bf16 v[112:127], v[84:87], v[176:179], v[112:127]
    ds_read_b128 v[80:83], v4 offset:14336
    s_waitcnt vmcnt(5) lgkmcnt(2)
    v_mfma_f32_32x32x16_bf16 v[96:111], v[88:91], v[180:183], v[96:111]
    ds_read_b128 v[84:87], v4 offset:47104
    buffer_load_dwordx4 v[204:207], v1, s[4:7], s96 offen offset:3072 sc1
    s_waitcnt lgkmcnt(2)
    v_mfma_f32_32x32x16_bf16 v[112:127], v[92:95], v[180:183], v[112:127]
    ds_read_b128 v[88:91], v4 offset:15360
    s_waitcnt vmcnt(5) lgkmcnt(2)
    v_mfma_f32_32x32x16_bf16 v[96:111], v[80:83], v[184:187], v[96:111]
    ds_read_b128 v[92:95], v4 offset:48128
    s_xor_b32 s96, s72, 0x5000
    buffer_load_dwordx4 v[208:211], v1, s[4:7], s96 offen offset:0 sc1
    v_mfma_f32_32x32x16_bf16 v[64:79], a[248:251], a[252:255], 0
    s_waitcnt lgkmcnt(2)
    v_mfma_f32_32x32x16_bf16 v[112:127], v[84:87], v[184:187], v[112:127]
    ds_read_b128 v[80:83], v4 offset:16384
    buffer_load_dwordx4 v[16:19], v1, s[4:7], s73 offen offset:0 sc1
    s_waitcnt vmcnt(6) lgkmcnt(2)
    v_mfma_f32_32x32x16_bf16 v[96:111], v[88:91], v[188:191], v[96:111]
    ds_read_b128 v[84:87], v4 offset:49152
    buffer_load_dwordx4 v[212:215], v1, s[4:7], s96 offen offset:1024 sc1
    s_waitcnt lgkmcnt(2)
    v_mfma_f32_32x32x16_bf16 v[112:127], v[92:95], v[188:191], v[112:127]
    ds_read_b128 v[88:91], v4 offset:17408
    s_waitcnt vmcnt(6) lgkmcnt(2)
    v_mfma_f32_32x32x16_bf16 v[96:111], v[80:83], v[192:195], v[96:111]
    ds_read_b128 v[92:95], v4 offset:50176
    buffer_load_dwordx4 v[216:219], v1, s[4:7], s96 offen offset:2048 sc1
    s_waitcnt lgkmcnt(2)
    v_mfma_f32_32x32x16_bf16 v[112:127], v[84:87], v[192:195], v[112:127]
    ds_read_b128 v[80:83], v4 offset:18432
    buffer_load_dwordx4 v[20:23], v1, s[4:7], s73 offen offset:1024 sc1
    s_waitcnt vmcnt(7) lgkmcnt(2)
    v_mfma_f32_32x32x16_bf16 v[96:111], v[88:91], v[196:199], v[96:111]
    ds_read_b128 v[84:87], v4 offset:51200
    buffer_load_dwordx4 v[220:223], v1, s[4:7], s96 offen offset:3072 sc1
    s_waitcnt lgkmcnt(2)
    v_mfma_f32_32x32x16_bf16 v[112:127], v[92:95], v[196:199], v[112:127]
    ds_read_b128 v[88:91], v4 offset:19456
    s_waitcnt vmcnt(7) lgkmcnt(2)
    v_mfma_f32_32x32x16_bf16 v[96:111], v[80:83], v[200:203], v[96:111]
    ds_read_b128 v[92:95], v4 offset:52224
    s_xor_b32 s96, s72, 0x6000
    buffer_load_dwordx4 v[224:227], v1, s[4:7], s96 offen offset:0 sc1
    s_waitcnt lgkmcnt(2)
    v_mfma_f32_32x32x16_bf16 v[112:127], v[84:87], v[200:203], v[112:127]
    ds_read_b128 v[80:83], v4 offset:20480
    buffer_load_dwordx4 v[24:27], v1, s[4:7], s73 offen offset:2048 sc1
    s_waitcnt vmcnt(8) lgkmcnt(2)
    v_mfma_f32_32x32x16_bf16 v[96:111], v[88:91], v[204:207], v[96:111]
    ds_read_b128 v[84:87], v4 offset:53248
    buffer_load_dwordx4 v[228:231], v1, s[4:7], s96 offen offset:1024 sc1
    s_waitcnt lgkmcnt(2)
    v_mfma_f32_32x32x16_bf16 v[112:127], v[92:95], v[204:207], v[112:127]
    ds_read_b128 v[88:91], v4 offset:21504
    s_waitcnt vmcnt(8) lgkmcnt(2)
    v_mfma_f32_32x32x16_bf16 v[96:111], v[80:83], v[208:211], v[96:111]
    ds_read_b128 v[92:95], v4 offset:54272
    buffer_load_dwordx4 v[232:235], v1, s[4:7], s96 offen offset:2048 sc1
    s_waitcnt lgkmcnt(2)
    v_mfma_f32_32x32x16_bf16 v[112:127], v[84:87], v[208:211], v[112:127]
    ds_read_b128 v[80:83], v4 offset:22528
    buffer_load_dwordx4 v[28:31], v1, s[4:7], s73 offen offset:3072 sc1
    s_waitcnt vmcnt(8) lgkmcnt(2)
    v_mfma_f32_32x32x16_bf16 v[96:111], v[88:91], v[212:215], v[96:111]
    ds_read_b128 v[84:87], v4 offset:55296
    buffer_load_dwordx4 v[236:239], v1, s[4:7], s96 offen offset:3072 sc1
    s_waitcnt lgkmcnt(2)
    v_mfma_f32_32x32x16_bf16 v[112:127], v[92:95], v[212:215], v[112:127]
    ds_read_b128 v[88:91], v4 offset:23552
    s_waitcnt vmcnt(8) lgkmcnt(2)
    v_mfma_f32_32x32x16_bf16 v[96:111], v[80:83], v[216:219], v[96:111]
    ds_read_b128 v[92:95], v4 offset:56320
    s_xor_b32 s96, s72, 0x7000
    buffer_load_dwordx4 v[240:243], v1, s[4:7], s96 offen offset:0 sc1
    s_waitcnt lgkmcnt(2)
    v_mfma_f32_32x32x16_bf16 v[112:127], v[84:87], v[216:219], v[112:127]
    ds_read_b128 v[80:83], v4 offset:24576
    s_waitcnt vmcnt(7) lgkmcnt(2)
    v_mfma_f32_32x32x16_bf16 v[96:111], v[88:91], v[220:223], v[96:111]
    ds_read_b128 v[84:87], v4 offset:57344
    buffer_load_dwordx4 v[244:247], v1, s[4:7], s96 offen offset:1024 sc1
    s_waitcnt lgkmcnt(2)
    v_mfma_f32_32x32x16_bf16 v[112:127], v[92:95], v[220:223], v[112:127]
    ds_read_b128 v[88:91], v4 offset:25600
    s_waitcnt vmcnt(7) lgkmcnt(2)
    v_mfma_f32_32x32x16_bf16 v[96:111], v[80:83], v[224:227], v[96:111]
    ds_read_b128 v[92:95], v4 offset:58368
    buffer_load_dwordx4 v[248:251], v1, s[4:7], s96 offen offset:2048 sc1
    s_waitcnt lgkmcnt(2)
    v_mfma_f32_32x32x16_bf16 v[112:127], v[84:87], v[224:227], v[112:127]
    ds_read_b128 v[80:83], v4 offset:26624
    s_waitcnt vmcnt(6) lgkmcnt(2)
    v_mfma_f32_32x32x16_bf16 v[96:111], v[88:91], v[228:231], v[96:111]
    ds_read_b128 v[84:87], v4 offset:59392
    buffer_load_dwordx4 v[252:255], v1, s[4:7], s96 offen offset:3072 sc1
    s_waitcnt lgkmcnt(2)
    v_mfma_f32_32x32x16_bf16 v[112:127], v[92:95], v[228:231], v[112:127]
    ds_read_b128 v[88:91], v4 offset:27648
    s_waitcnt vmcnt(6) lgkmcnt(2)
    v_mfma_f32_32x32x16_bf16 v[96:111], v[80:83], v[232:235], v[96:111]
    ds_read_b128 v[92:95], v4 offset:60416
    s_add_u32 s97, s79, 0x10000
    s_add_u32 m0, s41, 0x0
    s_nop 0
    buffer_load_dwordx4 v1, s[4:7], s97 offen offset:0 sc1  lds
    s_waitcnt lgkmcnt(2)
    v_mfma_f32_32x32x16_bf16 v[112:127], v[84:87], v[232:235], v[112:127]
    ds_read_b128 v[80:83], v4 offset:28672
    s_waitcnt vmcnt(6)
    v_add_f32 v16, v16, v24
    v_add_f32 v17, v17, v25
    v_add_f32 v18, v18, v26
    s_waitcnt vmcnt(5) lgkmcnt(2)
    v_mfma_f32_32x32x16_bf16 v[96:111], v[88:91], v[236:239], v[96:111]
    ds_read_b128 v[84:87], v4 offset:61440
    v_add_f32 v19, v19, v27
    v_add_f32 v20, v20, v28
    buffer_load_dwordx4 v1, s[4:7], s97 offen offset:1024 sc1  lds
    s_waitcnt lgkmcnt(2)
    v_mfma_f32_32x32x16_bf16 v[112:127], v[92:95], v[236:239], v[112:127]
    ds_read_b128 v[88:91], v4 offset:29696
    v_add_f32 v21, v21, v29
    v_add_f32 v22, v22, v30
    v_add_f32 v23, v23, v31
    s_waitcnt vmcnt(5) lgkmcnt(2)
    v_mfma_f32_32x32x16_bf16 v[96:111], v[80:83], v[240:243], v[96:111]
    ds_read_b128 v[92:95], v4 offset:62464
    v_add_f32 v16, v16, v20
    v_add_f32 v17, v17, v21
    buffer_load_dwordx4 v1, s[4:7], s97 offen offset:2048 sc1  lds
    s_waitcnt lgkmcnt(2)
    v_mfma_f32_32x32x16_bf16 v[112:127], v[84:87], v[240:243], v[112:127]
    ds_read_b128 v[80:83], v4 offset:30720
    v_add_f32 v18, v18, v22
    v_add_f32 v19, v19, v23
    s_nop 0
    v_permlane32_swap_b32 v16, v18
    s_waitcnt vmcnt(5) lgkmcnt(2)
    v_mfma_f32_32x32x16_bf16 v[96:111], v[88:91], v[244:247], v[96:111]
    ds_read_b128 v[84:87], v4 offset:63488
    v_permlane32_swap_b32 v17, v19
    v_add_f32 v16, v16, v18
    buffer_load_dwordx4 v1, s[4:7], s97 offen offset:3072 sc1  lds
    s_waitcnt lgkmcnt(2)
    v_mfma_f32_32x32x16_bf16 v[112:127], v[92:95], v[244:247], v[112:127]
    ds_read_b128 v[88:91], v4 offset:31744
    v_add_f32 v17, v17, v19
    s_nop 1
    v_permlane16_swap_b32 v16, v17
    v_add_f32 v16, v16, v17
    s_waitcnt vmcnt(5) lgkmcnt(2)
    v_mfma_f32_32x32x16_bf16 v[96:111], v[80:83], v[248:251], v[96:111]
    ds_read_b128 v[92:95], v4 offset:64512
    v_mul_f32 v16, 0x3b000000, v16
    v_mov_b32 v17, v16
    s_add_u32 s97, s48, 0x10000
    s_add_u32 m0, s41, 0x4000
    s_nop 0
    buffer_load_dwordx4 v1, s[4:7], s97 offen offset:0 sc1  lds
    s_waitcnt lgkmcnt(2)
    v_mfma_f32_32x32x16_bf16 v[112:127], v[84:87], v[248:251], v[112:127]
    v_permlane32_swap_b32 v16, v17
    v_fma_f32 v17, -v16, v16, v17
    v_max_f32 v17, 0, v17
    s_waitcnt vmcnt(5) lgkmcnt(1)
    v_mfma_f32_32x32x16_bf16 v[96:111], v[88:91], v[252:255], v[96:111]
    v_add_f32 v17, 0x3727c5ac, v17
    v_rsq_f32 v6, v17
    buffer_load_dwordx4 v1, s[4:7], s97 offen offset:1024 sc1  lds
    s_waitcnt lgkmcnt(0)
    v_mfma_f32_32x32x16_bf16 v[112:127], v[92:95], v[252:255], v[112:127]
    s_barrier
    v_mov_b32 v16, -1
    v_mov_b32 v17, -1
    v_mov_b32 v18, -1
    v_mov_b32 v19, -1
    s_mov_b64 exec, s[56:57]
    buffer_store_dwordx4 v[16:19], v1, s[4:7], s51 offen offset:0 sc1
    s_mov_b64 exec, -1
    v_mul_f32 v14, 0x3fb8aa3b, v6
    buffer_load_dwordx4 v1, s[4:7], s97 offen offset:2048 sc1  lds
    v_max3_f32 v8, v96, v97, v98
    v_max3_f32 v9, v104, v105, v106
    v_max3_f32 v8, v8, v99, v100
    v_max3_f32 v9, v9, v107, v108
    v_max3_f32 v8, v8, v101, v102
    v_max3_f32 v9, v9, v109, v110
    v_max_f32 v8, v8, v103
    v_max_f32 v9, v9, v111
    v_min3_f32 v10, v96, v97, v98
    v_min3_f32 v11, v104, v105, v106
    v_min3_f32 v10, v10, v99, v100
    v_min3_f32 v11, v11, v107, v108
    v_min3_f32 v10, v10, v101, v102
    v_min3_f32 v11, v11, v109, v110
    v_min_f32 v10, v10, v103
    v_min_f32 v11, v11, v111
    v_pk_mul_f32 v[112:113], v[112:113], v[6:7] op_sel_hi:[1,0]
    v_pk_mul_f32 v[114:115], v[114:115], v[6:7] op_sel_hi:[1,0]
    v_pk_mul_f32 v[116:117], v[116:117], v[6:7] op_sel_hi:[1,0]
    buffer_load_dwordx4 v1, s[4:7], s97 offen offset:3072 sc1  lds
    v_pk_mul_f32 v[118:119], v[118:119], v[6:7] op_sel_hi:[1,0]
    v_pk_mul_f32 v[120:121], v[120:121], v[6:7] op_sel_hi:[1,0]
    v_pk_mul_f32 v[122:123], v[122:123], v[6:7] op_sel_hi:[1,0]
    v_pk_mul_f32 v[124:125], v[124:125], v[6:7] op_sel_hi:[1,0]
    v_pk_mul_f32 v[126:127], v[126:127], v[6:7] op_sel_hi:[1,0]
    v_cvt_pk_bf16_f32 v112, v112, v113
    v_cvt_pk_bf16_f32 v113, v114, v115
    v_cvt_pk_bf16_f32 v114, v116, v117
    v_cvt_pk_bf16_f32 v115, v118, v119
    v_cvt_pk_bf16_f32 v116, v120, v121
    v_cvt_pk_bf16_f32 v117, v122, v123
    v_mfma_f32_32x32x16_bf16 v[48:63], v[112:115], a[240:243], v[48:63]
    v_cvt_pk_bf16_f32 v118, v124, v125
    v_cvt_pk_bf16_f32 v119, v126, v127
    v_permlane32_swap_b32 v8, v9
    v_permlane32_swap_b32 v10, v11
    v_max_f32 v8, v8, v9
    v_min_f32 v10, v10, v11
    s_add_u32 s97, s80, 0x0
    s_add_u32 m0, s83, 0x0
    s_nop 0
    buffer_load_dwordx4 v1, s[4:7], s97 offen offset:0 sc1  lds
    v_mul_f32 v8, v8, v14
    v_mul_f32 v10, v10, v14
    v_mfma_f32_32x32x16_bf16 v[64:79], v[116:119], a[240:243], v[64:79]
    v_mov_b32 v9, v8
    v_mov_b32 v11, v10
    s_nop 0
    v_permlane32_swap_b32 v8, v9
    v_permlane32_swap_b32 v10, v11
    v_fma_f32 v16, v96, v14, -v8
    v_fma_f32 v17, v97, v14, -v8
    v_fma_f32 v18, v98, v14, -v8
    v_fma_f32 v19, v99, v14, -v8
    v_fma_f32 v20, v100, v14, -v8
    v_fma_f32 v21, v101, v14, -v8
    v_fma_f32 v22, v102, v14, -v8
    v_fma_f32 v23, v103, v14, -v8
    v_fma_f32 v24, -v96, v14, v10
    v_fma_f32 v25, -v97, v14, v10
    buffer_load_dwordx4 v1, s[4:7], s97 offen offset:1024 sc1  lds
    v_fma_f32 v26, -v98, v14, v10
    v_fma_f32 v27, -v99, v14, v10
    v_fma_f32 v28, -v100, v14, v10
    v_cvt_pk_bf16_f32 v80, v48, v49
    v_cvt_pk_bf16_f32 v81, v50, v51
    v_cvt_pk_bf16_f32 v82, v52, v53
    v_cvt_pk_bf16_f32 v83, v54, v55
    v_cvt_pk_bf16_f32 v84, v56, v57
    v_cvt_pk_bf16_f32 v85, v58, v59
    v_cvt_pk_bf16_f32 v86, v60, v61
    v_cvt_pk_bf16_f32 v87, v62, v63
    v_fma_f32 v29, -v101, v14, v10
    v_fma_f32 v30, -v102, v14, v10
    v_fma_f32 v31, -v103, v14, v10
    v_fma_f32 v32, v104, v14, -v9
    v_fma_f32 v33, v105, v14, -v9
    v_fma_f32 v34, v106, v14, -v9
    v_fma_f32 v35, v107, v14, -v9
    v_fma_f32 v36, v108, v14, -v9
    buffer_load_dwordx4 v1, s[4:7], s97 offen offset:2048 sc1  lds
    v_fma_f32 v37, v109, v14, -v9
    v_fma_f32 v38, v110, v14, -v9
    v_cvt_pk_bf16_f32 v88, v64, v65
    v_cvt_pk_bf16_f32 v89, v66, v67
    v_cvt_pk_bf16_f32 v90, v68, v69
    v_cvt_pk_bf16_f32 v91, v70, v71
    v_cvt_pk_bf16_f32 v92, v72, v73
    v_cvt_pk_bf16_f32 v93, v74, v75
    v_cvt_pk_bf16_f32 v94, v76, v77
    v_cvt_pk_bf16_f32 v95, v78, v79
    v_fma_f32 v39, v111, v14, -v9
    v_fma_f32 v40, -v104, v14, v11
    v_fma_f32 v41, -v105, v14, v11
    v_fma_f32 v42, -v106, v14, v11
    v_fma_f32 v43, -v107, v14, v11
    v_fma_f32 v44, -v108, v14, v11
    v_fma_f32 v45, -v109, v14, v11
    v_fma_f32 v46, -v110, v14, v11
    v_fma_f32 v47, -v111, v14, v11
    buffer_load_dwordx4 v1, s[4:7], s97 offen offset:3072 sc1  lds
    v_exp_f32 v16, v16
    v_exp_f32 v17, v17
    v_exp_f32 v18, v18
    v_exp_f32 v19, v19
    v_exp_f32 v20, v20
    s_add_u32 s97, s80, 0x8000
    s_add_u32 m0, s83, 0x8000
    s_nop 0
    buffer_load_dwordx4 v1, s[4:7], s97 offen offset:0 sc1  lds
    v_exp_f32 v21, v21
    v_exp_f32 v22, v22
    v_exp_f32 v23, v23
    v_exp_f32 v24, v24
    v_exp_f32 v25, v25
    buffer_load_dwordx4 v1, s[4:7], s97 offen offset:1024 sc1  lds
    v_exp_f32 v26, v26
    v_exp_f32 v27, v27
    v_exp_f32 v28, v28
    v_exp_f32 v29, v29
    v_exp_f32 v30, v30
    buffer_load_dwordx4 v1, s[4:7], s97 offen offset:2048 sc1  lds
    v_exp_f32 v31, v31
    v_exp_f32 v32, v32
    v_exp_f32 v33, v33
    v_exp_f32 v34, v34
    v_exp_f32 v35, v35
    buffer_load_dwordx4 v1, s[4:7], s97 offen offset:3072 sc1  lds
    v_exp_f32 v36, v36
    v_exp_f32 v37, v37
    v_exp_f32 v38, v38
    v_exp_f32 v39, v39
    v_exp_f32 v40, v40
    s_add_u32 s97, s49, 0x0
    s_add_u32 m0, s83, 0x4000
    s_nop 0
    buffer_load_dwordx4 v1, s[4:7], s97 offen offset:0 sc1  lds
    v_exp_f32 v41, v41
    v_exp_f32 v42, v42
    v_exp_f32 v43, v43
    v_exp_f32 v44, v44
    v_exp_f32 v45, v45
    buffer_load_dwordx4 v1, s[4:7], s97 offen offset:1024 sc1  lds
    v_exp_f32 v46, v46
    v_exp_f32 v47, v47
    v_pk_add_f32 v[96:97], v[16:17], v[18:19]
    v_pk_add_f32 v[98:99], v[20:21], v[22:23]
    v_pk_add_f32 v[100:101], v[24:25], v[26:27]
    v_pk_add_f32 v[102:103], v[28:29], v[30:31]
    v_pk_add_f32 v[104:105], v[32:33], v[34:35]
    v_pk_add_f32 v[106:107], v[36:37], v[38:39]
    v_pk_add_f32 v[108:109], v[40:41], v[42:43]
    v_pk_add_f32 v[110:111], v[44:45], v[46:47]
    v_pk_add_f32 v[96:97], v[96:97], v[98:99]
    v_pk_add_f32 v[100:101], v[100:101], v[102:103]
    v_pk_add_f32 v[104:105], v[104:105], v[106:107]
    buffer_load_dwordx4 v1, s[4:7], s97 offen offset:2048 sc1  lds
    v_pk_add_f32 v[108:109], v[108:109], v[110:111]
    v_add_f32 v8, v96, v97
    v_add_f32 v9, v104, v105
    v_add_f32 v10, v100, v101
    v_add_f32 v11, v108, v109
    v_permlane32_swap_b32 v8, v9
    s_nop 0
    v_permlane32_swap_b32 v10, v11
    v_add_f32 v8, v8, v9
    v_add_f32 v10, v10, v11
    v_rcp_f32 v8, v8
    v_rcp_f32 v10, v10
    v_mov_b32 v9, v8
    v_mov_b32 v11, v10
    buffer_load_dwordx4 v1, s[4:7], s97 offen offset:3072 sc1  lds
    s_nop 0
    v_permlane32_swap_b32 v8, v9
    v_permlane32_swap_b32 v10, v11
    v_pk_mul_f32 v[16:17], v[16:17], v[8:9] op_sel:[0,0] op_sel_hi:[1,0]
    v_pk_mul_f32 v[18:19], v[18:19], v[8:9] op_sel:[0,0] op_sel_hi:[1,0]
    v_pk_mul_f32 v[20:21], v[20:21], v[8:9] op_sel:[0,0] op_sel_hi:[1,0]
    v_pk_mul_f32 v[22:23], v[22:23], v[8:9] op_sel:[0,0] op_sel_hi:[1,0]
    v_pk_mul_f32 v[24:25], v[24:25], v[10:11] op_sel:[0,0] op_sel_hi:[1,0]
    v_pk_mul_f32 v[26:27], v[26:27], v[10:11] op_sel:[0,0] op_sel_hi:[1,0]
    v_pk_mul_f32 v[28:29], v[28:29], v[10:11] op_sel:[0,0] op_sel_hi:[1,0]
    v_pk_mul_f32 v[30:31], v[30:31], v[10:11] op_sel:[0,0] op_sel_hi:[1,0]
    v_pk_mul_f32 v[32:33], v[32:33], v[8:9] op_sel:[0,1] op_sel_hi:[1,1]
    v_pk_mul_f32 v[34:35], v[34:35], v[8:9] op_sel:[0,1] op_sel_hi:[1,1]
    v_pk_mul_f32 v[36:37], v[36:37], v[8:9] op_sel:[0,1] op_sel_hi:[1,1]
    v_pk_mul_f32 v[38:39], v[38:39], v[8:9] op_sel:[0,1] op_sel_hi:[1,1]
    v_pk_mul_f32 v[40:41], v[40:41], v[10:11] op_sel:[0,1] op_sel_hi:[1,1]
    v_pk_mul_f32 v[42:43], v[42:43], v[10:11] op_sel:[0,1] op_sel_hi:[1,1]
    v_pk_mul_f32 v[44:45], v[44:45], v[10:11] op_sel:[0,1] op_sel_hi:[1,1]
    v_pk_mul_f32 v[46:47], v[46:47], v[10:11] op_sel:[0,1] op_sel_hi:[1,1]
    s_add_u32 s97, s49, 0x8000
    s_add_u32 m0, s83, 0xc000
    s_nop 0
    buffer_load_dwordx4 v1, s[4:7], s97 offen offset:0 sc1  lds
    v_cvt_pk_bf16_f32 v112, v16, v17
    v_cvt_pk_bf16_f32 v113, v18, v19
    v_cvt_pk_bf16_f32 v114, v20, v21
    v_cvt_pk_bf16_f32 v115, v22, v23
    v_cvt_pk_bf16_f32 v116, v24, v25
    v_cvt_pk_bf16_f32 v117, v26, v27
    v_mfma_f32_32x32x16_bf16 v[48:63], v[112:115], a[240:243], 0
    v_cvt_pk_bf16_f32 v118, v28, v29
    v_cvt_pk_bf16_f32 v119, v30, v31
    v_cvt_pk_bf16_f32 v120, v32, v33
    v_cvt_pk_bf16_f32 v121, v34, v35
    v_mfma_f32_32x32x16_bf16 v[48:63], v[116:119], a[244:247], v[48:63]
    v_cvt_pk_bf16_f32 v122, v36, v37
    v_cvt_pk_bf16_f32 v123, v38, v39
    v_cvt_pk_bf16_f32 v124, v40, v41
    v_cvt_pk_bf16_f32 v125, v42, v43
    v_mfma_f32_32x32x16_bf16 v[64:79], v[120:123], a[240:243], 0
    buffer_load_dwordx4 v1, s[4:7], s97 offen offset:1024 sc1  lds
    v_cvt_pk_bf16_f32 v126, v44, v45
    v_cvt_pk_bf16_f32 v127, v46, v47
    v_add_u32 v8, s84, v1
    s_mul_i32 s33, s30, -3584
    s_add_u32 s33, s33, s84
    v_add_u32 v9, s33, v2
    v_mfma_f32_32x32x16_bf16 v[64:79], v[124:127], a[244:247], v[64:79]
    v_cvt_pk_bf16_f32 v96, v48, v49
    v_cvt_pk_bf16_f32 v97, v50, v51
    v_cvt_pk_bf16_f32 v98, v52, v53
    v_cvt_pk_bf16_f32 v99, v54, v55
    v_cvt_pk_bf16_f32 v100, v56, v57
    v_cvt_pk_bf16_f32 v101, v58, v59
    v_mfma_f32_32x32x16_bf16 v[16:31], v[80:83], v[96:99], 0
    v_cvt_pk_bf16_f32 v102, v60, v61
    v_cvt_pk_bf16_f32 v103, v62, v63
    s_nop 1
    v_mfma_f32_32x32x16_bf16 v[16:31], v[84:87], v[100:103], v[16:31]
    buffer_load_dwordx4 v1, s[4:7], s97 offen offset:2048 sc1  lds
    v_cvt_pk_bf16_f32 v104, v64, v65
    v_cvt_pk_bf16_f32 v105, v66, v67
    v_cvt_pk_bf16_f32 v106, v68, v69
    v_cvt_pk_bf16_f32 v107, v70, v71
    v_cvt_pk_bf16_f32 v108, v72, v73
    v_cvt_pk_bf16_f32 v109, v74, v75
    v_mfma_f32_32x32x16_bf16 v[32:47], v[88:91], v[104:107], 0
    v_cvt_pk_bf16_f32 v110, v76, v77
    v_cvt_pk_bf16_f32 v111, v78, v79
    s_nop 1
    v_mfma_f32_32x32x16_bf16 v[32:47], v[92:95], v[108:111], v[32:47]
    ds_write_b128 v8, v[16:19] offset:0
    ds_write_b128 v8, v[20:23] offset:1024
    ds_write_b32 v9, v24 offset:16384
    s_nop 8
    ds_write_b128 v8, v[32:35] offset:2048
    ds_write_b128 v8, v[36:39] offset:3072
    ds_write_b32 v9, v40 offset:16640
    s_waitcnt vmcnt(17)
    s_waitcnt vmcnt(15) lgkmcnt(0)
    s_barrier
    s_cmp_ge_u32 s30, 2
    s_cbranch_scc1 KV_Z0
    s_lshl_b32 s33, s30, 11
    v_add_u32 v8, s33, v4
    ds_read_b128 v[48:51], v8 offset:0
    ds_read_b128 v[52:55], v8 offset:1024
    ds_read_b128 v[56:59], v8 offset:4096
    ds_read_b128 v[60:63], v8 offset:5120
    ds_read_b128 v[64:67], v8 offset:8192
    ds_read_b128 v[68:71], v8 offset:9216
    ds_read_b128 v[72:75], v8 offset:12288
    ds_read_b128 v[76:79], v8 offset:13312
    s_waitcnt lgkmcnt(4)
    v_pk_add_f32 v[48:49], v[48:49], v[56:57]
    v_pk_add_f32 v[50:51], v[50:51], v[58:59]
    v_pk_add_f32 v[52:53], v[52:53], v[60:61]
    v_pk_add_f32 v[54:55], v[54:55], v[62:63]
    s_waitcnt lgkmcnt(2)
    v_pk_add_f32 v[48:49], v[48:49], v[64:65]
    v_pk_add_f32 v[50:51], v[50:51], v[66:67]
    v_pk_add_f32 v[52:53], v[52:53], v[68:69]
    v_pk_add_f32 v[54:55], v[54:55], v[70:71]
    s_waitcnt lgkmcnt(0)
    v_pk_add_f32 v[48:49], v[48:49], v[72:73]
    v_pk_add_f32 v[50:51], v[50:51], v[74:75]
    v_pk_add_f32 v[52:53], v[52:53], v[76:77]
    v_pk_add_f32 v[54:55], v[54:55], v[78:79]
    v_cvt_pk_bf16_f32 v56, v48, v49
    v_cvt_pk_bf16_f32 v57, v50, v51
    v_cvt_pk_bf16_f32 v58, v52, v53
    v_cvt_pk_bf16_f32 v59, v54, v55
    buffer_store_dwordx4 v[56:59], v1, s[4:7], s85 offen offset:0 sc1
    s_branch KV_DONE0
KV_Z0:
    s_cmp_eq_u32 s30, 3
    s_cbranch_scc1 KV_DONE0
    v_lshrrev_b32 v8, 5, v0
    v_lshlrev_b32 v8, 7, v8
    v_add_u32 v8, v8, v2
    v_add_u32 v8, s84, v8
    ds_read_b32 v48, v8 offset:8192
    ds_read_b32 v49, v8 offset:8704
    ds_read_b32 v50, v8 offset:9216
    ds_read_b32 v51, v8 offset:9728
    s_waitcnt lgkmcnt(0)
    v_add_f32 v48, v48, v49
    v_add_f32 v50, v50, v51
    v_add_f32 v48, v48, v50
    v_cvt_pk_bf16_f32 v49, v48, v48
    v_lshlrev_b32 v49, 16, v49
    v_sub_f32 v49, v48, v49
    v_cvt_pk_bf16_f32 v48, v48, v49
    buffer_store_dword v48, v2, s[4:7], s87 offen sc1
KV_DONE0:
    ds_read_b128 v[80:83], v5 offset:0
    ds_read_b128 v[84:87], v5 offset:1024
    ds_read_b128 v[88:91], v5 offset:2048
    s_waitcnt lgkmcnt(2)
    v_mfma_f32_32x32x16_bf16 v[96:111], v[80:83], v[128:131], 0
    ds_read_b128 v[92:95], v5 offset:3072
    buffer_load_dwordx4 v1, s[4:7], s97 offen offset:3072 sc1  lds
    s_waitcnt lgkmcnt(2)
    v_mfma_f32_32x32x16_bf16 v[96:111], v[84:87], v[132:135], v[96:111]
    ds_read_b128 v[80:83], v5 offset:4096
    v_lshlrev_b32 v13, 5, v0
    buffer_load_dword v13, v13, s[4:7], s70 offen sc1
    s_waitcnt lgkmcnt(2)
    v_mfma_f32_32x32x16_bf16 v[96:111], v[88:91], v[136:139], v[96:111]
    ds_read_b128 v[84:87], v5 offset:5120
    buffer_load_dword v13, v2, s[4:7], s71 offen sc1
    s_waitcnt lgkmcnt(2)
    v_mfma_f32_32x32x16_bf16 v[96:111], v[92:95], v[140:143], v[96:111]
    ds_read_b128 v[88:91], v5 offset:6144
    v_lshlrev_b32 v13, 5, v0
    buffer_load_dword v13, v13, s[4:7], s89 offen sc1
    s_waitcnt lgkmcnt(2)
    v_mfma_f32_32x32x16_bf16 v[96:111], v[80:83], v[144:147], v[96:111]
    ds_read_b128 v[92:95], v5 offset:7168
    s_waitcnt lgkmcnt(2)
    v_mfma_f32_32x32x16_bf16 v[96:111], v[84:87], v[148:151], v[96:111]
    ds_read_b128 v[80:83], v5 offset:8192
WZ2:
    s_cbranch_execz WZ6
    s_waitcnt lgkmcnt(2)
    v_mfma_f32_32x32x16_bf16 v[96:111], v[88:91], v[152:155], v[96:111]
    ds_read_b128 v[84:87], v5 offset:9216
    s_xor_b32 s96, s81, 0x0
    buffer_load_dwordx4 v[128:131], v1, s[4:7], s96 offen offset:0 sc1
    s_waitcnt lgkmcnt(2)
    v_mfma_f32_32x32x16_bf16 v[96:111], v[92:95], v[156:159], v[96:111]
    ds_read_b128 v[88:91], v5 offset:10240
    s_waitcnt lgkmcnt(2)
    v_mfma_f32_32x32x16_bf16 v[96:111], v[80:83], v[160:163], v[96:111]
    ds_read_b128 v[92:95], v5 offset:11264
    s_waitcnt lgkmcnt(2)
    v_mfma_f32_32x32x16_bf16 v[96:111], v[84:87], v[164:167], v[96:111]
    ds_read_b128 v[80:83], v5 offset:12288
    buffer_load_dwordx4 v[132:135], v1, s[4:7], s96 offen offset:1024 sc1
    s_waitcnt lgkmcnt(2)
    v_mfma_f32_32x32x16_bf16 v[96:111], v[88:91], v[168:171], v[96:111]
    ds_read_b128 v[84:87], v5 offset:13312
    s_waitcnt lgkmcnt(2)
    v_mfma_f32_32x32x16_bf16 v[96:111], v[92:95], v[172:175], v[96:111]
    ds_read_b128 v[88:91], v5 offset:14336
    s_waitcnt lgkmcnt(2)
    v_mfma_f32_32x32x16_bf16 v[96:111], v[80:83], v[176:179], v[96:111]
    ds_read_b128 v[92:95], v5 offset:15360
    buffer_load_dwordx4 v[136:139], v1, s[4:7], s96 offen offset:2048 sc1
    s_waitcnt lgkmcnt(2)
    v_mfma_f32_32x32x16_bf16 v[96:111], v[84:87], v[180:183], v[96:111]
    ds_read_b128 v[80:83], v5 offset:16384
    s_waitcnt lgkmcnt(2)
    v_mfma_f32_32x32x16_bf16 v[96:111], v[88:91], v[184:187], v[96:111]
    ds_read_b128 v[84:87], v5 offset:17408
    s_waitcnt lgkmcnt(2)
    v_mfma_f32_32x32x16_bf16 v[96:111], v[92:95], v[188:191], v[96:111]
    ds_read_b128 v[88:91], v5 offset:18432
    buffer_load_dwordx4 v[140:143], v1, s[4:7], s96 offen offset:3072 sc1
    s_waitcnt lgkmcnt(2)
    v_mfma_f32_32x32x16_bf16 v[96:111], v[80:83], v[192:195], v[96:111]
    ds_read_b128 v[92:95], v5 offset:19456
    s_waitcnt lgkmcnt(2)
    v_mfma_f32_32x32x16_bf16 v[96:111], v[84:87], v[196:199], v[96:111]
    ds_read_b128 v[80:83], v5 offset:20480
    s_waitcnt lgkmcnt(2)
    v_mfma_f32_32x32x16_bf16 v[96:111], v[88:91], v[200:203], v[96:111]
    ds_read_b128 v[84:87], v5 offset:21504
    s_xor_b32 s96, s81, 0x1000
    buffer_load_dwordx4 v[144:147], v1, s[4:7], s96 offen offset:0 sc1
    s_waitcnt lgkmcnt(2)
    v_mfma_f32_32x32x16_bf16 v[96:111], v[92:95], v[204:207], v[96:111]
    ds_read_b128 v[88:91], v5 offset:22528
    s_waitcnt lgkmcnt(2)
    v_mfma_f32_32x32x16_bf16 v[96:111], v[80:83], v[208:211], v[96:111]
    ds_read_b128 v[92:95], v5 offset:23552
    s_waitcnt lgkmcnt(2)
    v_mfma_f32_32x32x16_bf16 v[96:111], v[84:87], v[212:215], v[96:111]
    ds_read_b128 v[80:83], v5 offset:24576
    buffer_load_dwordx4 v[148:151], v1, s[4:7], s96 offen offset:1024 sc1
    s_waitcnt lgkmcnt(2)
    v_mfma_f32_32x32x16_bf16 v[96:111], v[88:91], v[216:219], v[96:111]
    ds_read_b128 v[84:87], v5 offset:25600
    s_waitcnt lgkmcnt(2)
    v_mfma_f32_32x32x16_bf16 v[96:111], v[92:95], v[220:223], v[96:111]
    ds_read_b128 v[88:91], v5 offset:26624
    s_waitcnt lgkmcnt(2)
    v_mfma_f32_32x32x16_bf16 v[96:111], v[80:83], v[224:227], v[96:111]
    ds_read_b128 v[92:95], v5 offset:27648
    buffer_load_dwordx4 v[152:155], v1, s[4:7], s96 offen offset:2048 sc1
    s_waitcnt lgkmcnt(2)
    v_mfma_f32_32x32x16_bf16 v[96:111], v[84:87], v[228:231], v[96:111]
    ds_read_b128 v[80:83], v5 offset:28672
    s_waitcnt lgkmcnt(2)
    v_mfma_f32_32x32x16_bf16 v[96:111], v[88:91], v[232:235], v[96:111]
    ds_read_b128 v[84:87], v5 offset:29696
    s_waitcnt lgkmcnt(2)
    v_mfma_f32_32x32x16_bf16 v[96:111], v[92:95], v[236:239], v[96:111]
    ds_read_b128 v[88:91], v5 offset:30720
    buffer_load_dwordx4 v[156:159], v1, s[4:7], s96 offen offset:3072 sc1
    s_waitcnt lgkmcnt(2)
    v_mfma_f32_32x32x16_bf16 v[96:111], v[80:83], v[240:243], v[96:111]
    ds_read_b128 v[92:95], v5 offset:31744
    s_waitcnt lgkmcnt(2)
    v_mfma_f32_32x32x16_bf16 v[96:111], v[84:87], v[244:247], v[96:111]
    s_waitcnt lgkmcnt(1)
    v_mfma_f32_32x32x16_bf16 v[96:111], v[88:91], v[248:251], v[96:111]
    s_waitcnt lgkmcnt(0)
    v_mfma_f32_32x32x16_bf16 v[96:111], v[92:95], v[252:255], v[96:111]
    s_barrier
    v_and_b32 v84, 31, v0
    v_lshlrev_b32 v84, 2, v84
    v_lshrrev_b32 v85, 5, v0
    v_lshl_add_u32 v84, v85, 10, v84
    s_lshl_b32 s33, s30, 11
    s_add_u32 s33, s33, 24576
    v_add_u32 v85, s33, v4
    s_nop 3
    v_max3_f32 v8, v96, v97, v98
    s_add_u32 s33, s31, 1
    v_mov_b32 v7, s33
    s_waitcnt vmcnt(12)
    s_mov_b64 exec, 1
    buffer_store_dword v7, off, s[4:7], s78 sc1
    s_mov_b64 exec, -1
    s_xor_b32 s98, s86, 0x0
    buffer_load_dwordx4 v[48:51], v1, s[4:7], s98 offen offset:0 sc1
    v_max3_f32 v9, v104, v105, v106
    v_max3_f32 v8, v8, v99, v100
    v_max3_f32 v9, v9, v107, v108
    v_max3_f32 v8, v8, v101, v102
    v_max3_f32 v9, v9, v109, v110
    v_max_f32 v8, v8, v103
    v_max_f32 v9, v9, v111
    v_min3_f32 v10, v96, v97, v98
    v_min3_f32 v11, v104, v105, v106
    v_min3_f32 v10, v10, v99, v100
    v_min3_f32 v11, v11, v107, v108
    v_min3_f32 v10, v10, v101, v102
    v_min3_f32 v11, v11, v109, v110
    v_min_f32 v10, v10, v103
    v_min_f32 v11, v11, v111
    v_permlane32_swap_b32 v8, v9
    buffer_load_dwordx4 v[52:55], v1, s[4:7], s98 offen offset:1024 sc1
    v_permlane32_swap_b32 v10, v11
    v_max_f32 v8, v8, v9
    v_min_f32 v10, v10, v11
    v_mul_f32 v8, v8, v14
    v_mul_f32 v10, v10, v14
    v_mov_b32 v9, v8
    v_mov_b32 v11, v10
    s_nop 0
    v_permlane32_swap_b32 v8, v9
    v_permlane32_swap_b32 v10, v11
    v_fma_f32 v16, v96, v14, -v8
    v_fma_f32 v17, v97, v14, -v8
    v_fma_f32 v18, v98, v14, -v8
    v_fma_f32 v19, v99, v14, -v8
    v_fma_f32 v20, v100, v14, -v8
    v_fma_f32 v21, v101, v14, -v8
    buffer_load_dwordx4 v[56:59], v1, s[4:7], s98 offen offset:2048 sc1
    v_fma_f32 v22, v102, v14, -v8
    v_fma_f32 v23, v103, v14, -v8
    v_fma_f32 v24, -v96, v14, v10
    v_fma_f32 v25, -v97, v14, v10
    v_fma_f32 v26, -v98, v14, v10
    v_fma_f32 v27, -v99, v14, v10
    v_fma_f32 v28, -v100, v14, v10
    v_fma_f32 v29, -v101, v14, v10
    v_fma_f32 v30, -v102, v14, v10
    v_fma_f32 v31, -v103, v14, v10
    v_fma_f32 v32, v104, v14, -v9
    v_fma_f32 v33, v105, v14, -v9
    v_fma_f32 v34, v106, v14, -v9
    v_fma_f32 v35, v107, v14, -v9
    v_fma_f32 v36, v108, v14, -v9
    v_fma_f32 v37, v109, v14, -v9
    buffer_load_dwordx4 v[60:63], v1, s[4:7], s98 offen offset:3072 sc1
    v_fma_f32 v38, v110, v14, -v9
    v_fma_f32 v39, v111, v14, -v9
    v_fma_f32 v40, -v104, v14, v11
    v_fma_f32 v41, -v105, v14, v11
    v_fma_f32 v42, -v106, v14, v11
    v_fma_f32 v43, -v107, v14, v11
    v_fma_f32 v44, -v108, v14, v11
    v_fma_f32 v45, -v109, v14, v11
    v_fma_f32 v46, -v110, v14, v11
    v_fma_f32 v47, -v111, v14, v11
    v_exp_f32 v16, v16
    v_exp_f32 v17, v17
    s_xor_b32 s98, s86, 0x1000
    buffer_load_dwordx4 v[64:67], v1, s[4:7], s98 offen offset:0 sc1
    buffer_load_dword v80, v84, s[4:7], s88 offen offset:0 sc1
    v_exp_f32 v18, v18
    v_exp_f32 v19, v19
    v_exp_f32 v20, v20
    v_exp_f32 v21, v21
    buffer_load_dwordx4 v[68:71], v1, s[4:7], s98 offen offset:1024 sc1
    buffer_load_dword v81, v84, s[4:7], s88 offen offset:256 sc1
    v_exp_f32 v22, v22
    v_exp_f32 v23, v23
    v_exp_f32 v24, v24
    v_exp_f32 v25, v25
    buffer_load_dwordx4 v[72:75], v1, s[4:7], s98 offen offset:2048 sc1
    buffer_load_dword v82, v84, s[4:7], s88 offen offset:512 sc1
    v_exp_f32 v26, v26
    v_exp_f32 v27, v27
    v_exp_f32 v28, v28
    v_exp_f32 v29, v29
    buffer_load_dwordx4 v[76:79], v1, s[4:7], s98 offen offset:3072 sc1
    buffer_load_dword v83, v84, s[4:7], s88 offen offset:768 sc1
    v_exp_f32 v30, v30
    v_exp_f32 v31, v31
    v_exp_f32 v32, v32
    v_exp_f32 v33, v33
    s_xor_b32 s96, s82, 0x0
    buffer_load_dwordx4 v[160:163], v1, s[4:7], s96 offen offset:0 sc1
    v_exp_f32 v34, v34
    v_exp_f32 v35, v35
    v_exp_f32 v36, v36
    v_exp_f32 v37, v37
    buffer_load_dwordx4 v[164:167], v1, s[4:7], s96 offen offset:1024 sc1
    v_exp_f32 v38, v38
    v_exp_f32 v39, v39
    v_exp_f32 v40, v40
    v_exp_f32 v41, v41
    buffer_load_dwordx4 v[168:171], v1, s[4:7], s96 offen offset:2048 sc1
    v_exp_f32 v42, v42
    v_exp_f32 v43, v43
    v_exp_f32 v44, v44
    v_exp_f32 v45, v45
    buffer_load_dwordx4 v[172:175], v1, s[4:7], s96 offen offset:3072 sc1
    v_exp_f32 v46, v46
    v_exp_f32 v47, v47
    v_pk_add_f32 v[96:97], v[16:17], v[18:19]
    v_pk_add_f32 v[98:99], v[20:21], v[22:23]
    v_pk_add_f32 v[100:101], v[24:25], v[26:27]
    v_pk_add_f32 v[102:103], v[28:29], v[30:31]
    v_pk_add_f32 v[104:105], v[32:33], v[34:35]
    v_pk_add_f32 v[106:107], v[36:37], v[38:39]
    v_pk_add_f32 v[108:109], v[40:41], v[42:43]
    v_pk_add_f32 v[110:111], v[44:45], v[46:47]
    s_xor_b32 s96, s82, 0x1000
    buffer_load_dwordx4 v[176:179], v1, s[4:7], s96 offen offset:0 sc1
    v_pk_add_f32 v[96:97], v[96:97], v[98:99]
    v_pk_add_f32 v[100:101], v[100:101], v[102:103]
    v_pk_add_f32 v[104:105], v[104:105], v[106:107]
    v_pk_add_f32 v[108:109], v[108:109], v[110:111]
    v_add_f32 v8, v96, v97
    v_add_f32 v9, v104, v105
    v_add_f32 v10, v100, v101
    v_add_f32 v11, v108, v109
    v_permlane32_swap_b32 v8, v9
    s_nop 0
    v_permlane32_swap_b32 v10, v11
    v_add_f32 v8, v8, v9
    v_add_f32 v10, v10, v11
    v_rcp_f32 v8, v8
    buffer_load_dwordx4 v[180:183], v1, s[4:7], s96 offen offset:1024 sc1
    v_rcp_f32 v10, v10
    v_mov_b32 v9, v8
    v_mov_b32 v11, v10
    s_nop 0
    v_permlane32_swap_b32 v8, v9
    v_permlane32_swap_b32 v10, v11
    v_pk_mul_f32 v[16:17], v[16:17], v[8:9] op_sel:[0,0] op_sel_hi:[1,0]
    v_pk_mul_f32 v[18:19], v[18:19], v[8:9] op_sel:[0,0] op_sel_hi:[1,0]
    v_pk_mul_f32 v[20:21], v[20:21], v[8:9] op_sel:[0,0] op_sel_hi:[1,0]
    v_pk_mul_f32 v[22:23], v[22:23], v[8:9] op_sel:[0,0] op_sel_hi:[1,0]
    v_cvt_pk_bf16_f32 v112, v16, v17
    v_cvt_pk_bf16_f32 v113, v18, v19
    v_cvt_pk_bf16_f32 v114, v20, v21
    buffer_load_dwordx4 v[184:187], v1, s[4:7], s96 offen offset:2048 sc1
    v_cvt_pk_bf16_f32 v115, v22, v23
    v_pk_mul_f32 v[24:25], v[24:25], v[10:11] op_sel:[0,0] op_sel_hi:[1,0]
    v_pk_mul_f32 v[26:27], v[26:27], v[10:11] op_sel:[0,0] op_sel_hi:[1,0]
    v_pk_mul_f32 v[28:29], v[28:29], v[10:11] op_sel:[0,0] op_sel_hi:[1,0]
    v_pk_mul_f32 v[30:31], v[30:31], v[10:11] op_sel:[0,0] op_sel_hi:[1,0]
    v_cvt_pk_bf16_f32 v116, v24, v25
    v_cvt_pk_bf16_f32 v117, v26, v27
    v_cvt_pk_bf16_f32 v118, v28, v29
    v_cvt_pk_bf16_f32 v119, v30, v31
    v_pk_mul_f32 v[32:33], v[32:33], v[8:9] op_sel:[0,1] op_sel_hi:[1,1]
    v_pk_mul_f32 v[34:35], v[34:35], v[8:9] op_sel:[0,1] op_sel_hi:[1,1]
    v_pk_mul_f32 v[36:37], v[36:37], v[8:9] op_sel:[0,1] op_sel_hi:[1,1]
    v_pk_mul_f32 v[38:39], v[38:39], v[8:9] op_sel:[0,1] op_sel_hi:[1,1]
    v_cvt_pk_bf16_f32 v120, v32, v33
    v_cvt_pk_bf16_f32 v121, v34, v35
    v_cvt_pk_bf16_f32 v122, v36, v37
    buffer_load_dwordx4 v[188:191], v1, s[4:7], s96 offen offset:3072 sc1
    v_cvt_pk_bf16_f32 v123, v38, v39
    v_pk_mul_f32 v[40:41], v[40:41], v[10:11] op_sel:[0,1] op_sel_hi:[1,1]
    v_pk_mul_f32 v[42:43], v[42:43], v[10:11] op_sel:[0,1] op_sel_hi:[1,1]
    v_pk_mul_f32 v[44:45], v[44:45], v[10:11] op_sel:[0,1] op_sel_hi:[1,1]
    v_pk_mul_f32 v[46:47], v[46:47], v[10:11] op_sel:[0,1] op_sel_hi:[1,1]
    v_cvt_pk_bf16_f32 v124, v40, v41
    v_cvt_pk_bf16_f32 v125, v42, v43
    v_cvt_pk_bf16_f32 v126, v44, v45
    v_cvt_pk_bf16_f32 v127, v46, v47
    s_waitcnt vmcnt(19)
    v_mfma_f32_32x32x16_bf16 v[192:207], v[48:51], a[240:243], 0
    s_waitcnt vmcnt(18)
    v_mfma_f32_32x32x16_bf16 v[192:207], v[52:55], a[240:243], v[192:207]
    s_waitcnt vmcnt(17)
    v_mfma_f32_32x32x16_bf16 v[192:207], v[56:59], a[240:243], v[192:207]
    s_waitcnt vmcnt(16)
    v_mfma_f32_32x32x16_bf16 v[192:207], v[60:63], a[240:243], v[192:207]
    s_add_u32 s97, s80, 0x10000
    s_add_u32 m0, s41, 0x0
    s_nop 0
    buffer_load_dwordx4 v1, s[4:7], s97 offen offset:0 sc1  lds
    s_waitcnt vmcnt(16)
    v_mfma_f32_32x32x16_bf16 v[192:207], v[64:67], a[240:243], v[192:207]
    s_waitcnt vmcnt(14)
    v_mfma_f32_32x32x16_bf16 v[192:207], v[68:71], a[240:243], v[192:207]
    s_waitcnt vmcnt(12)
    v_mfma_f32_32x32x16_bf16 v[192:207], v[72:75], a[240:243], v[192:207]
    s_waitcnt vmcnt(10)
    v_mfma_f32_32x32x16_bf16 v[192:207], v[76:79], a[240:243], v[192:207]
    s_waitcnt vmcnt(9)
    v_mfma_f32_32x32x16_bf16 v[192:207], v[80:83], a[252:255], v[192:207]
    s_nop 11
    v_cvt_pk_bf16_f32 v208, v192, v193
    v_cvt_pk_bf16_f32 v209, v194, v195
    v_cvt_pk_bf16_f32 v210, v196, v197
    v_cvt_pk_bf16_f32 v211, v198, v199
    v_cvt_pk_bf16_f32 v212, v200, v201
    v_cvt_pk_bf16_f32 v213, v202, v203
    v_cvt_pk_bf16_f32 v214, v204, v205
    v_cvt_pk_bf16_f32 v215, v206, v207
    ds_write_b128 v85, v[208:211] offset:0
    ds_write_b128 v85, v[212:215] offset:1024
    v_pk_add_f32 v[192:193], v[192:193], v[200:201]
    v_pk_add_f32 v[194:195], v[194:195], v[202:203]
    v_pk_add_f32 v[196:197], v[196:197], v[204:205]
    v_pk_add_f32 v[198:199], v[198:199], v[206:207]
    v_pk_add_f32 v[192:193], v[192:193], v[196:197]
    v_pk_add_f32 v[194:195], v[194:195], v[198:199]
    v_pk_add_f32 v[192:193], v[192:193], v[194:195]
    v_cmp_u_f32 vcc, v192, v193
    s_cbranch_vccnz KV_RETRY0
KV_OK0:
    buffer_load_dwordx4 v1, s[4:7], s97 offen offset:1024 sc1  lds
    s_waitcnt lgkmcnt(0)
    s_barrier
    ds_read_b128 v[48:51], v4 offset:24576
    ds_read_b128 v[52:55], v4 offset:25600
    ds_read_b128 v[56:59], v4 offset:26624
    ds_read_b128 v[60:63], v4 offset:27648
    ds_read_b128 v[64:67], v4 offset:28672
    ds_read_b128 v[68:71], v4 offset:29696
    ds_read_b128 v[72:75], v4 offset:30720
    ds_read_b128 v[76:79], v4 offset:31744
    s_waitcnt lgkmcnt(7)
    v_mfma_f32_32x32x16_bf16 v[16:31], v[48:51], v[112:115], 0
    buffer_load_dwordx4 v1, s[4:7], s97 offen offset:2048 sc1  lds
    s_waitcnt lgkmcnt(6)
    v_mfma_f32_32x32x16_bf16 v[16:31], v[52:55], v[116:119], v[16:31]
    buffer_load_dwordx4 v1, s[4:7], s97 offen offset:3072 sc1  lds
    s_waitcnt lgkmcnt(5)
    v_mfma_f32_32x32x16_bf16 v[16:31], v[56:59], v[112:115], v[16:31]
    s_add_u32 s97, s49, 0x10000
    s_add_u32 m0, s41, 0x4000
    s_nop 0
    buffer_load_dwordx4 v1, s[4:7], s97 offen offset:0 sc1  lds
    s_waitcnt lgkmcnt(4)
    v_mfma_f32_32x32x16_bf16 v[16:31], v[60:63], v[116:119], v[16:31]
    buffer_load_dwordx4 v1, s[4:7], s97 offen offset:1024 sc1  lds
    s_waitcnt lgkmcnt(3)
    v_mfma_f32_32x32x16_bf16 v[32:47], v[64:67], v[120:123], 0
    s_waitcnt lgkmcnt(2)
    v_mfma_f32_32x32x16_bf16 v[32:47], v[68:71], v[124:127], v[32:47]
    s_waitcnt lgkmcnt(1)
    v_mfma_f32_32x32x16_bf16 v[32:47], v[72:75], v[120:123], v[32:47]
    v_add_f32 v24, 0x358637bd, v24
    v_rcp_f32 v24, v24
    s_nop 0
    v_mul_f32 v16, v16, v24
    v_mul_f32 v17, v17, v24
    v_mul_f32 v18, v18, v24
    v_mul_f32 v19, v19, v24
    s_waitcnt lgkmcnt(0)
    v_mfma_f32_32x32x16_bf16 v[32:47], v[76:79], v[124:127], v[32:47]
    v_mul_f32 v20, v20, v24
    v_mul_f32 v21, v21, v24
    v_mul_f32 v22, v22, v24
    v_mul_f32 v23, v23, v24
    v_cvt_pk_bf16_f32 v88, v16, v17
    v_cvt_pk_bf16_f32 v89, v18, v19
    v_cvt_pk_bf16_f32 v90, v20, v21
    v_cvt_pk_bf16_f32 v91, v22, v23
    buffer_store_dwordx4 v[88:91], v1, s[4:7], s89 offen offset:0 nt
    s_nop 2
    v_add_f32 v40, 0x358637bd, v40
    v_rcp_f32 v40, v40
    s_nop 0
    v_pk_mul_f32 v[32:33], v[32:33], v[40:41] op_sel_hi:[1,0]
    v_pk_mul_f32 v[34:35], v[34:35], v[40:41] op_sel_hi:[1,0]
    v_pk_mul_f32 v[36:37], v[36:37], v[40:41] op_sel_hi:[1,0]
    v_pk_mul_f32 v[38:39], v[38:39], v[40:41] op_sel_hi:[1,0]
    v_cvt_pk_bf16_f32 v92, v32, v33
    v_cvt_pk_bf16_f32 v93, v34, v35
    v_cvt_pk_bf16_f32 v94, v36, v37
    v_cvt_pk_bf16_f32 v95, v38, v39
    buffer_store_dwordx4 v[92:95], v1, s[4:7], s89 offen offset:1024 nt
    s_getpc_b64 s[34:35]
PC_6:
    s_and_b32 s33, s2, 0xf8
    s_lshl1_add_u32 s33, s30, s33
    v_lshrrev_b32 v112, 5, v0
    v_add_lshl_u32 v112, v112, s33, 7
    v_min_u32 v112, CODE_END-PC_6-4, v112
    v_mov_b32 v113, 0
    v_lshl_add_u64 v[112:113], v[112:113], 0, s[34:35]
    global_load_dword v13, v[112:113], off
    v_accvgpr_read_b32 v64, a224
    v_accvgpr_read_b32 v65, a225
    buffer_load_dwordx4 v1, s[4:7], s97 offen offset:2048 sc1  lds
    v_accvgpr_read_b32 v66, a226
    v_accvgpr_read_b32 v67, a227
    buffer_load_dwordx4 v1, s[4:7], s97 offen offset:3072 sc1  lds
    v_accvgpr_read_b32 v68, a228
    v_accvgpr_read_b32 v69, a229
    v_accvgpr_read_b32 v70, a230
    v_accvgpr_read_b32 v71, a231
    v_accvgpr_read_b32 v72, a232
    v_accvgpr_read_b32 v73, a233
    v_accvgpr_read_b32 v74, a234
    v_accvgpr_read_b32 v75, a235
    v_accvgpr_read_b32 v76, a236
    v_accvgpr_read_b32 v77, a237
    v_accvgpr_read_b32 v78, a238
    v_accvgpr_read_b32 v79, a239
    v_lshl_add_u32 v8, s68, 1, v4
    v_xor_b32 v9, 8192, v8
    v_xor_b32 v10, 16384, v8
    v_xor_b32 v11, 24576, v8
    s_add_u32 s33, s74, 2
    v_mov_b32 v7, s33
    s_cmp_lg_u32 s36, 0
    s_waitcnt vmcnt(3)
    s_mov_b64 exec, 1
    s_cbranch_scc1 SIGS_7
    buffer_store_dword v7, off, s[4:7], s76
SIGB_8:
    s_mov_b64 exec, -1
    s_barrier
    s_add_u32 s33, s74, 2
    s_mov_b32 s95, 0
    buffer_load_dword v7, v12, s[4:7], s75 offen sc1
POLL_9:
    buffer_load_dword v255, v12, s[4:7], s75 offen sc1
    s_add_u32 s95, s95, 1
    s_waitcnt vmcnt(1)
    v_cmp_gt_u32 vcc, s33, v7
    s_and_b64 vcc, vcc, s[60:61]
    s_cbranch_scc0 PDONE_10
    buffer_load_dword v7, v12, s[4:7], s75 offen sc1
    s_waitcnt vmcnt(1)
    v_cmp_gt_u32 vcc, s33, v255
    s_and_b64 vcc, vcc, s[60:61]
    s_cbranch_scc0 PDONE_10
    s_cmp_lt_u32 s95, 400000
    s_cbranch_scc1 POLL_9
PDONE_10:
    s_cmp_lg_u32 s36, 0
    s_cbranch_scc1 ACQS_11
ACQB_12:
    s_xor_b32 s96, s91, 0x0
    buffer_load_dwordx4 v[192:195], v1, s[4:7], s96 offen offset:0 sc1
    buffer_load_dwordx4 v[196:199], v1, s[4:7], s96 offen offset:1024 sc1
    buffer_load_dwordx4 v[200:203], v1, s[4:7], s96 offen offset:2048 sc1
    buffer_load_dwordx4 v[204:207], v1, s[4:7], s96 offen offset:3072 sc1
    s_xor_b32 s96, s91, 0x1000
    buffer_load_dwordx4 v[208:211], v1, s[4:7], s96 offen offset:0 sc1
    buffer_load_dwordx4 v[212:215], v1, s[4:7], s96 offen offset:1024 sc1
    s_waitcnt vmcnt(5)
    v_mfma_f32_32x32x16_bf16 v[32:47], v[128:131], v[192:195], 0
    buffer_load_dwordx4 v[216:219], v1, s[4:7], s96 offen offset:2048 sc1
    v_mfma_f32_32x32x16_bf16 v[48:63], v[160:163], v[192:195], 0
    s_waitcnt vmcnt(5)
    v_mfma_f32_32x32x16_bf16 v[32:47], v[132:135], v[196:199], v[32:47]
    buffer_load_dwordx4 v[220:223], v1, s[4:7], s96 offen offset:3072 sc1
    v_mfma_f32_32x32x16_bf16 v[48:63], v[164:167], v[196:199], v[48:63]
    s_waitcnt vmcnt(5)
    v_mfma_f32_32x32x16_bf16 v[32:47], v[136:139], v[200:203], v[32:47]
    s_xor_b32 s96, s90, 0x0
    buffer_load_dwordx4 v[224:227], v1, s[4:7], s96 offen offset:0 sc1
    v_mfma_f32_32x32x16_bf16 v[48:63], v[168:171], v[200:203], v[48:63]
    s_waitcnt vmcnt(5)
    v_mfma_f32_32x32x16_bf16 v[32:47], v[140:143], v[204:207], v[32:47]
    buffer_load_dwordx4 v[228:231], v1, s[4:7], s96 offen offset:1024 sc1
    v_mfma_f32_32x32x16_bf16 v[48:63], v[172:175], v[204:207], v[48:63]
    s_waitcnt vmcnt(5)
    v_mfma_f32_32x32x16_bf16 v[32:47], v[144:147], v[208:211], v[32:47]
    buffer_load_dwordx4 v[232:235], v1, s[4:7], s96 offen offset:2048 sc1
    v_mfma_f32_32x32x16_bf16 v[48:63], v[176:179], v[208:211], v[48:63]
    s_waitcnt vmcnt(5)
    v_mfma_f32_32x32x16_bf16 v[32:47], v[148:151], v[212:215], v[32:47]
    buffer_load_dwordx4 v[236:239], v1, s[4:7], s96 offen offset:3072 sc1
    v_mfma_f32_32x32x16_bf16 v[48:63], v[180:183], v[212:215], v[48:63]
    s_waitcnt vmcnt(5)
    v_mfma_f32_32x32x16_bf16 v[32:47], v[152:155], v[216:219], v[32:47]
    s_xor_b32 s96, s90, 0x1000
    buffer_load_dwordx4 v[240:243], v1, s[4:7], s96 offen offset:0 sc1
    v_mfma_f32_32x32x16_bf16 v[48:63], v[184:187], v[216:219], v[48:63]
    s_waitcnt vmcnt(5)
    v_mfma_f32_32x32x16_bf16 v[32:47], v[156:159], v[220:223], v[32:47]
    buffer_load_dwordx4 v[244:247], v1, s[4:7], s96 offen offset:1024 sc1
    v_mfma_f32_32x32x16_bf16 v[48:63], v[188:191], v[220:223], v[48:63]
    s_waitcnt vmcnt(5)
    v_mfma_f32_32x32x16_bf16 v[16:31], v[160:163], v[224:227], 0
    buffer_load_dwordx4 v[248:251], v1, s[4:7], s96 offen offset:2048 sc1
    s_waitcnt vmcnt(5)
    v_mfma_f32_32x32x16_bf16 v[16:31], v[164:167], v[228:231], v[16:31]
    v_cvt_pk_bf16_f32 v32, v32, v33
    v_cvt_pk_bf16_f32 v33, v34, v35
    v_cvt_pk_bf16_f32 v34, v36, v37
    v_cvt_pk_bf16_f32 v35, v38, v39
    s_waitcnt vmcnt(4)
    v_mfma_f32_32x32x16_bf16 v[16:31], v[168:171], v[232:235], v[16:31]
    buffer_load_dwordx4 v[252:255], v1, s[4:7], s96 offen offset:3072 sc1
    s_add_u32 s97, s80, 0x18000
    s_add_u32 m0, s84, 0x8000
    s_nop 0
    buffer_load_dwordx4 v1, s[4:7], s97 offen offset:0 sc1  lds
    ds_write_b128 v10, v[32:35] offset:0
    v_cvt_pk_bf16_f32 v36, v40, v41
    v_cvt_pk_bf16_f32 v37, v42, v43
    v_cvt_pk_bf16_f32 v38, v44, v45
    v_cvt_pk_bf16_f32 v39, v46, v47
    s_waitcnt vmcnt(5)
    v_mfma_f32_32x32x16_bf16 v[16:31], v[172:175], v[236:239], v[16:31]
    ds_write_b128 v10, v[36:39] offset:1024
    v_cvt_pk_bf16_f32 v48, v48, v49
    v_cvt_pk_bf16_f32 v49, v50, v51
    v_cvt_pk_bf16_f32 v50, v52, v53
    v_cvt_pk_bf16_f32 v51, v54, v55
    s_waitcnt vmcnt(4)
    v_mfma_f32_32x32x16_bf16 v[16:31], v[176:179], v[240:243], v[16:31]
    buffer_load_dwordx4 v1, s[4:7], s97 offen offset:1024 sc1  lds
    ds_write_b128 v11, v[48:51] offset:2048
    v_cvt_pk_bf16_f32 v52, v56, v57
    v_cvt_pk_bf16_f32 v53, v58, v59
    v_cvt_pk_bf16_f32 v54, v60, v61
    v_cvt_pk_bf16_f32 v55, v62, v63
    s_waitcnt vmcnt(4)
    v_mfma_f32_32x32x16_bf16 v[16:31], v[180:183], v[244:247], v[16:31]
    ds_write_b128 v11, v[52:55] offset:3072
    s_waitcnt vmcnt(3)
    v_mfma_f32_32x32x16_bf16 v[16:31], v[184:187], v[248:251], v[16:31]
    buffer_load_dwordx4 v1, s[4:7], s97 offen offset:2048 sc1  lds
    s_waitcnt vmcnt(3)
    v_mfma_f32_32x32x16_bf16 v[16:31], v[188:191], v[252:255], v[16:31]
    v_mfma_f32_32x32x16_bf16 v[64:79], v[128:131], v[224:227], v[64:79]
    buffer_load_dwordx4 v1, s[4:7], s97 offen offset:3072 sc1  lds
    s_waitcnt lgkmcnt(0)
    s_barrier
    ds_read_b128 v[80:83], v8 offset:0
    ds_read_b128 v[84:87], v8 offset:1024
    v_mfma_f32_32x32x16_bf16 v[64:79], v[132:135], v[228:231], v[64:79]
    ds_read_b128 v[88:91], v8 offset:2048
    ds_read_b128 v[92:95], v8 offset:3072
    v_mfma_f32_32x32x16_bf16 v[64:79], v[136:139], v[232:235], v[64:79]
    s_add_u32 s97, s49, 0x18000
    s_add_u32 m0, s84, 0xc000
    s_nop 0
    buffer_load_dwordx4 v1, s[4:7], s97 offen offset:0 sc1  lds
    v_cvt_pk_bf16_f32 v16, v16, v17
    v_cvt_pk_bf16_f32 v17, v18, v19
    v_cvt_pk_bf16_f32 v18, v20, v21
    v_cvt_pk_bf16_f32 v19, v22, v23
    v_mfma_f32_32x32x16_bf16 v[64:79], v[140:143], v[236:239], v[64:79]
    ds_write_b128 v9, v[16:19] offset:4096
    v_cvt_pk_bf16_f32 v20, v24, v25
    v_cvt_pk_bf16_f32 v21, v26, v27
    v_cvt_pk_bf16_f32 v22, v28, v29
    v_cvt_pk_bf16_f32 v23, v30, v31
    v_mfma_f32_32x32x16_bf16 v[64:79], v[144:147], v[240:243], v[64:79]
    buffer_load_dwordx4 v1, s[4:7], s97 offen offset:1024 sc1  lds
    ds_write_b128 v9, v[20:23] offset:5120
    v_mfma_f32_32x32x16_bf16 v[64:79], v[148:151], v[244:247], v[64:79]
    v_mfma_f32_32x32x16_bf16 v[64:79], v[152:155], v[248:251], v[64:79]
    buffer_load_dwordx4 v1, s[4:7], s97 offen offset:2048 sc1  lds
    v_mfma_f32_32x32x16_bf16 v[64:79], v[156:159], v[252:255], v[64:79]
    s_waitcnt lgkmcnt(5)
    v_mfma_f32_32x32x16_bf16 v[64:79], a[240:243], v[80:83], v[64:79]
    buffer_load_dwordx4 v1, s[4:7], s97 offen offset:3072 sc1  lds
    s_waitcnt lgkmcnt(0)
    s_barrier
    ds_read_b128 v[96:99], v8 offset:4096
    ds_read_b128 v[100:103], v8 offset:5120
    v_mfma_f32_32x32x16_bf16 v[64:79], a[244:247], v[84:87], v[64:79]
    v_mfma_f32_32x32x16_bf16 v[64:79], a[240:243], v[88:91], v[64:79]
    v_mfma_f32_32x32x16_bf16 v[64:79], a[244:247], v[92:95], v[64:79]
    s_waitcnt lgkmcnt(1)
    v_mfma_f32_32x32x16_bf16 v[64:79], a[240:243], v[96:99], v[64:79]
    s_waitcnt lgkmcnt(0)
    v_mfma_f32_32x32x16_bf16 v[64:79], a[244:247], v[100:103], v[64:79]
    s_nop 11
    v_cvt_pk_bf16_f32 v80, v64, v65
    v_cvt_pk_bf16_f32 v81, v66, v67
    v_cvt_pk_bf16_f32 v82, v68, v69
    v_cvt_pk_bf16_f32 v83, v70, v71
    v_cvt_pk_bf16_f32 v84, v72, v73
    v_cvt_pk_bf16_f32 v85, v74, v75
    v_cvt_pk_bf16_f32 v86, v76, v77
    v_cvt_pk_bf16_f32 v87, v78, v79
    s_add_u32 s33, s70, 0x0
    buffer_store_dwordx4 v[80:83], v1, s[4:7], s33 offen offset:0 nt
    buffer_store_dwordx4 v[84:87], v1, s[4:7], s33 offen offset:1024 nt
    v_pk_add_f32 v[8:9], v[64:65], v[66:67]
    v_pk_mul_f32 v[10:11], v[64:65], v[64:65]
    v_pk_fma_f32 v[10:11], v[66:67], v[66:67], v[10:11]
    v_pk_add_f32 v[8:9], v[8:9], v[68:69]
    v_pk_fma_f32 v[10:11], v[68:69], v[68:69], v[10:11]
    v_pk_add_f32 v[8:9], v[8:9], v[70:71]
    v_pk_fma_f32 v[10:11], v[70:71], v[70:71], v[10:11]
    v_pk_add_f32 v[8:9], v[8:9], v[72:73]
    v_pk_fma_f32 v[10:11], v[72:73], v[72:73], v[10:11]
    v_pk_add_f32 v[8:9], v[8:9], v[74:75]
    v_pk_fma_f32 v[10:11], v[74:75], v[74:75], v[10:11]
    v_pk_add_f32 v[8:9], v[8:9], v[76:77]
    v_pk_fma_f32 v[10:11], v[76:77], v[76:77], v[10:11]
    v_pk_add_f32 v[8:9], v[8:9], v[78:79]
    v_pk_fma_f32 v[10:11], v[78:79], v[78:79], v[10:11]
    v_add_f32 v8, v8, v9
    v_add_f32 v10, v10, v11
    s_add_u32 s34, s71, 0x0
    s_nop 0
    v_permlane32_swap_b32 v8, v10
    v_add_f32 v8, v8, v10
    buffer_store_dword v8, v3, s[4:7], s34 offen nt
    v_accvgpr_write_b32 a224, v64
    v_accvgpr_write_b32 a225, v65
    v_accvgpr_write_b32 a226, v66
    v_accvgpr_write_b32 a227, v67
    v_accvgpr_write_b32 a228, v68
    v_accvgpr_write_b32 a229, v69
    v_accvgpr_write_b32 a230, v70
    v_accvgpr_write_b32 a231, v71
    v_accvgpr_write_b32 a232, v72
    v_accvgpr_write_b32 a233, v73
WZ3:
    s_cbranch_execz WZ7
    v_accvgpr_write_b32 a234, v74
    v_accvgpr_write_b32 a235, v75
    v_accvgpr_write_b32 a236, v76
    v_accvgpr_write_b32 a237, v77
    v_accvgpr_write_b32 a238, v78
    v_accvgpr_write_b32 a239, v79
    s_add_u32 s33, s74, 3
    v_mov_b32 v7, s33
    s_cmp_lg_u32 s36, 0
    s_waitcnt vmcnt(0)
    s_mov_b64 exec, 1
    s_cbranch_scc1 SIGS_13
    buffer_store_dword v7, off, s[4:7], s62
SIGB_14:
    s_mov_b64 exec, -1
    s_and_b32 s58, s71, 0xfffff000
    s_add_u32 s33, s74, 3
    s_mov_b32 s95, 0
    buffer_load_dword v7, v12, s[4:7], s75 offen offset:64 sc1
POLL_15:
    buffer_load_dword v255, v12, s[4:7], s75 offen offset:64 sc1
    s_add_u32 s95, s95, 1
    s_waitcnt vmcnt(1)
    v_cmp_gt_u32 vcc, s33, v7
    s_and_b64 vcc, vcc, 0xffff
    s_cbranch_scc0 PDONE_16
    buffer_load_dword v7, v12, s[4:7], s75 offen offset:64 sc1
    s_waitcnt vmcnt(1)
    v_cmp_gt_u32 vcc, s33, v255
    s_and_b64 vcc, vcc, 0xffff
    s_cbranch_scc0 PDONE_16
    s_cmp_lt_u32 s95, 400000
    s_cbranch_scc1 POLL_15
PDONE_16:
    s_cmp_lg_u32 s36, 0
    s_cbranch_scc1 ACQS_17
ACQB_18:
    s_xor_b32 s96, s55, 0x0
    buffer_load_dwordx4 v[128:131], v1, s[4:7], s96 offen offset:0 sc1
    buffer_load_dwordx4 v[132:135], v1, s[4:7], s96 offen offset:1024 sc1
    buffer_load_dwordx4 v[136:139], v1, s[4:7], s96 offen offset:2048 sc1
    buffer_load_dwordx4 v[140:143], v1, s[4:7], s96 offen offset:3072 sc1
    s_xor_b32 s96, s55, 0x1000
    buffer_load_dwordx4 v[144:147], v1, s[4:7], s96 offen offset:0 sc1
    buffer_load_dwordx4 v[148:151], v1, s[4:7], s96 offen offset:1024 sc1
    s_barrier
    ds_read_b128 v[32:35], v1 offset:0
    ds_read_b128 v[36:39], v1 offset:32768
    ds_read_b128 v[40:43], v5 offset:0
    s_waitcnt vmcnt(5) lgkmcnt(2)
    v_mfma_f32_32x32x16_bf16 v[96:111], v[32:35], v[128:131], 0
    ds_read_b128 v[44:47], v1 offset:1024
    buffer_load_dwordx4 v[152:155], v1, s[4:7], s96 offen offset:2048 sc1
    s_waitcnt lgkmcnt(2)
    v_mfma_f32_32x32x16_bf16 v[112:127], v[36:39], v[128:131], 0
    ds_read_b128 v[32:35], v1 offset:33792
    s_waitcnt lgkmcnt(2)
    v_mfma_f32_32x32x16_bf16 v[80:95], v[40:43], v[128:131], 0
    ds_read_b128 v[36:39], v5 offset:1024
    buffer_load_dwordx4 v[156:159], v1, s[4:7], s96 offen offset:3072 sc1
    s_waitcnt vmcnt(6) lgkmcnt(2)
    v_mfma_f32_32x32x16_bf16 v[96:111], v[44:47], v[132:135], v[96:111]
    ds_read_b128 v[40:43], v1 offset:2048
    s_waitcnt lgkmcnt(2)
    v_mfma_f32_32x32x16_bf16 v[112:127], v[32:35], v[132:135], v[112:127]
    ds_read_b128 v[44:47], v1 offset:34816
    s_xor_b32 s96, s55, 0x2000
    buffer_load_dwordx4 v[160:163], v1, s[4:7], s96 offen offset:0 sc1
    s_waitcnt lgkmcnt(2)
    v_mfma_f32_32x32x16_bf16 v[80:95], v[36:39], v[132:135], v[80:95]
    ds_read_b128 v[32:35], v5 offset:2048
    s_waitcnt vmcnt(6) lgkmcnt(2)
    v_mfma_f32_32x32x16_bf16 v[96:111], v[40:43], v[136:139], v[96:111]
    ds_read_b128 v[36:39], v1 offset:3072
    buffer_load_dwordx4 v[164:167], v1, s[4:7], s96 offen offset:1024 sc1
    s_waitcnt lgkmcnt(2)
    v_mfma_f32_32x32x16_bf16 v[112:127], v[44:47], v[136:139], v[112:127]
    ds_read_b128 v[40:43], v1 offset:35840
    s_waitcnt lgkmcnt(2)
    v_mfma_f32_32x32x16_bf16 v[80:95], v[32:35], v[136:139], v[80:95]
    ds_read_b128 v[44:47], v5 offset:3072
    buffer_load_dwordx4 v[168:171], v1, s[4:7], s96 offen offset:2048 sc1
    s_waitcnt vmcnt(7) lgkmcnt(2)
    v_mfma_f32_32x32x16_bf16 v[96:111], v[36:39], v[140:143], v[96:111]
    ds_read_b128 v[32:35], v1 offset:4096
    s_waitcnt lgkmcnt(2)
    v_mfma_f32_32x32x16_bf16 v[112:127], v[40:43], v[140:143], v[112:127]
    ds_read_b128 v[36:39], v1 offset:36864
    buffer_load_dwordx4 v[172:175], v1, s[4:7], s96 offen offset:3072 sc1
    s_waitcnt lgkmcnt(2)
    v_mfma_f32_32x32x16_bf16 v[80:95], v[44:47], v[140:143], v[80:95]
    ds_read_b128 v[40:43], v5 offset:4096
    s_waitcnt vmcnt(7) lgkmcnt(2)
    v_mfma_f32_32x32x16_bf16 v[96:111], v[32:35], v[144:147], v[96:111]
    ds_read_b128 v[44:47], v1 offset:5120
    s_xor_b32 s96, s55, 0x3000
    buffer_load_dwordx4 v[176:179], v1, s[4:7], s96 offen offset:0 sc1
    s_waitcnt lgkmcnt(2)
    v_mfma_f32_32x32x16_bf16 v[112:127], v[36:39], v[144:147], v[112:127]
    ds_read_b128 v[32:35], v1 offset:37888
    s_waitcnt lgkmcnt(2)
    v_mfma_f32_32x32x16_bf16 v[80:95], v[40:43], v[144:147], v[80:95]
    ds_read_b128 v[36:39], v5 offset:5120
    buffer_load_dwordx4 v[180:183], v1, s[4:7], s96 offen offset:1024 sc1
    s_waitcnt vmcnt(8) lgkmcnt(2)
    v_mfma_f32_32x32x16_bf16 v[96:111], v[44:47], v[148:151], v[96:111]
    ds_read_b128 v[40:43], v1 offset:6144
    s_waitcnt lgkmcnt(2)
    v_mfma_f32_32x32x16_bf16 v[112:127], v[32:35], v[148:151], v[112:127]
    ds_read_b128 v[44:47], v1 offset:38912
    buffer_load_dwordx4 v[184:187], v1, s[4:7], s96 offen offset:2048 sc1
    s_waitcnt lgkmcnt(2)
    v_mfma_f32_32x32x16_bf16 v[80:95], v[36:39], v[148:151], v[80:95]
    ds_read_b128 v[32:35], v5 offset:6144
    s_waitcnt vmcnt(8) lgkmcnt(2)
    v_mfma_f32_32x32x16_bf16 v[96:111], v[40:43], v[152:155], v[96:111]
    ds_read_b128 v[36:39], v1 offset:7168
    buffer_load_dwordx4 v[188:191], v1, s[4:7], s96 offen offset:3072 sc1
    s_waitcnt lgkmcnt(2)
    v_mfma_f32_32x32x16_bf16 v[112:127], v[44:47], v[152:155], v[112:127]
    ds_read_b128 v[40:43], v1 offset:39936
    s_waitcnt lgkmcnt(2)
    v_mfma_f32_32x32x16_bf16 v[80:95], v[32:35], v[152:155], v[80:95]
    ds_read_b128 v[44:47], v5 offset:7168
    s_xor_b32 s96, s55, 0x4000
    buffer_load_dwordx4 v[192:195], v1, s[4:7], s96 offen offset:0 sc1
    s_waitcnt vmcnt(9) lgkmcnt(2)
    v_mfma_f32_32x32x16_bf16 v[96:111], v[36:39], v[156:159], v[96:111]
    ds_read_b128 v[32:35], v1 offset:8192
    s_waitcnt lgkmcnt(2)
    v_mfma_f32_32x32x16_bf16 v[112:127], v[40:43], v[156:159], v[112:127]
    ds_read_b128 v[36:39], v1 offset:40960
    buffer_load_dwordx4 v[196:199], v1, s[4:7], s96 offen offset:1024 sc1
    s_waitcnt lgkmcnt(2)
    v_mfma_f32_32x32x16_bf16 v[80:95], v[44:47], v[156:159], v[80:95]
    ds_read_b128 v[40:43], v5 offset:8192
    s_waitcnt vmcnt(9) lgkmcnt(2)
    v_mfma_f32_32x32x16_bf16 v[96:111], v[32:35], v[160:163], v[96:111]
    ds_read_b128 v[44:47], v1 offset:9216
    buffer_load_dwordx4 v[200:203], v1, s[4:7], s96 offen offset:2048 sc1
    s_waitcnt lgkmcnt(2)
    v_mfma_f32_32x32x16_bf16 v[112:127], v[36:39], v[160:163], v[112:127]
    ds_read_b128 v[32:35], v1 offset:41984
    s_waitcnt lgkmcnt(2)
    v_mfma_f32_32x32x16_bf16 v[80:95], v[40:43], v[160:163], v[80:95]
    ds_read_b128 v[36:39], v5 offset:9216
    buffer_load_dwordx4 v[204:207], v1, s[4:7], s96 offen offset:3072 sc1
    s_waitcnt vmcnt(10) lgkmcnt(2)
    v_mfma_f32_32x32x16_bf16 v[96:111], v[44:47], v[164:167], v[96:111]
    ds_read_b128 v[40:43], v1 offset:10240
    s_waitcnt lgkmcnt(2)
    v_mfma_f32_32x32x16_bf16 v[112:127], v[32:35], v[164:167], v[112:127]
    ds_read_b128 v[44:47], v1 offset:43008
    s_xor_b32 s96, s55, 0x5000
    buffer_load_dwordx4 v[208:211], v1, s[4:7], s96 offen offset:0 sc1
    s_waitcnt lgkmcnt(2)
    v_mfma_f32_32x32x16_bf16 v[80:95], v[36:39], v[164:167], v[80:95]
    ds_read_b128 v[32:35], v5 offset:10240
    s_waitcnt vmcnt(10) lgkmcnt(2)
    v_mfma_f32_32x32x16_bf16 v[96:111], v[40:43], v[168:171], v[96:111]
    ds_read_b128 v[36:39], v1 offset:11264
    buffer_load_dwordx4 v[212:215], v1, s[4:7], s96 offen offset:1024 sc1
    s_waitcnt lgkmcnt(2)
    v_mfma_f32_32x32x16_bf16 v[112:127], v[44:47], v[168:171], v[112:127]
    ds_read_b128 v[40:43], v1 offset:44032
    s_waitcnt lgkmcnt(2)
    v_mfma_f32_32x32x16_bf16 v[80:95], v[32:35], v[168:171], v[80:95]
    ds_read_b128 v[44:47], v5 offset:11264
    buffer_load_dwordx4 v[216:219], v1, s[4:7], s96 offen offset:2048 sc1
    s_waitcnt vmcnt(11) lgkmcnt(2)
    v_mfma_f32_32x32x16_bf16 v[96:111], v[36:39], v[172:175], v[96:111]
    ds_read_b128 v[32:35], v1 offset:12288
    s_waitcnt lgkmcnt(2)
    v_mfma_f32_32x32x16_bf16 v[112:127], v[40:43], v[172:175], v[112:127]
    ds_read_b128 v[36:39], v1 offset:45056
    buffer_load_dwordx4 v[220:223], v1, s[4:7], s96 offen offset:3072 sc1
    s_waitcnt lgkmcnt(2)
    v_mfma_f32_32x32x16_bf16 v[80:95], v[44:47], v[172:175], v[80:95]
    ds_read_b128 v[40:43], v5 offset:12288
    s_waitcnt vmcnt(11) lgkmcnt(2)
    v_mfma_f32_32x32x16_bf16 v[96:111], v[32:35], v[176:179], v[96:111]
    ds_read_b128 v[44:47], v1 offset:13312
    s_xor_b32 s96, s55, 0x6000
    buffer_load_dwordx4 v[224:227], v1, s[4:7], s96 offen offset:0 sc1
    s_waitcnt lgkmcnt(2)
    v_mfma_f32_32x32x16_bf16 v[112:127], v[36:39], v[176:179], v[112:127]
    ds_read_b128 v[32:35], v1 offset:46080
    s_waitcnt lgkmcnt(2)
    v_mfma_f32_32x32x16_bf16 v[80:95], v[40:43], v[176:179], v[80:95]
    ds_read_b128 v[36:39], v5 offset:13312
    buffer_load_dwordx4 v[228:231], v1, s[4:7], s96 offen offset:1024 sc1
    s_waitcnt vmcnt(12) lgkmcnt(2)
    v_mfma_f32_32x32x16_bf16 v[96:111], v[44:47], v[180:183], v[96:111]
    ds_read_b128 v[40:43], v1 offset:14336
    s_waitcnt lgkmcnt(2)
    v_mfma_f32_32x32x16_bf16 v[112:127], v[32:35], v[180:183], v[112:127]
    ds_read_b128 v[44:47], v1 offset:47104
    buffer_load_dwordx4 v[232:235], v1, s[4:7], s96 offen offset:2048 sc1
    s_waitcnt lgkmcnt(2)
    v_mfma_f32_32x32x16_bf16 v[80:95], v[36:39], v[180:183], v[80:95]
    ds_read_b128 v[32:35], v5 offset:14336
    s_waitcnt vmcnt(12) lgkmcnt(2)
    v_mfma_f32_32x32x16_bf16 v[96:111], v[40:43], v[184:187], v[96:111]
    ds_read_b128 v[36:39], v1 offset:15360
    buffer_load_dwordx4 v[236:239], v1, s[4:7], s96 offen offset:3072 sc1
    s_waitcnt lgkmcnt(2)
    v_mfma_f32_32x32x16_bf16 v[112:127], v[44:47], v[184:187], v[112:127]
    ds_read_b128 v[40:43], v1 offset:48128
    s_waitcnt lgkmcnt(2)
    v_mfma_f32_32x32x16_bf16 v[80:95], v[32:35], v[184:187], v[80:95]
    ds_read_b128 v[44:47], v5 offset:15360
    s_xor_b32 s96, s55, 0x7000
    buffer_load_dwordx4 v[240:243], v1, s[4:7], s96 offen offset:0 sc1
    s_waitcnt vmcnt(13) lgkmcnt(2)
    v_mfma_f32_32x32x16_bf16 v[96:111], v[36:39], v[188:191], v[96:111]
    ds_read_b128 v[32:35], v1 offset:16384
    s_waitcnt lgkmcnt(2)
    v_mfma_f32_32x32x16_bf16 v[112:127], v[40:43], v[188:191], v[112:127]
    ds_read_b128 v[36:39], v1 offset:49152
    buffer_load_dwordx4 v[244:247], v1, s[4:7], s96 offen offset:1024 sc1
    s_waitcnt lgkmcnt(2)
    v_mfma_f32_32x32x16_bf16 v[80:95], v[44:47], v[188:191], v[80:95]
    ds_read_b128 v[40:43], v5 offset:16384
    s_waitcnt vmcnt(13) lgkmcnt(2)
    v_mfma_f32_32x32x16_bf16 v[96:111], v[32:35], v[192:195], v[96:111]
    ds_read_b128 v[44:47], v1 offset:17408
    buffer_load_dwordx4 v[248:251], v1, s[4:7], s96 offen offset:2048 sc1
    s_waitcnt lgkmcnt(2)
    v_mfma_f32_32x32x16_bf16 v[112:127], v[36:39], v[192:195], v[112:127]
    ds_read_b128 v[32:35], v1 offset:50176
    s_waitcnt lgkmcnt(2)
    v_mfma_f32_32x32x16_bf16 v[80:95], v[40:43], v[192:195], v[80:95]
    ds_read_b128 v[36:39], v5 offset:17408
    buffer_load_dwordx4 v[252:255], v1, s[4:7], s96 offen offset:3072 sc1
    s_waitcnt vmcnt(14) lgkmcnt(2)
    v_mfma_f32_32x32x16_bf16 v[96:111], v[44:47], v[196:199], v[96:111]
    ds_read_b128 v[40:43], v1 offset:18432
    s_barrier
    s_waitcnt lgkmcnt(2)
    v_mfma_f32_32x32x16_bf16 v[112:127], v[32:35], v[196:199], v[112:127]
    ds_read_b128 v[44:47], v1 offset:51200
    s_add_u32 s97, s80, 0x20000
    s_add_u32 m0, s84, 0x0
    s_waitcnt lgkmcnt(2)
    v_mfma_f32_32x32x16_bf16 v[80:95], v[36:39], v[196:199], v[80:95]
    ds_read_b128 v[32:35], v5 offset:18432
    buffer_load_dwordx4 v1, s[4:7], s97 offen offset:0 sc1  lds
    s_waitcnt vmcnt(14) lgkmcnt(2)
    v_mfma_f32_32x32x16_bf16 v[96:111], v[40:43], v[200:203], v[96:111]
    ds_read_b128 v[36:39], v1 offset:19456
    s_waitcnt lgkmcnt(2)
    v_mfma_f32_32x32x16_bf16 v[112:127], v[44:47], v[200:203], v[112:127]
    ds_read_b128 v[40:43], v1 offset:52224
    s_waitcnt lgkmcnt(2)
    v_mfma_f32_32x32x16_bf16 v[80:95], v[32:35], v[200:203], v[80:95]
    ds_read_b128 v[44:47], v5 offset:19456
    buffer_load_dwordx4 v1, s[4:7], s97 offen offset:1024 sc1  lds
    s_waitcnt vmcnt(14) lgkmcnt(2)
    v_mfma_f32_32x32x16_bf16 v[96:111], v[36:39], v[204:207], v[96:111]
    ds_read_b128 v[32:35], v1 offset:20480
    s_waitcnt lgkmcnt(2)
    v_mfma_f32_32x32x16_bf16 v[112:127], v[40:43], v[204:207], v[112:127]
    ds_read_b128 v[36:39], v1 offset:53248
    s_waitcnt lgkmcnt(2)
    v_mfma_f32_32x32x16_bf16 v[80:95], v[44:47], v[204:207], v[80:95]
    ds_read_b128 v[40:43], v5 offset:20480
    s_waitcnt vmcnt(13) lgkmcnt(2)
    v_mfma_f32_32x32x16_bf16 v[96:111], v[32:35], v[208:211], v[96:111]
    ds_read_b128 v[44:47], v1 offset:21504
    buffer_load_dwordx4 v1, s[4:7], s97 offen offset:2048 sc1  lds
    s_waitcnt lgkmcnt(2)
    v_mfma_f32_32x32x16_bf16 v[112:127], v[36:39], v[208:211], v[112:127]
    ds_read_b128 v[32:35], v1 offset:54272
    s_waitcnt lgkmcnt(2)
    v_mfma_f32_32x32x16_bf16 v[80:95], v[40:43], v[208:211], v[80:95]
    ds_read_b128 v[36:39], v5 offset:21504
    s_waitcnt vmcnt(13) lgkmcnt(2)
    v_mfma_f32_32x32x16_bf16 v[96:111], v[44:47], v[212:215], v[96:111]
    ds_read_b128 v[40:43], v1 offset:22528
    buffer_load_dwordx4 v1, s[4:7], s97 offen offset:3072 sc1  lds
    s_waitcnt lgkmcnt(2)
    v_mfma_f32_32x32x16_bf16 v[112:127], v[32:35], v[212:215], v[112:127]
    ds_read_b128 v[44:47], v1 offset:55296
    s_waitcnt lgkmcnt(2)
    v_mfma_f32_32x32x16_bf16 v[80:95], v[36:39], v[212:215], v[80:95]
    ds_read_b128 v[32:35], v5 offset:22528
    s_waitcnt vmcnt(13) lgkmcnt(2)
    v_mfma_f32_32x32x16_bf16 v[96:111], v[40:43], v[216:219], v[96:111]
    ds_read_b128 v[36:39], v1 offset:23552
    s_add_u32 s97, s49, 0x20000
    s_add_u32 m0, s84, 0x4000
    s_waitcnt lgkmcnt(2)
    v_mfma_f32_32x32x16_bf16 v[112:127], v[44:47], v[216:219], v[112:127]
    ds_read_b128 v[40:43], v1 offset:56320
    buffer_load_dwordx4 v1, s[4:7], s97 offen offset:0 sc1  lds
    s_waitcnt lgkmcnt(2)
    v_mfma_f32_32x32x16_bf16 v[80:95], v[32:35], v[216:219], v[80:95]
    ds_read_b128 v[44:47], v5 offset:23552
    s_waitcnt vmcnt(13) lgkmcnt(2)
    v_mfma_f32_32x32x16_bf16 v[96:111], v[36:39], v[220:223], v[96:111]
    ds_read_b128 v[32:35], v1 offset:24576
    s_waitcnt lgkmcnt(2)
    v_mfma_f32_32x32x16_bf16 v[112:127], v[40:43], v[220:223], v[112:127]
    ds_read_b128 v[36:39], v1 offset:57344
    buffer_load_dwordx4 v1, s[4:7], s97 offen offset:1024 sc1  lds
    s_waitcnt lgkmcnt(2)
    v_mfma_f32_32x32x16_bf16 v[80:95], v[44:47], v[220:223], v[80:95]
    ds_read_b128 v[40:43], v5 offset:24576
    buffer_load_dwordx4 v[16:19], v1, s[4:7], s58 offen offset:0 sc1
    s_waitcnt vmcnt(14) lgkmcnt(2)
    v_mfma_f32_32x32x16_bf16 v[96:111], v[32:35], v[224:227], v[96:111]
    ds_read_b128 v[44:47], v1 offset:25600
    buffer_load_dwordx4 v[20:23], v1, s[4:7], s58 offen offset:1024 sc1
    s_waitcnt lgkmcnt(2)
    v_mfma_f32_32x32x16_bf16 v[112:127], v[36:39], v[224:227], v[112:127]
    ds_read_b128 v[32:35], v1 offset:58368
    buffer_load_dwordx4 v[24:27], v1, s[4:7], s58 offen offset:2048 sc1
    s_waitcnt lgkmcnt(2)
    v_mfma_f32_32x32x16_bf16 v[80:95], v[40:43], v[224:227], v[80:95]
    ds_read_b128 v[36:39], v5 offset:25600
    buffer_load_dwordx4 v1, s[4:7], s97 offen offset:2048 sc1  lds
    s_waitcnt vmcnt(16) lgkmcnt(2)
    v_mfma_f32_32x32x16_bf16 v[96:111], v[44:47], v[228:231], v[96:111]
    ds_read_b128 v[40:43], v1 offset:26624
    buffer_load_dwordx4 v[28:31], v1, s[4:7], s58 offen offset:3072 sc1
    s_waitcnt lgkmcnt(2)
    v_mfma_f32_32x32x16_bf16 v[112:127], v[32:35], v[228:231], v[112:127]
    ds_read_b128 v[44:47], v1 offset:59392
    s_waitcnt lgkmcnt(2)
    v_mfma_f32_32x32x16_bf16 v[80:95], v[36:39], v[228:231], v[80:95]
    ds_read_b128 v[32:35], v5 offset:26624
    buffer_load_dwordx4 v1, s[4:7], s97 offen offset:3072 sc1  lds
    s_waitcnt vmcnt(17) lgkmcnt(2)
    v_mfma_f32_32x32x16_bf16 v[96:111], v[40:43], v[232:235], v[96:111]
    ds_read_b128 v[36:39], v1 offset:27648
    s_waitcnt lgkmcnt(2)
    v_mfma_f32_32x32x16_bf16 v[112:127], v[44:47], v[232:235], v[112:127]
    ds_read_b128 v[40:43], v1 offset:60416
    s_waitcnt lgkmcnt(2)
    v_mfma_f32_32x32x16_bf16 v[80:95], v[32:35], v[232:235], v[80:95]
    ds_read_b128 v[44:47], v5 offset:27648
    s_add_u32 s97, s63, 0x0
    s_add_u32 m0, s83, 0x0
    s_waitcnt vmcnt(16) lgkmcnt(2)
    v_mfma_f32_32x32x16_bf16 v[96:111], v[36:39], v[236:239], v[96:111]
    ds_read_b128 v[32:35], v1 offset:28672
    buffer_load_dwordx4 v1, s[4:7], s97 offen offset:0 sc1  lds
    s_waitcnt lgkmcnt(2)
    v_mfma_f32_32x32x16_bf16 v[112:127], v[40:43], v[236:239], v[112:127]
    ds_read_b128 v[36:39], v1 offset:61440
    s_waitcnt lgkmcnt(2)
    v_mfma_f32_32x32x16_bf16 v[80:95], v[44:47], v[236:239], v[80:95]
    ds_read_b128 v[40:43], v5 offset:28672
    s_waitcnt vmcnt(16) lgkmcnt(2)
    v_mfma_f32_32x32x16_bf16 v[96:111], v[32:35], v[240:243], v[96:111]
    ds_read_b128 v[44:47], v1 offset:29696
    buffer_load_dwordx4 v1, s[4:7], s97 offen offset:1024 sc1  lds
    s_waitcnt lgkmcnt(2)
    v_mfma_f32_32x32x16_bf16 v[112:127], v[36:39], v[240:243], v[112:127]
    ds_read_b128 v[32:35], v1 offset:62464
    s_waitcnt lgkmcnt(2)
    v_mfma_f32_32x32x16_bf16 v[80:95], v[40:43], v[240:243], v[80:95]
    ds_read_b128 v[36:39], v5 offset:29696
    s_waitcnt vmcnt(16) lgkmcnt(2)
    v_mfma_f32_32x32x16_bf16 v[96:111], v[44:47], v[244:247], v[96:111]
    ds_read_b128 v[40:43], v1 offset:30720
    s_waitcnt lgkmcnt(2)
    v_mfma_f32_32x32x16_bf16 v[112:127], v[32:35], v[244:247], v[112:127]
    ds_read_b128 v[44:47], v1 offset:63488
    buffer_load_dwordx4 v1, s[4:7], s97 offen offset:2048 sc1  lds
    s_waitcnt lgkmcnt(2)
    v_mfma_f32_32x32x16_bf16 v[80:95], v[36:39], v[244:247], v[80:95]
    ds_read_b128 v[32:35], v5 offset:30720
    s_waitcnt vmcnt(16) lgkmcnt(2)
    v_mfma_f32_32x32x16_bf16 v[96:111], v[40:43], v[248:251], v[96:111]
    ds_read_b128 v[36:39], v1 offset:31744
    s_waitcnt lgkmcnt(2)
    v_mfma_f32_32x32x16_bf16 v[112:127], v[44:47], v[248:251], v[112:127]
    ds_read_b128 v[40:43], v1 offset:64512
    buffer_load_dwordx4 v1, s[4:7], s97 offen offset:3072 sc1  lds
    s_waitcnt lgkmcnt(2)
    v_mfma_f32_32x32x16_bf16 v[80:95], v[32:35], v[248:251], v[80:95]
    ds_read_b128 v[44:47], v5 offset:31744
    s_waitcnt vmcnt(16) lgkmcnt(2)
    v_mfma_f32_32x32x16_bf16 v[96:111], v[36:39], v[252:255], v[96:111]
    ds_read_b128 v[32:35], v4 offset:32768
    s_waitcnt lgkmcnt(2)
    v_mfma_f32_32x32x16_bf16 v[112:127], v[40:43], v[252:255], v[112:127]
    ds_read_b128 v[36:39], v4 offset:33792
    s_add_u32 s97, s63, 0x8000
    s_add_u32 m0, s83, 0x8000
    s_waitcnt lgkmcnt(2)
    v_mfma_f32_32x32x16_bf16 v[80:95], v[44:47], v[252:255], v[80:95]
    ds_read_b128 v[40:43], v4 offset:34816
    buffer_load_dwordx4 v1, s[4:7], s97 offen offset:0 sc1  lds
    s_waitcnt lgkmcnt(2)
    v_mfma_f32_32x32x16_bf16 v[48:63], v[32:35], v[128:131], 0
    ds_read_b128 v[44:47], v4 offset:35840
    v_max_f32 v96, 0, v96
    v_max_f32 v97, 0, v97
    v_max_f32 v98, 0, v98
    s_waitcnt lgkmcnt(2)
    v_mfma_f32_32x32x16_bf16 v[48:63], v[36:39], v[132:135], v[48:63]
    ds_read_b128 v[32:35], v4 offset:36864
    s_barrier
    v_max_f32 v99, 0, v99
    v_max_f32 v100, 0, v100
    v_max_f32 v101, 0, v101
    s_waitcnt lgkmcnt(2)
    v_mfma_f32_32x32x16_bf16 v[48:63], v[40:43], v[136:139], v[48:63]
    ds_read_b128 v[36:39], v4 offset:37888
    buffer_load_dwordx4 v1, s[4:7], s97 offen offset:1024 sc1  lds
    v_max_f32 v102, 0, v102
    s_waitcnt lgkmcnt(2)
    v_mfma_f32_32x32x16_bf16 v[48:63], v[44:47], v[140:143], v[48:63]
    ds_read_b128 v[40:43], v4 offset:38912
    v_max_f32 v103, 0, v103
    v_mul_f32 v96, v96, v104
    v_mul_f32 v97, v97, v105
    s_waitcnt lgkmcnt(2)
    v_mfma_f32_32x32x16_bf16 v[48:63], v[32:35], v[144:147], v[48:63]
    ds_read_b128 v[44:47], v4 offset:39936
    v_mul_f32 v98, v98, v106
    v_mul_f32 v99, v99, v107
    v_mul_f32 v100, v100, v108
    s_waitcnt lgkmcnt(2)
    v_mfma_f32_32x32x16_bf16 v[48:63], v[36:39], v[148:151], v[48:63]
    ds_read_b128 v[32:35], v4 offset:40960
    v_mul_f32 v101, v101, v109
    v_mul_f32 v102, v102, v110
    v_mul_f32 v103, v103, v111
    s_waitcnt lgkmcnt(2)
    v_mfma_f32_32x32x16_bf16 v[48:63], v[40:43], v[152:155], v[48:63]
    ds_read_b128 v[36:39], v4 offset:41984
    buffer_load_dwordx4 v1, s[4:7], s97 offen offset:2048 sc1  lds
    v_cvt_pk_bf16_f32 v104, v96, v97
    s_waitcnt lgkmcnt(2)
    v_mfma_f32_32x32x16_bf16 v[48:63], v[44:47], v[156:159], v[48:63]
    ds_read_b128 v[40:43], v4 offset:43008
    v_cvt_pk_bf16_f32 v105, v98, v99
    v_cvt_pk_bf16_f32 v106, v100, v101
    v_cvt_pk_bf16_f32 v107, v102, v103
    s_waitcnt lgkmcnt(2)
    v_mfma_f32_32x32x16_bf16 v[48:63], v[32:35], v[160:163], v[48:63]
    ds_read_b128 v[44:47], v4 offset:44032
    s_add_u32 s59, s92, 32768
    buffer_store_dwordx4 v[104:107], v1, s[4:7], s59 offen offset:0 sc1
    s_waitcnt lgkmcnt(2)
    v_mfma_f32_32x32x16_bf16 v[48:63], v[36:39], v[164:167], v[48:63]
    ds_read_b128 v[32:35], v4 offset:45056
    buffer_load_dwordx4 v1, s[4:7], s97 offen offset:3072 sc1  lds
    v_max_f32 v112, 0, v112
    s_waitcnt lgkmcnt(2)
    v_mfma_f32_32x32x16_bf16 v[48:63], v[40:43], v[168:171], v[48:63]
    ds_read_b128 v[36:39], v4 offset:46080
    v_max_f32 v113, 0, v113
    v_max_f32 v114, 0, v114
    v_max_f32 v115, 0, v115
    s_waitcnt lgkmcnt(2)
    v_mfma_f32_32x32x16_bf16 v[48:63], v[44:47], v[172:175], v[48:63]
    ds_read_b128 v[40:43], v4 offset:47104
    v_max_f32 v116, 0, v116
    v_max_f32 v117, 0, v117
    v_max_f32 v118, 0, v118
    s_waitcnt lgkmcnt(2)
    v_mfma_f32_32x32x16_bf16 v[48:63], v[32:35], v[176:179], v[48:63]
    ds_read_b128 v[44:47], v4 offset:48128
    s_add_u32 s97, s99, 0x0
    s_add_u32 m0, s83, 0x4000
    v_max_f32 v119, 0, v119
    v_mul_f32 v112, v112, v120
    s_waitcnt lgkmcnt(2)
    v_mfma_f32_32x32x16_bf16 v[48:63], v[36:39], v[180:183], v[48:63]
    ds_read_b128 v[32:35], v4 offset:49152
    buffer_load_dwordx4 v1, s[4:7], s97 offen offset:0 sc1  lds
    v_mul_f32 v113, v113, v121
    s_waitcnt lgkmcnt(2)
    v_mfma_f32_32x32x16_bf16 v[48:63], v[40:43], v[184:187], v[48:63]
    ds_read_b128 v[36:39], v4 offset:50176
    v_mul_f32 v114, v114, v122
    v_mul_f32 v115, v115, v123
    v_mul_f32 v116, v116, v124
    s_waitcnt lgkmcnt(2)
    v_mfma_f32_32x32x16_bf16 v[48:63], v[44:47], v[188:191], v[48:63]
    ds_read_b128 v[40:43], v4 offset:51200
    v_mul_f32 v117, v117, v125
    v_mul_f32 v118, v118, v126
    v_mul_f32 v119, v119, v127
    s_waitcnt lgkmcnt(2)
    v_mfma_f32_32x32x16_bf16 v[48:63], v[32:35], v[192:195], v[48:63]
    ds_read_b128 v[44:47], v4 offset:52224
    buffer_load_dwordx4 v1, s[4:7], s97 offen offset:1024 sc1  lds
    v_cvt_pk_bf16_f32 v120, v112, v113
    s_waitcnt lgkmcnt(2)
    v_mfma_f32_32x32x16_bf16 v[48:63], v[36:39], v[196:199], v[48:63]
    ds_read_b128 v[32:35], v4 offset:53248
    v_cvt_pk_bf16_f32 v121, v114, v115
    v_cvt_pk_bf16_f32 v122, v116, v117
    v_cvt_pk_bf16_f32 v123, v118, v119
    s_waitcnt lgkmcnt(2)
    v_mfma_f32_32x32x16_bf16 v[48:63], v[40:43], v[200:203], v[48:63]
    ds_read_b128 v[36:39], v4 offset:54272
    s_add_u32 s59, s92, 49152
    buffer_store_dwordx4 v[120:123], v1, s[4:7], s59 offen offset:0 sc1
    s_waitcnt lgkmcnt(2)
    v_mfma_f32_32x32x16_bf16 v[48:63], v[44:47], v[204:207], v[48:63]
    ds_read_b128 v[40:43], v4 offset:55296
    v_max_f32 v80, 0, v80
    v_max_f32 v81, 0, v81
    v_max_f32 v82, 0, v82
    s_waitcnt lgkmcnt(2)
    v_mfma_f32_32x32x16_bf16 v[48:63], v[32:35], v[208:211], v[48:63]
    ds_read_b128 v[44:47], v4 offset:56320
    buffer_load_dwordx4 v1, s[4:7], s97 offen offset:2048 sc1  lds
    v_max_f32 v83, 0, v83
    s_waitcnt lgkmcnt(2)
    v_mfma_f32_32x32x16_bf16 v[48:63], v[36:39], v[212:215], v[48:63]
    ds_read_b128 v[32:35], v4 offset:57344
    v_max_f32 v84, 0, v84
    v_max_f32 v85, 0, v85
    v_max_f32 v86, 0, v86
    s_waitcnt lgkmcnt(2)
    v_mfma_f32_32x32x16_bf16 v[48:63], v[40:43], v[216:219], v[48:63]
    ds_read_b128 v[36:39], v4 offset:58368
    v_max_f32 v87, 0, v87
    v_mul_f32 v80, v80, v88
    v_mul_f32 v81, v81, v89
    s_waitcnt lgkmcnt(2)
    v_mfma_f32_32x32x16_bf16 v[48:63], v[44:47], v[220:223], v[48:63]
    ds_read_b128 v[40:43], v4 offset:59392
    buffer_load_dwordx4 v1, s[4:7], s97 offen offset:3072 sc1  lds
    v_mul_f32 v82, v82, v90
    s_waitcnt lgkmcnt(2)
    v_mfma_f32_32x32x16_bf16 v[48:63], v[32:35], v[224:227], v[48:63]
    ds_read_b128 v[44:47], v4 offset:60416
    v_mul_f32 v83, v83, v91
    v_mul_f32 v84, v84, v92
    v_mul_f32 v85, v85, v93
    s_waitcnt lgkmcnt(2)
    v_mfma_f32_32x32x16_bf16 v[48:63], v[36:39], v[228:231], v[48:63]
    ds_read_b128 v[32:35], v4 offset:61440
    v_mul_f32 v86, v86, v94
    v_mul_f32 v87, v87, v95
    v_cvt_pk_bf16_f32 v88, v80, v81
    s_waitcnt lgkmcnt(2)
    v_mfma_f32_32x32x16_bf16 v[48:63], v[40:43], v[232:235], v[48:63]
    ds_read_b128 v[36:39], v4 offset:62464
    s_add_u32 s97, s99, 0x8000
    s_add_u32 m0, s83, 0xc000
    v_cvt_pk_bf16_f32 v89, v82, v83
    v_cvt_pk_bf16_f32 v90, v84, v85
    s_waitcnt lgkmcnt(2)
    v_mfma_f32_32x32x16_bf16 v[48:63], v[44:47], v[236:239], v[48:63]
    ds_read_b128 v[40:43], v4 offset:63488
    buffer_load_dwordx4 v1, s[4:7], s97 offen offset:0 sc1  lds
    v_cvt_pk_bf16_f32 v91, v86, v87
    s_waitcnt lgkmcnt(2)
    v_mfma_f32_32x32x16_bf16 v[48:63], v[32:35], v[240:243], v[48:63]
    ds_read_b128 v[44:47], v4 offset:64512
    s_add_u32 s59, s92, 65536
    buffer_store_dwordx4 v[88:91], v1, s[4:7], s59 offen offset:0 sc1
    s_waitcnt lgkmcnt(2)
    v_mfma_f32_32x32x16_bf16 v[48:63], v[36:39], v[244:247], v[48:63]
    s_waitcnt vmcnt(16)
    s_barrier
    ds_read_b128 v[32:35], v4 offset:0
    s_waitcnt lgkmcnt(2)
    v_mfma_f32_32x32x16_bf16 v[48:63], v[40:43], v[248:251], v[48:63]
    ds_read_b128 v[36:39], v4 offset:1024
    buffer_load_dwordx4 v1, s[4:7], s97 offen offset:1024 sc1  lds
    s_waitcnt lgkmcnt(2)
    v_mfma_f32_32x32x16_bf16 v[48:63], v[44:47], v[252:255], v[48:63]
    ds_read_b128 v[40:43], v4 offset:2048
    s_waitcnt lgkmcnt(2)
    v_mfma_f32_32x32x16_bf16 v[64:79], v[32:35], v[128:131], 0
    ds_read_b128 v[44:47], v4 offset:3072
    s_waitcnt lgkmcnt(2)
    v_mfma_f32_32x32x16_bf16 v[64:79], v[36:39], v[132:135], v[64:79]
    ds_read_b128 v[32:35], v4 offset:4096
    s_nop 1
    v_max_f32 v48, 0, v48
    v_max_f32 v49, 0, v49
    v_max_f32 v50, 0, v50
    s_waitcnt lgkmcnt(2)
    v_mfma_f32_32x32x16_bf16 v[64:79], v[40:43], v[136:139], v[64:79]
    ds_read_b128 v[36:39], v4 offset:5120
    buffer_load_dwordx4 v1, s[4:7], s97 offen offset:2048 sc1  lds
    v_max_f32 v51, 0, v51
    s_waitcnt lgkmcnt(2)
    v_mfma_f32_32x32x16_bf16 v[64:79], v[44:47], v[140:143], v[64:79]
    ds_read_b128 v[40:43], v4 offset:6144
    v_max_f32 v52, 0, v52
    v_max_f32 v53, 0, v53
    v_max_f32 v54, 0, v54
    s_waitcnt lgkmcnt(2)
    v_mfma_f32_32x32x16_bf16 v[64:79], v[32:35], v[144:147], v[64:79]
    ds_read_b128 v[44:47], v4 offset:7168
    v_max_f32 v55, 0, v55
    v_mul_f32 v48, v48, v56
    v_mul_f32 v49, v49, v57
    s_waitcnt lgkmcnt(2)
    v_mfma_f32_32x32x16_bf16 v[64:79], v[36:39], v[148:151], v[64:79]
    ds_read_b128 v[32:35], v4 offset:8192
    buffer_load_dwordx4 v1, s[4:7], s97 offen offset:3072 sc1  lds
    v_mul_f32 v50, v50, v58
    s_waitcnt lgkmcnt(2)
    v_mfma_f32_32x32x16_bf16 v[64:79], v[40:43], v[152:155], v[64:79]
    ds_read_b128 v[36:39], v4 offset:9216
    v_mul_f32 v51, v51, v59
    v_mul_f32 v52, v52, v60
    v_mul_f32 v53, v53, v61
    s_waitcnt lgkmcnt(2)
    v_mfma_f32_32x32x16_bf16 v[64:79], v[44:47], v[156:159], v[64:79]
    ds_read_b128 v[40:43], v4 offset:10240
    v_mul_f32 v54, v54, v62
    v_mul_f32 v55, v55, v63
    v_cvt_pk_bf16_f32 v56, v48, v49
    s_waitcnt lgkmcnt(2)
    v_mfma_f32_32x32x16_bf16 v[64:79], v[32:35], v[160:163], v[64:79]
    ds_read_b128 v[44:47], v4 offset:11264
    s_add_u32 s97, s79, 0x8000
    s_add_u32 m0, s84, 0x8000
    v_cvt_pk_bf16_f32 v57, v50, v51
    v_cvt_pk_bf16_f32 v58, v52, v53
    s_waitcnt lgkmcnt(2)
    v_mfma_f32_32x32x16_bf16 v[64:79], v[36:39], v[164:167], v[64:79]
    ds_read_b128 v[32:35], v4 offset:12288
    buffer_load_dwordx4 v1, s[4:7], s97 offen offset:0 sc1  lds
    v_cvt_pk_bf16_f32 v59, v54, v55
    s_waitcnt lgkmcnt(2)
    v_mfma_f32_32x32x16_bf16 v[64:79], v[40:43], v[168:171], v[64:79]
    ds_read_b128 v[36:39], v4 offset:13312
WZ4:
    s_cbranch_execz WZ8
    s_add_u32 s59, s92, 81920
    buffer_store_dwordx4 v[56:59], v1, s[4:7], s59 offen offset:0 sc1
    s_waitcnt lgkmcnt(2)
    v_mfma_f32_32x32x16_bf16 v[64:79], v[44:47], v[172:175], v[64:79]
    ds_read_b128 v[40:43], v4 offset:14336
    s_add_u32 s97, s48, 0x8000
    s_add_u32 m0, s84, 0xc000
    v_add_f32 v16, v16, v24
    s_waitcnt lgkmcnt(2)
    v_mfma_f32_32x32x16_bf16 v[64:79], v[32:35], v[176:179], v[64:79]
    ds_read_b128 v[44:47], v4 offset:15360
    buffer_load_dwordx4 v1, s[4:7], s97 offen offset:0 sc1  lds
    v_add_f32 v17, v17, v25
    s_waitcnt lgkmcnt(2)
    v_mfma_f32_32x32x16_bf16 v[64:79], v[36:39], v[180:183], v[64:79]
    ds_read_b128 v[32:35], v4 offset:16384
    v_add_f32 v18, v18, v26
    v_add_f32 v19, v19, v27
    v_add_f32 v20, v20, v28
    s_waitcnt lgkmcnt(2)
    v_mfma_f32_32x32x16_bf16 v[64:79], v[40:43], v[184:187], v[64:79]
    ds_read_b128 v[36:39], v4 offset:17408
    v_add_f32 v21, v21, v29
    v_add_f32 v22, v22, v30
    v_add_f32 v23, v23, v31
    s_waitcnt lgkmcnt(2)
    v_mfma_f32_32x32x16_bf16 v[64:79], v[44:47], v[188:191], v[64:79]
    ds_read_b128 v[40:43], v4 offset:18432
    s_add_u32 s97, s79, 0x8000
    s_add_u32 m0, s84, 0x8000
    v_add_f32 v16, v16, v20
    v_add_f32 v17, v17, v21
    s_waitcnt lgkmcnt(2)
    v_mfma_f32_32x32x16_bf16 v[64:79], v[32:35], v[192:195], v[64:79]
    ds_read_b128 v[44:47], v4 offset:19456
    buffer_load_dwordx4 v1, s[4:7], s97 offen offset:1024 sc1  lds
    v_add_f32 v18, v18, v22
    s_waitcnt lgkmcnt(2)
    v_mfma_f32_32x32x16_bf16 v[64:79], v[36:39], v[196:199], v[64:79]
    ds_read_b128 v[32:35], v4 offset:20480
    v_add_f32 v19, v19, v23
    s_waitcnt lgkmcnt(2)
    v_mfma_f32_32x32x16_bf16 v[64:79], v[40:43], v[200:203], v[64:79]
    ds_read_b128 v[36:39], v4 offset:21504
    s_add_u32 s97, s48, 0x8000
    s_add_u32 m0, s84, 0xc000
    v_permlane32_swap_b32 v16, v18
    s_waitcnt lgkmcnt(2)
    v_mfma_f32_32x32x16_bf16 v[64:79], v[44:47], v[204:207], v[64:79]
    ds_read_b128 v[40:43], v4 offset:22528
    buffer_load_dwordx4 v1, s[4:7], s97 offen offset:1024 sc1  lds
    s_waitcnt lgkmcnt(2)
    v_mfma_f32_32x32x16_bf16 v[64:79], v[32:35], v[208:211], v[64:79]
    ds_read_b128 v[44:47], v4 offset:23552
    v_permlane32_swap_b32 v17, v19
    s_waitcnt lgkmcnt(2)
    v_mfma_f32_32x32x16_bf16 v[64:79], v[36:39], v[212:215], v[64:79]
    ds_read_b128 v[32:35], v4 offset:24576
    v_add_f32 v16, v16, v18
    s_waitcnt lgkmcnt(2)
    v_mfma_f32_32x32x16_bf16 v[64:79], v[40:43], v[216:219], v[64:79]
    ds_read_b128 v[36:39], v4 offset:25600
    v_add_f32 v17, v17, v19
    s_waitcnt lgkmcnt(2)
    v_mfma_f32_32x32x16_bf16 v[64:79], v[44:47], v[220:223], v[64:79]
    ds_read_b128 v[40:43], v4 offset:26624
    v_permlane16_swap_b32 v16, v17
    s_waitcnt lgkmcnt(2)
    v_mfma_f32_32x32x16_bf16 v[64:79], v[32:35], v[224:227], v[64:79]
    ds_read_b128 v[44:47], v4 offset:27648
    v_add_f32 v16, v16, v17
    s_waitcnt lgkmcnt(2)
    v_mfma_f32_32x32x16_bf16 v[64:79], v[36:39], v[228:231], v[64:79]
    ds_read_b128 v[32:35], v4 offset:28672
    v_mul_f32 v16, 0x3b000000, v16
    s_waitcnt lgkmcnt(2)
    v_mfma_f32_32x32x16_bf16 v[64:79], v[40:43], v[232:235], v[64:79]
    ds_read_b128 v[36:39], v4 offset:29696
    v_mov_b32 v17, v16
    s_waitcnt lgkmcnt(2)
    v_mfma_f32_32x32x16_bf16 v[64:79], v[44:47], v[236:239], v[64:79]
    ds_read_b128 v[40:43], v4 offset:30720
    v_permlane32_swap_b32 v16, v17
    s_waitcnt lgkmcnt(2)
    v_mfma_f32_32x32x16_bf16 v[64:79], v[32:35], v[240:243], v[64:79]
    ds_read_b128 v[44:47], v4 offset:31744
    v_fma_f32 v17, -v16, v16, v17
    s_waitcnt lgkmcnt(2)
    v_mfma_f32_32x32x16_bf16 v[64:79], v[36:39], v[244:247], v[64:79]
    s_waitcnt vmcnt(10)
    s_barrier
    ds_read_b128 v[32:35], v1 offset:0
    v_max_f32 v17, 0, v17
    s_waitcnt lgkmcnt(2)
    v_mfma_f32_32x32x16_bf16 v[64:79], v[40:43], v[248:251], v[64:79]
    ds_read_b128 v[36:39], v1 offset:1024
    v_add_f32 v17, 0x3727c5ac, v17
    s_waitcnt lgkmcnt(2)
    v_mfma_f32_32x32x16_bf16 v[64:79], v[44:47], v[252:255], v[64:79]
    ds_read_b128 v[40:43], v1 offset:2048
    v_rsq_f32 v6, v17
    s_waitcnt lgkmcnt(2)
    v_mfma_f32_32x32x16_bf16 v[96:111], v[32:35], v[128:131], 0
    ds_read_b128 v[44:47], v1 offset:3072
    v_mul_f32 v6, v6, v6
    s_waitcnt lgkmcnt(2)
    v_mfma_f32_32x32x16_bf16 v[96:111], v[36:39], v[132:135], v[96:111]
    ds_read_b128 v[32:35], v1 offset:4096
    s_nop 1
    v_max_f32 v64, 0, v64
    v_max_f32 v65, 0, v65
    v_max_f32 v66, 0, v66
    s_waitcnt lgkmcnt(2)
    v_mfma_f32_32x32x16_bf16 v[96:111], v[40:43], v[136:139], v[96:111]
    ds_read_b128 v[36:39], v1 offset:5120
    v_max_f32 v67, 0, v67
    v_max_f32 v68, 0, v68
    v_max_f32 v69, 0, v69
    s_waitcnt lgkmcnt(2)
    v_mfma_f32_32x32x16_bf16 v[96:111], v[44:47], v[140:143], v[96:111]
    ds_read_b128 v[40:43], v1 offset:6144
    s_add_u32 s33, s74, 4
    v_mov_b32 v14, s33
    v_max_f32 v70, 0, v70
    v_max_f32 v71, 0, v71
    s_waitcnt lgkmcnt(2)
    v_mfma_f32_32x32x16_bf16 v[96:111], v[32:35], v[144:147], v[96:111]
    ds_read_b128 v[44:47], v1 offset:7168
    s_cmp_lg_u32 s36, 0
    s_waitcnt vmcnt(8)
    s_mov_b64 exec, 1
    s_cbranch_scc1 SIGS_20
    buffer_store_dword v14, off, s[4:7], s76
SIGB_21:
    s_mov_b64 exec, -1
    s_waitcnt lgkmcnt(2)
    v_mfma_f32_32x32x16_bf16 v[96:111], v[36:39], v[148:151], v[96:111]
    ds_read_b128 v[32:35], v1 offset:8192
    v_mul_f32 v64, v64, v72
    v_mul_f32 v65, v65, v73
    v_mul_f32 v66, v66, v74
    s_waitcnt lgkmcnt(2)
    v_mfma_f32_32x32x16_bf16 v[96:111], v[40:43], v[152:155], v[96:111]
    ds_read_b128 v[36:39], v1 offset:9216
    v_mul_f32 v67, v67, v75
    v_mul_f32 v68, v68, v76
    v_mul_f32 v69, v69, v77
    s_waitcnt lgkmcnt(2)
    v_mfma_f32_32x32x16_bf16 v[96:111], v[44:47], v[156:159], v[96:111]
    ds_read_b128 v[40:43], v1 offset:10240
    v_mul_f32 v70, v70, v78
    v_mul_f32 v71, v71, v79
    v_cvt_pk_bf16_f32 v72, v64, v65
    s_waitcnt lgkmcnt(2)
    v_mfma_f32_32x32x16_bf16 v[96:111], v[32:35], v[160:163], v[96:111]
    ds_read_b128 v[44:47], v1 offset:11264
    v_cvt_pk_bf16_f32 v73, v66, v67
    v_cvt_pk_bf16_f32 v74, v68, v69
    v_cvt_pk_bf16_f32 v75, v70, v71
    s_waitcnt lgkmcnt(2)
    v_mfma_f32_32x32x16_bf16 v[96:111], v[36:39], v[164:167], v[96:111]
    ds_read_b128 v[32:35], v1 offset:12288
    s_add_u32 s59, s92, 98304
    buffer_store_dwordx4 v[72:75], v1, s[4:7], s59 offen offset:0 sc1
    s_waitcnt lgkmcnt(2)
    v_mfma_f32_32x32x16_bf16 v[96:111], v[40:43], v[168:171], v[96:111]
    ds_read_b128 v[36:39], v1 offset:13312
    s_waitcnt lgkmcnt(2)
    v_mfma_f32_32x32x16_bf16 v[96:111], v[44:47], v[172:175], v[96:111]
    ds_read_b128 v[40:43], v1 offset:14336
    s_waitcnt lgkmcnt(2)
    v_mfma_f32_32x32x16_bf16 v[96:111], v[32:35], v[176:179], v[96:111]
    ds_read_b128 v[44:47], v1 offset:15360
    s_waitcnt lgkmcnt(2)
    v_mfma_f32_32x32x16_bf16 v[96:111], v[36:39], v[180:183], v[96:111]
    ds_read_b128 v[32:35], v1 offset:16384
    s_waitcnt lgkmcnt(2)
    v_mfma_f32_32x32x16_bf16 v[96:111], v[40:43], v[184:187], v[96:111]
    ds_read_b128 v[36:39], v1 offset:17408
    s_waitcnt lgkmcnt(2)
    v_mfma_f32_32x32x16_bf16 v[96:111], v[44:47], v[188:191], v[96:111]
    ds_read_b128 v[40:43], v1 offset:18432
    s_waitcnt lgkmcnt(2)
    v_mfma_f32_32x32x16_bf16 v[96:111], v[32:35], v[192:195], v[96:111]
    ds_read_b128 v[44:47], v1 offset:19456
    s_waitcnt lgkmcnt(2)
    v_mfma_f32_32x32x16_bf16 v[96:111], v[36:39], v[196:199], v[96:111]
    ds_read_b128 v[32:35], v1 offset:20480
    s_waitcnt lgkmcnt(2)
    v_mfma_f32_32x32x16_bf16 v[96:111], v[40:43], v[200:203], v[96:111]
    ds_read_b128 v[36:39], v1 offset:21504
    s_waitcnt lgkmcnt(2)
    v_mfma_f32_32x32x16_bf16 v[96:111], v[44:47], v[204:207], v[96:111]
    ds_read_b128 v[40:43], v1 offset:22528
    s_waitcnt lgkmcnt(2)
    v_mfma_f32_32x32x16_bf16 v[96:111], v[32:35], v[208:211], v[96:111]
    ds_read_b128 v[44:47], v1 offset:23552
    s_waitcnt lgkmcnt(2)
    v_mfma_f32_32x32x16_bf16 v[96:111], v[36:39], v[212:215], v[96:111]
    ds_read_b128 v[32:35], v1 offset:24576
    s_waitcnt lgkmcnt(2)
    v_mfma_f32_32x32x16_bf16 v[96:111], v[40:43], v[216:219], v[96:111]
    ds_read_b128 v[36:39], v1 offset:25600
    buffer_load_dword v7, v12, s[4:7], s75 offen sc1
    s_waitcnt lgkmcnt(2)
    v_mfma_f32_32x32x16_bf16 v[96:111], v[44:47], v[220:223], v[96:111]
    ds_read_b128 v[40:43], v1 offset:26624
    s_waitcnt lgkmcnt(2)
    v_mfma_f32_32x32x16_bf16 v[96:111], v[32:35], v[224:227], v[96:111]
    ds_read_b128 v[44:47], v1 offset:27648
    s_waitcnt lgkmcnt(2)
    v_mfma_f32_32x32x16_bf16 v[96:111], v[36:39], v[228:231], v[96:111]
    ds_read_b128 v[32:35], v1 offset:28672
    s_waitcnt lgkmcnt(2)
    v_mfma_f32_32x32x16_bf16 v[96:111], v[40:43], v[232:235], v[96:111]
    ds_read_b128 v[36:39], v1 offset:29696
    s_waitcnt lgkmcnt(2)
    v_mfma_f32_32x32x16_bf16 v[96:111], v[44:47], v[236:239], v[96:111]
    ds_read_b128 v[40:43], v1 offset:30720
    s_waitcnt lgkmcnt(2)
    v_mfma_f32_32x32x16_bf16 v[96:111], v[32:35], v[240:243], v[96:111]
    ds_read_b128 v[44:47], v1 offset:31744
    s_waitcnt lgkmcnt(2)
    v_mfma_f32_32x32x16_bf16 v[96:111], v[36:39], v[244:247], v[96:111]
    s_waitcnt vmcnt(8)
    s_barrier
    ds_read_b128 v[32:35], v1 offset:32768
    s_add_u32 s33, s74, 5
    v_mov_b32 v14, s33
    s_waitcnt lgkmcnt(2)
    v_mfma_f32_32x32x16_bf16 v[96:111], v[40:43], v[248:251], v[96:111]
    ds_read_b128 v[36:39], v1 offset:33792
    s_cmp_lg_u32 s36, 0
    s_waitcnt vmcnt(1)
    s_mov_b64 exec, 1
    s_cbranch_scc1 SIGS_22
    buffer_store_dword v14, off, s[4:7], s76
SIGB_23:
    s_mov_b64 exec, -1
    s_waitcnt lgkmcnt(2)
    v_mfma_f32_32x32x16_bf16 v[96:111], v[44:47], v[252:255], v[96:111]
    ds_read_b128 v[40:43], v1 offset:34816
    s_waitcnt lgkmcnt(2)
    v_mfma_f32_32x32x16_bf16 v[112:127], v[32:35], v[128:131], 0
    ds_read_b128 v[44:47], v1 offset:35840
    s_add_u32 s33, s74, 4
    s_waitcnt vmcnt(1)
    v_cmp_gt_u32 vcc, s33, v7
    s_and_b64 vcc, vcc, s[60:61]
    s_or_b64 vcc, vcc, s[36:37]
    s_cbranch_scc1 PFS_24
PFB_25:
    s_add_u32 s98, s94, 32768
    s_waitcnt lgkmcnt(2)
    v_mfma_f32_32x32x16_bf16 v[112:127], v[36:39], v[132:135], v[112:127]
    ds_read_b128 v[32:35], v1 offset:36864
    buffer_load_dwordx4 v[128:131], v1, s[4:7], s98 offen offset:0 sc1
    v_max_f32 v96, 0, v96
    v_max_f32 v97, 0, v97
    s_waitcnt lgkmcnt(2)
    v_mfma_f32_32x32x16_bf16 v[112:127], v[40:43], v[136:139], v[112:127]
    ds_read_b128 v[36:39], v1 offset:37888
    s_add_u32 s96, s93, 32768
    v_max_f32 v98, 0, v98
    v_max_f32 v99, 0, v99
    v_max_f32 v100, 0, v100
    s_waitcnt lgkmcnt(2)
    v_mfma_f32_32x32x16_bf16 v[112:127], v[44:47], v[140:143], v[112:127]
    ds_read_b128 v[40:43], v1 offset:38912
    buffer_load_dwordx4 v[132:135], v1, s[4:7], s96 offen offset:0 sc1
    v_max_f32 v101, 0, v101
    v_max_f32 v102, 0, v102
    s_waitcnt lgkmcnt(2)
    v_mfma_f32_32x32x16_bf16 v[112:127], v[32:35], v[144:147], v[112:127]
    ds_read_b128 v[44:47], v1 offset:39936
    v_max_f32 v103, 0, v103
    v_mul_f32 v96, v96, v104
    v_mul_f32 v97, v97, v105
    s_waitcnt lgkmcnt(2)
    v_mfma_f32_32x32x16_bf16 v[112:127], v[36:39], v[148:151], v[112:127]
    ds_read_b128 v[32:35], v1 offset:40960
    buffer_load_dwordx4 v[136:139], v1, s[4:7], s98 offen offset:1024 sc1
    v_mul_f32 v98, v98, v106
    v_mul_f32 v99, v99, v107
    s_waitcnt lgkmcnt(2)
    v_mfma_f32_32x32x16_bf16 v[112:127], v[40:43], v[152:155], v[112:127]
    ds_read_b128 v[36:39], v1 offset:41984
    v_mul_f32 v100, v100, v108
    v_mul_f32 v101, v101, v109
    v_mul_f32 v102, v102, v110
    s_waitcnt lgkmcnt(2)
    v_mfma_f32_32x32x16_bf16 v[112:127], v[44:47], v[156:159], v[112:127]
    ds_read_b128 v[40:43], v1 offset:43008
    buffer_load_dwordx4 v[140:143], v1, s[4:7], s96 offen offset:1024 sc1
    v_mul_f32 v103, v103, v111
    v_cvt_pk_bf16_f32 v104, v96, v97
    s_waitcnt lgkmcnt(2)
    v_mfma_f32_32x32x16_bf16 v[112:127], v[32:35], v[160:163], v[112:127]
    ds_read_b128 v[44:47], v1 offset:44032
    v_cvt_pk_bf16_f32 v105, v98, v99
    v_cvt_pk_bf16_f32 v106, v100, v101
    v_cvt_pk_bf16_f32 v107, v102, v103
    s_waitcnt lgkmcnt(2)
    v_mfma_f32_32x32x16_bf16 v[112:127], v[36:39], v[164:167], v[112:127]
    ds_read_b128 v[32:35], v1 offset:45056
    buffer_load_dwordx4 v[144:147], v1, s[4:7], s98 offen offset:2048 sc1
    s_add_u32 s59, s92, 0
    s_waitcnt lgkmcnt(2)
    v_mfma_f32_32x32x16_bf16 v[112:127], v[40:43], v[168:171], v[112:127]
    ds_read_b128 v[36:39], v1 offset:46080
    buffer_store_dwordx4 v[104:107], v1, s[4:7], s59 offen offset:0 nt
    s_waitcnt lgkmcnt(2)
    v_mfma_f32_32x32x16_bf16 v[112:127], v[44:47], v[172:175], v[112:127]
    ds_read_b128 v[40:43], v1 offset:47104
    buffer_load_dwordx4 v[148:151], v1, s[4:7], s96 offen offset:2048 sc1
    s_waitcnt lgkmcnt(2)
    v_mfma_f32_32x32x16_bf16 v[112:127], v[32:35], v[176:179], v[112:127]
    ds_read_b128 v[44:47], v1 offset:48128
    s_waitcnt lgkmcnt(2)
    v_mfma_f32_32x32x16_bf16 v[112:127], v[36:39], v[180:183], v[112:127]
    ds_read_b128 v[32:35], v1 offset:49152
    buffer_load_dwordx4 v[152:155], v1, s[4:7], s98 offen offset:3072 sc1
    s_waitcnt lgkmcnt(2)
    v_mfma_f32_32x32x16_bf16 v[112:127], v[40:43], v[184:187], v[112:127]
    ds_read_b128 v[36:39], v1 offset:50176
    s_waitcnt lgkmcnt(2)
    v_mfma_f32_32x32x16_bf16 v[112:127], v[44:47], v[188:191], v[112:127]
    ds_read_b128 v[40:43], v1 offset:51200
    buffer_load_dwordx4 v[156:159], v1, s[4:7], s96 offen offset:3072 sc1
    s_waitcnt lgkmcnt(2)
    v_mfma_f32_32x32x16_bf16 v[112:127], v[32:35], v[192:195], v[112:127]
    ds_read_b128 v[44:47], v1 offset:52224
    s_add_u32 s98, s94, 49152
    s_waitcnt lgkmcnt(2)
    v_mfma_f32_32x32x16_bf16 v[112:127], v[36:39], v[196:199], v[112:127]
    ds_read_b128 v[32:35], v1 offset:53248
    buffer_load_dwordx4 v[160:163], v1, s[4:7], s98 offen offset:0 sc1
    s_waitcnt lgkmcnt(2)
    v_mfma_f32_32x32x16_bf16 v[112:127], v[40:43], v[200:203], v[112:127]
    ds_read_b128 v[36:39], v1 offset:54272
    s_add_u32 s96, s93, 49152
    s_waitcnt lgkmcnt(2)
    v_mfma_f32_32x32x16_bf16 v[112:127], v[44:47], v[204:207], v[112:127]
    ds_read_b128 v[40:43], v1 offset:55296
    buffer_load_dwordx4 v[164:167], v1, s[4:7], s96 offen offset:0 sc1
    s_waitcnt lgkmcnt(2)
    v_mfma_f32_32x32x16_bf16 v[112:127], v[32:35], v[208:211], v[112:127]
    ds_read_b128 v[44:47], v1 offset:56320
    buffer_load_dword v7, v12, s[4:7], s75 offen sc1
    s_waitcnt lgkmcnt(2)
    v_mfma_f32_32x32x16_bf16 v[112:127], v[36:39], v[212:215], v[112:127]
    ds_read_b128 v[32:35], v1 offset:57344
    buffer_load_dwordx4 v[168:171], v1, s[4:7], s98 offen offset:1024 sc1
    s_waitcnt lgkmcnt(2)
    v_mfma_f32_32x32x16_bf16 v[112:127], v[40:43], v[216:219], v[112:127]
    ds_read_b128 v[36:39], v1 offset:58368
    s_waitcnt lgkmcnt(2)
    v_mfma_f32_32x32x16_bf16 v[112:127], v[44:47], v[220:223], v[112:127]
    ds_read_b128 v[40:43], v1 offset:59392
    s_waitcnt lgkmcnt(2)
    v_mfma_f32_32x32x16_bf16 v[112:127], v[32:35], v[224:227], v[112:127]
    ds_read_b128 v[44:47], v1 offset:60416
    buffer_load_dwordx4 v[172:175], v1, s[4:7], s96 offen offset:1024 sc1
    s_waitcnt lgkmcnt(2)
    v_mfma_f32_32x32x16_bf16 v[112:127], v[36:39], v[228:231], v[112:127]
    ds_read_b128 v[32:35], v1 offset:61440
    s_waitcnt lgkmcnt(2)
    v_mfma_f32_32x32x16_bf16 v[112:127], v[40:43], v[232:235], v[112:127]
    ds_read_b128 v[36:39], v1 offset:62464
    buffer_load_dwordx4 v[176:179], v1, s[4:7], s98 offen offset:2048 sc1
    s_waitcnt lgkmcnt(2)
    v_mfma_f32_32x32x16_bf16 v[112:127], v[44:47], v[236:239], v[112:127]
    ds_read_b128 v[40:43], v1 offset:63488
    s_waitcnt lgkmcnt(2)
    v_mfma_f32_32x32x16_bf16 v[112:127], v[32:35], v[240:243], v[112:127]
    ds_read_b128 v[44:47], v1 offset:64512
    buffer_load_dwordx4 v[180:183], v1, s[4:7], s96 offen offset:2048 sc1
    s_waitcnt lgkmcnt(2)
    v_mfma_f32_32x32x16_bf16 v[112:127], v[36:39], v[244:247], v[112:127]
    s_waitcnt lgkmcnt(1)
    v_mfma_f32_32x32x16_bf16 v[112:127], v[40:43], v[248:251], v[112:127]
    buffer_load_dwordx4 v[184:187], v1, s[4:7], s98 offen offset:3072 sc1
    s_waitcnt lgkmcnt(0)
    v_mfma_f32_32x32x16_bf16 v[112:127], v[44:47], v[252:255], v[112:127]
    s_waitcnt vmcnt(16)
    v_mfma_f32_32x32x16_bf16 v[32:47], a[0:3], v[128:131], 0
    buffer_load_dwordx4 v[188:191], v1, s[4:7], s96 offen offset:3072 sc1
    v_mfma_f32_32x32x16_bf16 v[48:63], a[112:115], v[128:131], 0
    s_add_u32 s98, s94, 65536
    s_nop 1
    v_max_f32 v112, 0, v112
    v_max_f32 v113, 0, v113
    v_max_f32 v114, 0, v114
    v_max_f32 v115, 0, v115
    s_waitcnt vmcnt(16)
    v_mfma_f32_32x32x16_bf16 v[16:31], a[112:115], v[132:135], 0
    buffer_load_dwordx4 v[192:195], v1, s[4:7], s98 offen offset:0 sc1
    v_max_f32 v116, 0, v116
    v_max_f32 v117, 0, v117
    v_max_f32 v118, 0, v118
    v_mfma_f32_32x32x16_bf16 v[64:79], a[0:3], v[132:135], 0
    s_add_u32 s96, s93, 65536
    v_max_f32 v119, 0, v119
    v_mul_f32 v112, v112, v120
    v_mul_f32 v113, v113, v121
    v_mul_f32 v114, v114, v122
    s_waitcnt vmcnt(16)
    v_mfma_f32_32x32x16_bf16 v[32:47], a[28:31], v[136:139], v[32:47]
    buffer_load_dwordx4 v[196:199], v1, s[4:7], s96 offen offset:0 sc1
    v_mul_f32 v115, v115, v123
    v_mul_f32 v116, v116, v124
    v_mul_f32 v117, v117, v125
    v_mfma_f32_32x32x16_bf16 v[48:63], a[140:143], v[136:139], v[48:63]
    s_add_u32 s33, s74, 6
    v_mov_b32 v14, s33
    v_mul_f32 v118, v118, v126
    v_mul_f32 v119, v119, v127
    v_cvt_pk_bf16_f32 v120, v112, v113
    s_waitcnt vmcnt(16)
    v_mfma_f32_32x32x16_bf16 v[16:31], a[140:143], v[140:143], v[16:31]
    s_cmp_lg_u32 s36, 0
    s_waitcnt vmcnt(14)
    s_mov_b64 exec, 1
    s_cbranch_scc1 SIGS_28
    buffer_store_dword v14, off, s[4:7], s76
SIGB_29:
    s_mov_b64 exec, -1
    v_mfma_f32_32x32x16_bf16 v[64:79], a[28:31], v[140:143], v[64:79]
    buffer_load_dwordx4 v[200:203], v1, s[4:7], s98 offen offset:1024 sc1
    v_cvt_pk_bf16_f32 v121, v114, v115
    v_cvt_pk_bf16_f32 v122, v116, v117
    v_cvt_pk_bf16_f32 v123, v118, v119
    v_mfma_f32_32x32x16_bf16 v[32:47], a[56:59], v[144:147], v[32:47]
    s_add_u32 s59, s92, 16384
    buffer_store_dwordx4 v[120:123], v1, s[4:7], s59 offen offset:0 nt
    v_mfma_f32_32x32x16_bf16 v[48:63], a[168:171], v[144:147], v[48:63]
    buffer_load_dwordx4 v[204:207], v1, s[4:7], s96 offen offset:1024 sc1
    s_waitcnt vmcnt(17)
    v_mfma_f32_32x32x16_bf16 v[16:31], a[168:171], v[148:151], v[16:31]
    v_mfma_f32_32x32x16_bf16 v[64:79], a[56:59], v[148:151], v[64:79]
    buffer_load_dwordx4 v[208:211], v1, s[4:7], s98 offen offset:2048 sc1
    s_waitcnt vmcnt(17)
    v_mfma_f32_32x32x16_bf16 v[32:47], a[84:87], v[152:155], v[32:47]
    s_add_u32 s33, s74, 5
    s_waitcnt vmcnt(13)
    v_cmp_gt_u32 vcc, s33, v7
    s_and_b64 vcc, vcc, s[60:61]
    s_or_b64 vcc, vcc, s[36:37]
    s_cbranch_scc1 PFS_30
PFB_31:
    v_mfma_f32_32x32x16_bf16 v[48:63], a[196:199], v[152:155], v[48:63]
    v_mfma_f32_32x32x16_bf16 v[16:31], a[196:199], v[156:159], v[16:31]
    buffer_load_dwordx4 v[212:215], v1, s[4:7], s96 offen offset:2048 sc1
    v_mfma_f32_32x32x16_bf16 v[64:79], a[84:87], v[156:159], v[64:79]
    v_mfma_f32_32x32x16_bf16 v[32:47], a[4:7], v[160:163], v[32:47]
    buffer_load_dwordx4 v[216:219], v1, s[4:7], s98 offen offset:3072 sc1
    v_lshl_add_u32 v8, s68, 1, v5
    v_xor_b32 v9, 8192, v8
    v_xor_b32 v10, 16384, v8
    v_mfma_f32_32x32x16_bf16 v[48:63], a[116:119], v[160:163], v[48:63]
    v_xor_b32 v11, 24576, v8
    v_accvgpr_read_b32 v112, a224
    v_accvgpr_read_b32 v113, a225
    v_mfma_f32_32x32x16_bf16 v[16:31], a[116:119], v[164:167], v[16:31]
    buffer_load_dwordx4 v[220:223], v1, s[4:7], s96 offen offset:3072 sc1
    v_accvgpr_read_b32 v114, a226
    v_accvgpr_read_b32 v115, a227
    v_accvgpr_read_b32 v116, a228
    v_mfma_f32_32x32x16_bf16 v[64:79], a[4:7], v[164:167], v[64:79]
    s_add_u32 s98, s94, 81920
    v_accvgpr_read_b32 v117, a229
    v_accvgpr_read_b32 v118, a230
    v_accvgpr_read_b32 v119, a231
    s_waitcnt vmcnt(15)
    v_mfma_f32_32x32x16_bf16 v[32:47], a[32:35], v[168:171], v[32:47]
    buffer_load_dwordx4 v[224:227], v1, s[4:7], s98 offen offset:0 sc1
    v_accvgpr_read_b32 v120, a232
    v_accvgpr_read_b32 v121, a233
    v_accvgpr_read_b32 v122, a234
    v_mfma_f32_32x32x16_bf16 v[48:63], a[144:147], v[168:171], v[48:63]
    s_add_u32 s33, s74, 7
    v_mov_b32 v14, s33
    v_accvgpr_read_b32 v123, a235
    v_accvgpr_read_b32 v124, a236
    v_accvgpr_read_b32 v125, a237
    s_waitcnt vmcnt(15)
    v_mfma_f32_32x32x16_bf16 v[16:31], a[144:147], v[172:175], v[16:31]
    s_cmp_lg_u32 s36, 0
    s_waitcnt vmcnt(6)
    s_mov_b64 exec, 1
    s_cbranch_scc1 SIGS_34
    buffer_store_dword v14, off, s[4:7], s76
SIGB_35:
    s_mov_b64 exec, -1
    s_add_u32 s96, s93, 81920
    v_mfma_f32_32x32x16_bf16 v[64:79], a[32:35], v[172:175], v[64:79]
    buffer_load_dwordx4 v[228:231], v1, s[4:7], s96 offen offset:0 sc1
    v_accvgpr_read_b32 v126, a238
    v_accvgpr_read_b32 v127, a239
    v_mfma_f32_32x32x16_bf16 v[32:47], a[60:63], v[176:179], v[32:47]
    v_mfma_f32_32x32x16_bf16 v[48:63], a[172:175], v[176:179], v[48:63]
    buffer_load_dwordx4 v[232:235], v1, s[4:7], s98 offen offset:1024 sc1
    v_mfma_f32_32x32x16_bf16 v[16:31], a[172:175], v[180:183], v[16:31]
    v_mfma_f32_32x32x16_bf16 v[64:79], a[60:63], v[180:183], v[64:79]
    buffer_load_dwordx4 v[236:239], v1, s[4:7], s96 offen offset:1024 sc1
    v_mfma_f32_32x32x16_bf16 v[32:47], a[88:91], v[184:187], v[32:47]
    buffer_load_dword v7, v12, s[4:7], s75 offen sc1
    v_mfma_f32_32x32x16_bf16 v[48:63], a[200:203], v[184:187], v[48:63]
    buffer_load_dwordx4 v[240:243], v1, s[4:7], s98 offen offset:2048 sc1
    v_mfma_f32_32x32x16_bf16 v[16:31], a[200:203], v[188:191], v[16:31]
    v_mfma_f32_32x32x16_bf16 v[64:79], a[88:91], v[188:191], v[64:79]
    buffer_load_dwordx4 v[244:247], v1, s[4:7], s96 offen offset:2048 sc1
    v_mfma_f32_32x32x16_bf16 v[32:47], a[8:11], v[192:195], v[32:47]
    v_mfma_f32_32x32x16_bf16 v[48:63], a[120:123], v[192:195], v[48:63]
    buffer_load_dwordx4 v[248:251], v1, s[4:7], s98 offen offset:3072 sc1
    v_mfma_f32_32x32x16_bf16 v[16:31], a[120:123], v[196:199], v[16:31]
    v_mfma_f32_32x32x16_bf16 v[64:79], a[8:11], v[196:199], v[64:79]
    v_mfma_f32_32x32x16_bf16 v[32:47], a[36:39], v[200:203], v[32:47]
    buffer_load_dwordx4 v[252:255], v1, s[4:7], s96 offen offset:3072 sc1
    v_mfma_f32_32x32x16_bf16 v[48:63], a[148:151], v[200:203], v[48:63]
    s_add_u32 s98, s94, 98304
    s_waitcnt vmcnt(14)
    v_mfma_f32_32x32x16_bf16 v[16:31], a[148:151], v[204:207], v[16:31]
    buffer_load_dwordx4 v[128:131], v1, s[4:7], s98 offen offset:0 sc1
    v_mfma_f32_32x32x16_bf16 v[64:79], a[36:39], v[204:207], v[64:79]
    s_add_u32 s96, s93, 98304
    s_waitcnt vmcnt(14)
    v_mfma_f32_32x32x16_bf16 v[32:47], a[64:67], v[208:211], v[32:47]
    buffer_load_dwordx4 v[132:135], v1, s[4:7], s96 offen offset:0 sc1
    v_mfma_f32_32x32x16_bf16 v[48:63], a[176:179], v[208:211], v[48:63]
    s_waitcnt vmcnt(14)
    v_mfma_f32_32x32x16_bf16 v[16:31], a[176:179], v[212:215], v[16:31]
    buffer_load_dwordx4 v[136:139], v1, s[4:7], s98 offen offset:1024 sc1
    v_mfma_f32_32x32x16_bf16 v[64:79], a[64:67], v[212:215], v[64:79]
    s_waitcnt vmcnt(14)
    v_mfma_f32_32x32x16_bf16 v[32:47], a[92:95], v[216:219], v[32:47]
    buffer_load_dwordx4 v[140:143], v1, s[4:7], s96 offen offset:1024 sc1
    v_mfma_f32_32x32x16_bf16 v[48:63], a[204:207], v[216:219], v[48:63]
    s_waitcnt vmcnt(14)
    v_mfma_f32_32x32x16_bf16 v[16:31], a[204:207], v[220:223], v[16:31]
    buffer_load_dwordx4 v[144:147], v1, s[4:7], s98 offen offset:2048 sc1
    v_mfma_f32_32x32x16_bf16 v[64:79], a[92:95], v[220:223], v[64:79]
    s_waitcnt vmcnt(14)
    v_mfma_f32_32x32x16_bf16 v[32:47], a[12:15], v[224:227], v[32:47]
    s_add_u32 s33, s74, 6
    s_waitcnt vmcnt(9)
    v_cmp_gt_u32 vcc, s33, v7
    s_and_b64 vcc, vcc, s[60:61]
    s_or_b64 vcc, vcc, s[36:37]
    s_cbranch_scc1 PFS_36
PFB_37:
    v_mfma_f32_32x32x16_bf16 v[48:63], a[124:127], v[224:227], v[48:63]
    buffer_load_dwordx4 v[148:151], v1, s[4:7], s96 offen offset:2048 sc1
    v_mfma_f32_32x32x16_bf16 v[16:31], a[124:127], v[228:231], v[16:31]
    v_mfma_f32_32x32x16_bf16 v[64:79], a[12:15], v[228:231], v[64:79]
    buffer_load_dwordx4 v[152:155], v1, s[4:7], s98 offen offset:3072 sc1
    v_mfma_f32_32x32x16_bf16 v[32:47], a[40:43], v[232:235], v[32:47]
    v_mfma_f32_32x32x16_bf16 v[48:63], a[152:155], v[232:235], v[48:63]
    buffer_load_dword v7, v12, s[4:7], s75 offen sc1
    buffer_load_dwordx4 v[156:159], v1, s[4:7], s96 offen offset:3072 sc1
    v_mfma_f32_32x32x16_bf16 v[16:31], a[152:155], v[236:239], v[16:31]
    v_mfma_f32_32x32x16_bf16 v[64:79], a[40:43], v[236:239], v[64:79]
    s_add_u32 s98, s94, 0
    s_waitcnt vmcnt(12)
    v_mfma_f32_32x32x16_bf16 v[32:47], a[68:71], v[240:243], v[32:47]
    buffer_load_dwordx4 v[160:163], v1, s[4:7], s98 offen offset:0 sc1
    v_mfma_f32_32x32x16_bf16 v[48:63], a[180:183], v[240:243], v[48:63]
    s_waitcnt vmcnt(12)
    v_mfma_f32_32x32x16_bf16 v[16:31], a[180:183], v[244:247], v[16:31]
    buffer_load_dwordx4 v[164:167], v1, s[4:7], s98 offen offset:1024 sc1
    v_mfma_f32_32x32x16_bf16 v[64:79], a[68:71], v[244:247], v[64:79]
    s_waitcnt vmcnt(12)
    v_mfma_f32_32x32x16_bf16 v[32:47], a[96:99], v[248:251], v[32:47]
    buffer_load_dwordx4 v[168:171], v1, s[4:7], s98 offen offset:2048 sc1
    v_mfma_f32_32x32x16_bf16 v[48:63], a[208:211], v[248:251], v[48:63]
    s_waitcnt vmcnt(12)
    v_mfma_f32_32x32x16_bf16 v[16:31], a[208:211], v[252:255], v[16:31]
    buffer_load_dwordx4 v[172:175], v1, s[4:7], s98 offen offset:3072 sc1
    v_mfma_f32_32x32x16_bf16 v[64:79], a[96:99], v[252:255], v[64:79]
    s_waitcnt vmcnt(12)
    v_mfma_f32_32x32x16_bf16 v[32:47], a[16:19], v[128:131], v[32:47]
    s_add_u32 s33, s74, 7
    s_waitcnt vmcnt(5)
    v_cmp_gt_u32 vcc, s33, v7
    s_and_b64 vcc, vcc, s[60:61]
    s_or_b64 vcc, vcc, s[36:37]
    s_cbranch_scc1 PFS_40
PFB_41:
    s_add_u32 s96, s93, 0
    v_mfma_f32_32x32x16_bf16 v[48:63], a[128:131], v[128:131], v[48:63]
    buffer_load_dwordx4 v[176:179], v1, s[4:7], s96 offen offset:0 sc1
    v_mfma_f32_32x32x16_bf16 v[16:31], a[128:131], v[132:135], v[16:31]
    v_mfma_f32_32x32x16_bf16 v[64:79], a[16:19], v[132:135], v[64:79]
    buffer_load_dwordx4 v[180:183], v1, s[4:7], s96 offen offset:1024 sc1
    v_mfma_f32_32x32x16_bf16 v[32:47], a[44:47], v[136:139], v[32:47]
    v_mfma_f32_32x32x16_bf16 v[48:63], a[156:159], v[136:139], v[48:63]
    buffer_load_dwordx4 v[184:187], v1, s[4:7], s96 offen offset:2048 sc1
    v_mfma_f32_32x32x16_bf16 v[16:31], a[156:159], v[140:143], v[16:31]
    v_mfma_f32_32x32x16_bf16 v[64:79], a[44:47], v[140:143], v[64:79]
    buffer_load_dwordx4 v[188:191], v1, s[4:7], s96 offen offset:3072 sc1
    v_mfma_f32_32x32x16_bf16 v[32:47], a[72:75], v[144:147], v[32:47]
    s_add_u32 s98, s94, 16384
    v_mfma_f32_32x32x16_bf16 v[48:63], a[184:187], v[144:147], v[48:63]
    buffer_load_dwordx4 v[192:195], v1, s[4:7], s98 offen offset:0 sc1
    v_mfma_f32_32x32x16_bf16 v[16:31], a[184:187], v[148:151], v[16:31]
    v_mfma_f32_32x32x16_bf16 v[64:79], a[72:75], v[148:151], v[64:79]
    buffer_load_dwordx4 v[196:199], v1, s[4:7], s98 offen offset:1024 sc1
    v_mfma_f32_32x32x16_bf16 v[32:47], a[100:103], v[152:155], v[32:47]
    v_mfma_f32_32x32x16_bf16 v[48:63], a[212:215], v[152:155], v[48:63]
    s_waitcnt vmcnt(10)
    v_mfma_f32_32x32x16_bf16 v[16:31], a[212:215], v[156:159], v[16:31]
    buffer_load_dwordx4 v[200:203], v1, s[4:7], s98 offen offset:2048 sc1
    v_mfma_f32_32x32x16_bf16 v[64:79], a[100:103], v[156:159], v[64:79]
    s_waitcnt vmcnt(10)
    v_mfma_f32_32x32x16_bf16 v[32:47], a[20:23], v[160:163], v[32:47]
    buffer_load_dwordx4 v[204:207], v1, s[4:7], s98 offen offset:3072 sc1
    v_mfma_f32_32x32x16_bf16 v[48:63], a[132:135], v[160:163], v[48:63]
    s_add_u32 s96, s93, 16384
    s_waitcnt vmcnt(10)
    v_mfma_f32_32x32x16_bf16 v[32:47], a[48:51], v[164:167], v[32:47]
    buffer_load_dwordx4 v[208:211], v1, s[4:7], s96 offen offset:0 sc1
    v_mfma_f32_32x32x16_bf16 v[48:63], a[160:163], v[164:167], v[48:63]
    s_waitcnt vmcnt(10)
    v_mfma_f32_32x32x16_bf16 v[32:47], a[76:79], v[168:171], v[32:47]
    buffer_load_dwordx4 v[212:215], v1, s[4:7], s96 offen offset:1024 sc1
    v_mfma_f32_32x32x16_bf16 v[48:63], a[188:191], v[168:171], v[48:63]
    s_waitcnt vmcnt(10)
    v_mfma_f32_32x32x16_bf16 v[32:47], a[104:107], v[172:175], v[32:47]
    buffer_load_dwordx4 v[216:219], v1, s[4:7], s96 offen offset:2048 sc1
    v_mfma_f32_32x32x16_bf16 v[48:63], a[216:219], v[172:175], v[48:63]
    s_waitcnt vmcnt(6)
    v_mfma_f32_32x32x16_bf16 v[32:47], a[24:27], v[192:195], v[32:47]
    buffer_load_dwordx4 v[220:223], v1, s[4:7], s96 offen offset:3072 sc1
    s_waitcnt vmcnt(6)
    v_mfma_f32_32x32x16_bf16 v[32:47], a[52:55], v[196:199], v[32:47]
    s_waitcnt vmcnt(5)
    v_mfma_f32_32x32x16_bf16 v[32:47], a[80:83], v[200:203], v[32:47]
    s_add_u32 s97, s79, 0x8000
    s_add_u32 m0, s84, 0x8000
    s_waitcnt vmcnt(4)
    v_mfma_f32_32x32x16_bf16 v[32:47], a[108:111], v[204:207], v[32:47]
    buffer_load_dwordx4 v1, s[4:7], s97 offen offset:2048 sc1  lds
WZ5:
    s_cbranch_execz WZ9
    v_mfma_f32_32x32x16_bf16 v[48:63], a[136:139], v[192:195], v[48:63]
    v_mfma_f32_32x32x16_bf16 v[48:63], a[164:167], v[196:199], v[48:63]
    s_add_u32 s97, s48, 0x8000
    s_add_u32 m0, s84, 0xc000
    v_mfma_f32_32x32x16_bf16 v[48:63], a[192:195], v[200:203], v[48:63]
    buffer_load_dwordx4 v1, s[4:7], s97 offen offset:2048 sc1  lds
    v_cvt_pk_bf16_f32 v32, v32, v33
    v_cvt_pk_bf16_f32 v33, v34, v35
    v_cvt_pk_bf16_f32 v34, v36, v37
    v_cvt_pk_bf16_f32 v35, v38, v39
    v_mfma_f32_32x32x16_bf16 v[48:63], a[220:223], v[204:207], v[48:63]
    s_add_u32 s97, s79, 0x8000
    s_add_u32 m0, s84, 0x8000
    ds_write_b128 v10, v[32:35] offset:0
    v_cvt_pk_bf16_f32 v36, v40, v41
    v_cvt_pk_bf16_f32 v37, v42, v43
    v_cvt_pk_bf16_f32 v38, v44, v45
    v_cvt_pk_bf16_f32 v39, v46, v47
    v_mfma_f32_32x32x16_bf16 v[16:31], a[132:135], v[176:179], v[16:31]
    buffer_load_dwordx4 v1, s[4:7], s97 offen offset:3072 sc1  lds
    ds_write_b128 v10, v[36:39] offset:1024
    v_mfma_f32_32x32x16_bf16 v[16:31], a[160:163], v[180:183], v[16:31]
    v_mfma_f32_32x32x16_bf16 v[16:31], a[188:191], v[184:187], v[16:31]
    s_add_u32 s97, s48, 0x8000
    s_add_u32 m0, s84, 0xc000
    v_cvt_pk_bf16_f32 v48, v48, v49
    v_cvt_pk_bf16_f32 v49, v50, v51
    v_cvt_pk_bf16_f32 v50, v52, v53
    v_cvt_pk_bf16_f32 v51, v54, v55
    v_mfma_f32_32x32x16_bf16 v[16:31], a[216:219], v[188:191], v[16:31]
    buffer_load_dwordx4 v1, s[4:7], s97 offen offset:3072 sc1  lds
    ds_write_b128 v11, v[48:51] offset:2048
    v_cvt_pk_bf16_f32 v52, v56, v57
    v_cvt_pk_bf16_f32 v53, v58, v59
    v_cvt_pk_bf16_f32 v54, v60, v61
    v_cvt_pk_bf16_f32 v55, v62, v63
    s_waitcnt vmcnt(7)
    v_mfma_f32_32x32x16_bf16 v[16:31], a[136:139], v[208:211], v[16:31]
    s_add_u32 s97, s79, 0x0
    s_add_u32 m0, s84, 0x0
    ds_write_b128 v11, v[52:55] offset:3072
    s_waitcnt vmcnt(6)
    v_mfma_f32_32x32x16_bf16 v[16:31], a[164:167], v[212:215], v[16:31]
    buffer_load_dwordx4 v1, s[4:7], s97 offen offset:0 sc1  lds
    s_waitcnt vmcnt(6)
    v_mfma_f32_32x32x16_bf16 v[16:31], a[192:195], v[216:219], v[16:31]
    s_waitcnt vmcnt(5)
    v_mfma_f32_32x32x16_bf16 v[16:31], a[220:223], v[220:223], v[16:31]
    s_add_u32 s97, s48, 0x0
    s_add_u32 m0, s84, 0x4000
    v_mfma_f32_32x32x16_bf16 v[64:79], a[20:23], v[176:179], v[64:79]
    buffer_load_dwordx4 v1, s[4:7], s97 offen offset:0 sc1  lds
    s_waitcnt lgkmcnt(0)
    s_barrier
    ds_read_b128 v[80:83], v8 offset:0
    ds_read_b128 v[84:87], v8 offset:1024
    v_mfma_f32_32x32x16_bf16 v[64:79], a[48:51], v[180:183], v[64:79]
    s_add_u32 s97, s79, 0x0
    s_add_u32 m0, s84, 0x0
    ds_read_b128 v[88:91], v8 offset:2048
    ds_read_b128 v[92:95], v8 offset:3072
    v_mfma_f32_32x32x16_bf16 v[64:79], a[76:79], v[184:187], v[64:79]
    buffer_load_dwordx4 v1, s[4:7], s97 offen offset:1024 sc1  lds
    v_cvt_pk_bf16_f32 v16, v16, v17
    v_cvt_pk_bf16_f32 v17, v18, v19
    v_cvt_pk_bf16_f32 v18, v20, v21
    v_cvt_pk_bf16_f32 v19, v22, v23
    v_mfma_f32_32x32x16_bf16 v[64:79], a[104:107], v[188:191], v[64:79]
    ds_write_b128 v9, v[16:19] offset:4096
    v_cvt_pk_bf16_f32 v20, v24, v25
    v_cvt_pk_bf16_f32 v21, v26, v27
    v_cvt_pk_bf16_f32 v22, v28, v29
    v_cvt_pk_bf16_f32 v23, v30, v31
    v_mfma_f32_32x32x16_bf16 v[64:79], a[24:27], v[208:211], v[64:79]
    s_add_u32 s97, s48, 0x0
    s_add_u32 m0, s84, 0x4000
    ds_write_b128 v9, v[20:23] offset:5120
    v_mfma_f32_32x32x16_bf16 v[64:79], a[52:55], v[212:215], v[64:79]
    buffer_load_dwordx4 v1, s[4:7], s97 offen offset:1024 sc1  lds
    v_mfma_f32_32x32x16_bf16 v[64:79], a[80:83], v[216:219], v[64:79]
    s_add_u32 s97, s79, 0x0
    s_add_u32 m0, s84, 0x0
    v_mfma_f32_32x32x16_bf16 v[64:79], a[108:111], v[220:223], v[64:79]
    buffer_load_dwordx4 v1, s[4:7], s97 offen offset:2048 sc1  lds
    s_waitcnt lgkmcnt(5)
    v_mfma_f32_32x32x16_bf16 v[64:79], a[240:243], v[80:83], v[64:79]
    s_waitcnt lgkmcnt(0)
    s_barrier
    ds_read_b128 v[96:99], v8 offset:4096
    ds_read_b128 v[100:103], v8 offset:5120
    v_mfma_f32_32x32x16_bf16 v[64:79], a[244:247], v[84:87], v[64:79]
    s_add_u32 s97, s48, 0x0
    s_add_u32 m0, s84, 0x4000
    v_mfma_f32_32x32x16_bf16 v[64:79], a[240:243], v[88:91], v[64:79]
    buffer_load_dwordx4 v1, s[4:7], s97 offen offset:2048 sc1  lds
    v_mfma_f32_32x32x16_bf16 v[64:79], a[244:247], v[92:95], v[64:79]
    s_add_u32 s97, s79, 0x0
    s_add_u32 m0, s84, 0x0
    s_waitcnt lgkmcnt(1)
    v_mfma_f32_32x32x16_bf16 v[64:79], a[240:243], v[96:99], v[64:79]
    buffer_load_dwordx4 v1, s[4:7], s97 offen offset:3072 sc1  lds
    s_waitcnt lgkmcnt(0)
    v_mfma_f32_32x32x16_bf16 v[64:79], a[244:247], v[100:103], v[64:79]
    s_add_u32 s97, s48, 0x0
    s_add_u32 m0, s84, 0x4000
    s_nop 0
    buffer_load_dwordx4 v1, s[4:7], s97 offen offset:3072 sc1  lds
    s_nop 7
    v_pk_fma_f32 v[64:65], v[64:65], v[6:7], v[112:113] op_sel_hi:[1,0,1]
    v_pk_fma_f32 v[66:67], v[66:67], v[6:7], v[114:115] op_sel_hi:[1,0,1]
    v_pk_fma_f32 v[68:69], v[68:69], v[6:7], v[116:117] op_sel_hi:[1,0,1]
    v_pk_fma_f32 v[70:71], v[70:71], v[6:7], v[118:119] op_sel_hi:[1,0,1]
    v_pk_fma_f32 v[72:73], v[72:73], v[6:7], v[120:121] op_sel_hi:[1,0,1]
    v_pk_fma_f32 v[74:75], v[74:75], v[6:7], v[122:123] op_sel_hi:[1,0,1]
    v_pk_fma_f32 v[76:77], v[76:77], v[6:7], v[124:125] op_sel_hi:[1,0,1]
    v_pk_fma_f32 v[78:79], v[78:79], v[6:7], v[126:127] op_sel_hi:[1,0,1]
    v_cvt_pk_bf16_f32 v80, v64, v65
    v_cvt_pk_bf16_f32 v81, v66, v67
    v_cvt_pk_bf16_f32 v82, v68, v69
    v_cvt_pk_bf16_f32 v83, v70, v71
    v_cvt_pk_bf16_f32 v84, v72, v73
    v_cvt_pk_bf16_f32 v85, v74, v75
    v_cvt_pk_bf16_f32 v86, v76, v77
    v_cvt_pk_bf16_f32 v87, v78, v79
    s_add_u32 s33, s70, 0x0
    buffer_store_dwordx4 v[80:83], v1, s[4:7], s33 offen offset:0 nt
    buffer_store_dwordx4 v[84:87], v1, s[4:7], s33 offen offset:1024 nt
    v_pk_add_f32 v[8:9], v[64:65], v[66:67]
    v_pk_mul_f32 v[10:11], v[64:65], v[64:65]
    v_pk_fma_f32 v[10:11], v[66:67], v[66:67], v[10:11]
    v_pk_add_f32 v[8:9], v[8:9], v[68:69]
    v_pk_fma_f32 v[10:11], v[68:69], v[68:69], v[10:11]
    v_pk_add_f32 v[8:9], v[8:9], v[70:71]
    v_pk_fma_f32 v[10:11], v[70:71], v[70:71], v[10:11]
    v_pk_add_f32 v[8:9], v[8:9], v[72:73]
    v_pk_fma_f32 v[10:11], v[72:73], v[72:73], v[10:11]
    v_pk_add_f32 v[8:9], v[8:9], v[74:75]
    v_pk_fma_f32 v[10:11], v[74:75], v[74:75], v[10:11]
    v_pk_add_f32 v[8:9], v[8:9], v[76:77]
    v_pk_fma_f32 v[10:11], v[76:77], v[76:77], v[10:11]
    v_pk_add_f32 v[8:9], v[8:9], v[78:79]
    v_pk_fma_f32 v[10:11], v[78:79], v[78:79], v[10:11]
    v_add_f32 v8, v8, v9
    v_add_f32 v10, v10, v11
    s_add_u32 s34, s71, 0x0
    s_nop 0
    v_permlane32_swap_b32 v8, v10
    v_add_f32 v8, v8, v10
    buffer_store_dword v8, v3, s[4:7], s34 offen nt
    v_accvgpr_write_b32 a224, v64
    v_accvgpr_write_b32 a225, v65
    v_accvgpr_write_b32 a226, v66
    v_accvgpr_write_b32 a227, v67
    v_accvgpr_write_b32 a228, v68
    v_accvgpr_write_b32 a229, v69
    v_accvgpr_write_b32 a230, v70
    v_accvgpr_write_b32 a231, v71
    v_accvgpr_write_b32 a232, v72
    v_accvgpr_write_b32 a233, v73
    v_accvgpr_write_b32 a234, v74
    v_accvgpr_write_b32 a235, v75
    v_accvgpr_write_b32 a236, v76
    v_accvgpr_write_b32 a237, v77
    v_accvgpr_write_b32 a238, v78
    v_accvgpr_write_b32 a239, v79
    s_add_u32 s85, s85, 0x80000
    s_add_u32 s86, s86, 0x80000
    s_add_u32 s87, s87, 0x10000
    s_add_u32 s88, s88, 0x10000
    s_mov_b32 s63, s80
    s_mov_b32 s99, s49
    s_add_u32 s33, s74, 8
    v_mov_b32 v7, s33
    s_cmp_lg_u32 s36, 0
    s_waitcnt vmcnt(0)
    s_mov_b64 exec, 1
    s_cbranch_scc1 SIGS_44
    buffer_store_dword v7, off, s[4:7], s62
SIGB_45:
    s_mov_b64 exec, -1
    s_add_u32 s33, s74, 8
    s_mov_b32 s95, 0
    buffer_load_dword v7, v12, s[4:7], s75 offen offset:64 sc1
POLL_46:
    buffer_load_dword v255, v12, s[4:7], s75 offen offset:64 sc1
    s_add_u32 s95, s95, 1
    s_waitcnt vmcnt(1)
    v_cmp_gt_u32 vcc, s33, v7
    s_and_b64 vcc, vcc, 0xffff
    s_cbranch_scc0 PDONE_47
    buffer_load_dword v7, v12, s[4:7], s75 offen offset:64 sc1
    s_waitcnt vmcnt(1)
    v_cmp_gt_u32 vcc, s33, v255
    s_and_b64 vcc, vcc, 0xffff
    s_cbranch_scc0 PDONE_47
    s_cmp_lt_u32 s95, 400000
    s_cbranch_scc1 POLL_46
PDONE_47:
    s_cmp_lg_u32 s36, 0
    s_cbranch_scc1 ACQS_48
ACQB_49:
    s_mov_b32 s31, 1
    s_mov_b32 s74, 16
    s_xor_b32 s96, s72, 0x0
    buffer_load_dwordx4 v[128:131], v1, s[4:7], s96 offen offset:0 sc1
    buffer_load_dwordx4 v[132:135], v1, s[4:7], s96 offen offset:1024 sc1
    buffer_load_dwordx4 v[136:139], v1, s[4:7], s96 offen offset:2048 sc1
    buffer_load_dwordx4 v[140:143], v1, s[4:7], s96 offen offset:3072 sc1
    s_xor_b32 s96, s72, 0x1000
    buffer_load_dwordx4 v[144:147], v1, s[4:7], s96 offen offset:0 sc1
    buffer_load_dwordx4 v[148:151], v1, s[4:7], s96 offen offset:1024 sc1
    s_barrier
    ds_read_b128 v[80:83], v4 offset:0
    ds_read_b128 v[84:87], v4 offset:32768
    ds_read_b128 v[88:91], v4 offset:1024
    s_waitcnt vmcnt(5) lgkmcnt(2)
    v_mfma_f32_32x32x16_bf16 v[96:111], v[80:83], v[128:131], 0
    ds_read_b128 v[92:95], v4 offset:33792
    buffer_load_dwordx4 v[152:155], v1, s[4:7], s96 offen offset:2048 sc1
    s_waitcnt lgkmcnt(2)
    v_mfma_f32_32x32x16_bf16 v[112:127], v[84:87], v[128:131], 0
    ds_read_b128 v[80:83], v4 offset:2048
    s_waitcnt vmcnt(5) lgkmcnt(2)
    v_mfma_f32_32x32x16_bf16 v[96:111], v[88:91], v[132:135], v[96:111]
    ds_read_b128 v[84:87], v4 offset:34816
    buffer_load_dwordx4 v[156:159], v1, s[4:7], s96 offen offset:3072 sc1
    s_waitcnt lgkmcnt(2)
    v_mfma_f32_32x32x16_bf16 v[112:127], v[92:95], v[132:135], v[112:127]
    ds_read_b128 v[88:91], v4 offset:3072
    s_waitcnt vmcnt(5) lgkmcnt(2)
    v_mfma_f32_32x32x16_bf16 v[96:111], v[80:83], v[136:139], v[96:111]
    ds_read_b128 v[92:95], v4 offset:35840
    s_xor_b32 s96, s72, 0x2000
    buffer_load_dwordx4 v[160:163], v1, s[4:7], s96 offen offset:0 sc1
    s_waitcnt lgkmcnt(2)
    v_mfma_f32_32x32x16_bf16 v[112:127], v[84:87], v[136:139], v[112:127]
    ds_read_b128 v[80:83], v4 offset:4096
    s_waitcnt vmcnt(5) lgkmcnt(2)
    v_mfma_f32_32x32x16_bf16 v[96:111], v[88:91], v[140:143], v[96:111]
    ds_read_b128 v[84:87], v4 offset:36864
    buffer_load_dwordx4 v[164:167], v1, s[4:7], s96 offen offset:1024 sc1
    s_waitcnt lgkmcnt(2)
    v_mfma_f32_32x32x16_bf16 v[112:127], v[92:95], v[140:143], v[112:127]
    ds_read_b128 v[88:91], v4 offset:5120
    s_waitcnt vmcnt(5) lgkmcnt(2)
    v_mfma_f32_32x32x16_bf16 v[96:111], v[80:83], v[144:147], v[96:111]
    ds_read_b128 v[92:95], v4 offset:37888
    buffer_load_dwordx4 v[168:171], v1, s[4:7], s96 offen offset:2048 sc1
    s_waitcnt lgkmcnt(2)
    v_mfma_f32_32x32x16_bf16 v[112:127], v[84:87], v[144:147], v[112:127]
    ds_read_b128 v[80:83], v4 offset:6144
    s_waitcnt vmcnt(5) lgkmcnt(2)
    v_mfma_f32_32x32x16_bf16 v[96:111], v[88:91], v[148:151], v[96:111]
    ds_read_b128 v[84:87], v4 offset:38912
    buffer_load_dwordx4 v[172:175], v1, s[4:7], s96 offen offset:3072 sc1
    s_waitcnt lgkmcnt(2)
    v_mfma_f32_32x32x16_bf16 v[112:127], v[92:95], v[148:151], v[112:127]
    ds_read_b128 v[88:91], v4 offset:7168
    s_waitcnt vmcnt(5) lgkmcnt(2)
    v_mfma_f32_32x32x16_bf16 v[96:111], v[80:83], v[152:155], v[96:111]
    ds_read_b128 v[92:95], v4 offset:39936
    s_xor_b32 s96, s72, 0x3000
    buffer_load_dwordx4 v[176:179], v1, s[4:7], s96 offen offset:0 sc1
    s_waitcnt lgkmcnt(2)
    v_mfma_f32_32x32x16_bf16 v[112:127], v[84:87], v[152:155], v[112:127]
    ds_read_b128 v[80:83], v4 offset:8192
    s_waitcnt vmcnt(5) lgkmcnt(2)
    v_mfma_f32_32x32x16_bf16 v[96:111], v[88:91], v[156:159], v[96:111]
    ds_read_b128 v[84:87], v4 offset:40960
    buffer_load_dwordx4 v[180:183], v1, s[4:7], s96 offen offset:1024 sc1
    s_waitcnt lgkmcnt(2)
    v_mfma_f32_32x32x16_bf16 v[112:127], v[92:95], v[156:159], v[112:127]
    ds_read_b128 v[88:91], v4 offset:9216
    s_waitcnt vmcnt(5) lgkmcnt(2)
    v_mfma_f32_32x32x16_bf16 v[96:111], v[80:83], v[160:163], v[96:111]
    ds_read_b128 v[92:95], v4 offset:41984
    buffer_load_dwordx4 v[184:187], v1, s[4:7], s96 offen offset:2048 sc1
    s_waitcnt lgkmcnt(2)
    v_mfma_f32_32x32x16_bf16 v[112:127], v[84:87], v[160:163], v[112:127]
    ds_read_b128 v[80:83], v4 offset:10240
    s_waitcnt vmcnt(5) lgkmcnt(2)
    v_mfma_f32_32x32x16_bf16 v[96:111], v[88:91], v[164:167], v[96:111]
    ds_read_b128 v[84:87], v4 offset:43008
    buffer_load_dwordx4 v[188:191], v1, s[4:7], s96 offen offset:3072 sc1
    s_waitcnt lgkmcnt(2)
    v_mfma_f32_32x32x16_bf16 v[112:127], v[92:95], v[164:167], v[112:127]
    ds_read_b128 v[88:91], v4 offset:11264
    s_waitcnt vmcnt(5) lgkmcnt(2)
    v_mfma_f32_32x32x16_bf16 v[96:111], v[80:83], v[168:171], v[96:111]
    ds_read_b128 v[92:95], v4 offset:44032
    s_xor_b32 s96, s72, 0x4000
    buffer_load_dwordx4 v[192:195], v1, s[4:7], s96 offen offset:0 sc1
    v_mfma_f32_32x32x16_bf16 v[48:63], a[248:251], a[252:255], 0
    s_waitcnt lgkmcnt(2)
    v_mfma_f32_32x32x16_bf16 v[112:127], v[84:87], v[168:171], v[112:127]
    ds_read_b128 v[80:83], v4 offset:12288
    s_waitcnt vmcnt(5) lgkmcnt(2)
    v_mfma_f32_32x32x16_bf16 v[96:111], v[88:91], v[172:175], v[96:111]
    ds_read_b128 v[84:87], v4 offset:45056
    buffer_load_dwordx4 v[196:199], v1, s[4:7], s96 offen offset:1024 sc1
    s_waitcnt lgkmcnt(2)
    v_mfma_f32_32x32x16_bf16 v[112:127], v[92:95], v[172:175], v[112:127]
    ds_read_b128 v[88:91], v4 offset:13312
    s_waitcnt vmcnt(5) lgkmcnt(2)
    v_mfma_f32_32x32x16_bf16 v[96:111], v[80:83], v[176:179], v[96:111]
    ds_read_b128 v[92:95], v4 offset:46080
    buffer_load_dwordx4 v[200:203], v1, s[4:7], s96 offen offset:2048 sc1
    s_waitcnt lgkmcnt(2)
    v_mfma_f32_32x32x16_bf16 v[112:127], v[84:87], v[176:179], v[112:127]
    ds_read_b128 v[80:83], v4 offset:14336
    s_waitcnt vmcnt(5) lgkmcnt(2)
    v_mfma_f32_32x32x16_bf16 v[96:111], v[88:91], v[180:183], v[96:111]
    ds_read_b128 v[84:87], v4 offset:47104
    buffer_load_dwordx4 v[204:207], v1, s[4:7], s96 offen offset:3072 sc1
    s_waitcnt lgkmcnt(2)
    v_mfma_f32_32x32x16_bf16 v[112:127], v[92:95], v[180:183], v[112:127]
    ds_read_b128 v[88:91], v4 offset:15360
    s_waitcnt vmcnt(5) lgkmcnt(2)
    v_mfma_f32_32x32x16_bf16 v[96:111], v[80:83], v[184:187], v[96:111]
    ds_read_b128 v[92:95], v4 offset:48128
    s_xor_b32 s96, s72, 0x5000
    buffer_load_dwordx4 v[208:211], v1, s[4:7], s96 offen offset:0 sc1
    v_mfma_f32_32x32x16_bf16 v[64:79], a[248:251], a[252:255], 0
    s_waitcnt lgkmcnt(2)
    v_mfma_f32_32x32x16_bf16 v[112:127], v[84:87], v[184:187], v[112:127]
    ds_read_b128 v[80:83], v4 offset:16384
    buffer_load_dwordx4 v[16:19], v1, s[4:7], s73 offen offset:0 sc1
    s_waitcnt vmcnt(6) lgkmcnt(2)
    v_mfma_f32_32x32x16_bf16 v[96:111], v[88:91], v[188:191], v[96:111]
    ds_read_b128 v[84:87], v4 offset:49152
    buffer_load_dwordx4 v[212:215], v1, s[4:7], s96 offen offset:1024 sc1
    s_waitcnt lgkmcnt(2)
    v_mfma_f32_32x32x16_bf16 v[112:127], v[92:95], v[188:191], v[112:127]
    ds_read_b128 v[88:91], v4 offset:17408
    s_waitcnt vmcnt(6) lgkmcnt(2)
    v_mfma_f32_32x32x16_bf16 v[96:111], v[80:83], v[192:195], v[96:111]
    ds_read_b128 v[92:95], v4 offset:50176
    buffer_load_dwordx4 v[216:219], v1, s[4:7], s96 offen offset:2048 sc1
    s_waitcnt lgkmcnt(2)
    v_mfma_f32_32x32x16_bf16 v[112:127], v[84:87], v[192:195], v[112:127]
    ds_read_b128 v[80:83], v4 offset:18432
    buffer_load_dwordx4 v[20:23], v1, s[4:7], s73 offen offset:1024 sc1
    s_waitcnt vmcnt(7) lgkmcnt(2)
    v_mfma_f32_32x32x16_bf16 v[96:111], v[88:91], v[196:199], v[96:111]
    ds_read_b128 v[84:87], v4 offset:51200
    buffer_load_dwordx4 v[220:223], v1, s[4:7], s96 offen offset:3072 sc1
    s_waitcnt lgkmcnt(2)
    v_mfma_f32_32x32x16_bf16 v[112:127], v[92:95], v[196:199], v[112:127]
    ds_read_b128 v[88:91], v4 offset:19456
    s_waitcnt vmcnt(7) lgkmcnt(2)
    v_mfma_f32_32x32x16_bf16 v[96:111], v[80:83], v[200:203], v[96:111]
    ds_read_b128 v[92:95], v4 offset:52224
    s_xor_b32 s96, s72, 0x6000
    buffer_load_dwordx4 v[224:227], v1, s[4:7], s96 offen offset:0 sc1
    s_waitcnt lgkmcnt(2)
    v_mfma_f32_32x32x16_bf16 v[112:127], v[84:87], v[200:203], v[112:127]
    ds_read_b128 v[80:83], v4 offset:20480
    buffer_load_dwordx4 v[24:27], v1, s[4:7], s73 offen offset:2048 sc1
    s_waitcnt vmcnt(8) lgkmcnt(2)
    v_mfma_f32_32x32x16_bf16 v[96:111], v[88:91], v[204:207], v[96:111]
    ds_read_b128 v[84:87], v4 offset:53248
    buffer_load_dwordx4 v[228:231], v1, s[4:7], s96 offen offset:1024 sc1
    s_waitcnt lgkmcnt(2)
    v_mfma_f32_32x32x16_bf16 v[112:127], v[92:95], v[204:207], v[112:127]
    ds_read_b128 v[88:91], v4 offset:21504
    s_waitcnt vmcnt(8) lgkmcnt(2)
    v_mfma_f32_32x32x16_bf16 v[96:111], v[80:83], v[208:211], v[96:111]
    ds_read_b128 v[92:95], v4 offset:54272
    buffer_load_dwordx4 v[232:235], v1, s[4:7], s96 offen offset:2048 sc1
    s_waitcnt lgkmcnt(2)
    v_mfma_f32_32x32x16_bf16 v[112:127], v[84:87], v[208:211], v[112:127]
    ds_read_b128 v[80:83], v4 offset:22528
    buffer_load_dwordx4 v[28:31], v1, s[4:7], s73 offen offset:3072 sc1
    s_waitcnt vmcnt(8) lgkmcnt(2)
    v_mfma_f32_32x32x16_bf16 v[96:111], v[88:91], v[212:215], v[96:111]
    ds_read_b128 v[84:87], v4 offset:55296
    buffer_load_dwordx4 v[236:239], v1, s[4:7], s96 offen offset:3072 sc1
    s_waitcnt lgkmcnt(2)
    v_mfma_f32_32x32x16_bf16 v[112:127], v[92:95], v[212:215], v[112:127]
    ds_read_b128 v[88:91], v4 offset:23552
    s_waitcnt vmcnt(8) lgkmcnt(2)
    v_mfma_f32_32x32x16_bf16 v[96:111], v[80:83], v[216:219], v[96:111]
    ds_read_b128 v[92:95], v4 offset:56320
    s_xor_b32 s96, s72, 0x7000
    buffer_load_dwordx4 v[240:243], v1, s[4:7], s96 offen offset:0 sc1
    s_waitcnt lgkmcnt(2)
    v_mfma_f32_32x32x16_bf16 v[112:127], v[84:87], v[216:219], v[112:127]
    ds_read_b128 v[80:83], v4 offset:24576
    s_waitcnt vmcnt(7) lgkmcnt(2)
    v_mfma_f32_32x32x16_bf16 v[96:111], v[88:91], v[220:223], v[96:111]
    ds_read_b128 v[84:87], v4 offset:57344
    buffer_load_dwordx4 v[244:247], v1, s[4:7], s96 offen offset:1024 sc1
    s_waitcnt lgkmcnt(2)
    v_mfma_f32_32x32x16_bf16 v[112:127], v[92:95], v[220:223], v[112:127]
    ds_read_b128 v[88:91], v4 offset:25600
    s_waitcnt vmcnt(7) lgkmcnt(2)
    v_mfma_f32_32x32x16_bf16 v[96:111], v[80:83], v[224:227], v[96:111]
    ds_read_b128 v[92:95], v4 offset:58368
    buffer_load_dwordx4 v[248:251], v1, s[4:7], s96 offen offset:2048 sc1
    s_waitcnt lgkmcnt(2)
    v_mfma_f32_32x32x16_bf16 v[112:127], v[84:87], v[224:227], v[112:127]
    ds_read_b128 v[80:83], v4 offset:26624
    s_waitcnt vmcnt(6) lgkmcnt(2)
    v_mfma_f32_32x32x16_bf16 v[96:111], v[88:91], v[228:231], v[96:111]
    ds_read_b128 v[84:87], v4 offset:59392
    buffer_load_dwordx4 v[252:255], v1, s[4:7], s96 offen offset:3072 sc1
    s_waitcnt lgkmcnt(2)
    v_mfma_f32_32x32x16_bf16 v[112:127], v[92:95], v[228:231], v[112:127]
    ds_read_b128 v[88:91], v4 offset:27648
    s_waitcnt vmcnt(6) lgkmcnt(2)
    v_mfma_f32_32x32x16_bf16 v[96:111], v[80:83], v[232:235], v[96:111]
    ds_read_b128 v[92:95], v4 offset:60416
    s_add_u32 s97, s79, 0x10000
    s_add_u32 m0, s41, 0x0
    s_nop 0
    buffer_load_dwordx4 v1, s[4:7], s97 offen offset:0 sc1  lds
    s_waitcnt lgkmcnt(2)
    v_mfma_f32_32x32x16_bf16 v[112:127], v[84:87], v[232:235], v[112:127]
    ds_read_b128 v[80:83], v4 offset:28672
    s_waitcnt vmcnt(6)
    v_add_f32 v16, v16, v24
    v_add_f32 v17, v17, v25
    v_add_f32 v18, v18, v26
    s_waitcnt vmcnt(5) lgkmcnt(2)
    v_mfma_f32_32x32x16_bf16 v[96:111], v[88:91], v[236:239], v[96:111]
    ds_read_b128 v[84:87], v4 offset:61440
    v_add_f32 v19, v19, v27
    v_add_f32 v20, v20, v28
    buffer_load_dwordx4 v1, s[4:7], s97 offen offset:1024 sc1  lds
    s_waitcnt lgkmcnt(2)
    v_mfma_f32_32x32x16_bf16 v[112:127], v[92:95], v[236:239], v[112:127]
    ds_read_b128 v[88:91], v4 offset:29696
    v_add_f32 v21, v21, v29
    v_add_f32 v22, v22, v30
    v_add_f32 v23, v23, v31
    s_waitcnt vmcnt(5) lgkmcnt(2)
    v_mfma_f32_32x32x16_bf16 v[96:111], v[80:83], v[240:243], v[96:111]
    ds_read_b128 v[92:95], v4 offset:62464
    v_add_f32 v16, v16, v20
    v_add_f32 v17, v17, v21
    buffer_load_dwordx4 v1, s[4:7], s97 offen offset:2048 sc1  lds
    s_waitcnt lgkmcnt(2)
    v_mfma_f32_32x32x16_bf16 v[112:127], v[84:87], v[240:243], v[112:127]
    ds_read_b128 v[80:83], v4 offset:30720
    v_add_f32 v18, v18, v22
    v_add_f32 v19, v19, v23
    s_nop 0
    v_permlane32_swap_b32 v16, v18
    s_waitcnt vmcnt(5) lgkmcnt(2)
    v_mfma_f32_32x32x16_bf16 v[96:111], v[88:91], v[244:247], v[96:111]
    ds_read_b128 v[84:87], v4 offset:63488
    v_permlane32_swap_b32 v17, v19
    v_add_f32 v16, v16, v18
    buffer_load_dwordx4 v1, s[4:7], s97 offen offset:3072 sc1  lds
    s_waitcnt lgkmcnt(2)
    v_mfma_f32_32x32x16_bf16 v[112:127], v[92:95], v[244:247], v[112:127]
    ds_read_b128 v[88:91], v4 offset:31744
    v_add_f32 v17, v17, v19
    s_nop 1
    v_permlane16_swap_b32 v16, v17
    v_add_f32 v16, v16, v17
    s_waitcnt vmcnt(5) lgkmcnt(2)
    v_mfma_f32_32x32x16_bf16 v[96:111], v[80:83], v[248:251], v[96:111]
    ds_read_b128 v[92:95], v4 offset:64512
    v_mul_f32 v16, 0x3b000000, v16
    v_mov_b32 v17, v16
    s_add_u32 s97, s48, 0x10000
    s_add_u32 m0, s41, 0x4000
    s_nop 0
    buffer_load_dwordx4 v1, s[4:7], s97 offen offset:0 sc1  lds
    s_waitcnt lgkmcnt(2)
    v_mfma_f32_32x32x16_bf16 v[112:127], v[84:87], v[248:251], v[112:127]
    v_permlane32_swap_b32 v16, v17
    v_fma_f32 v17, -v16, v16, v17
    v_max_f32 v17, 0, v17
    s_waitcnt vmcnt(5) lgkmcnt(1)
    v_mfma_f32_32x32x16_bf16 v[96:111], v[88:91], v[252:255], v[96:111]
    v_add_f32 v17, 0x3727c5ac, v17
    v_rsq_f32 v6, v17
    buffer_load_dwordx4 v1, s[4:7], s97 offen offset:1024 sc1  lds
    s_waitcnt lgkmcnt(0)
    v_mfma_f32_32x32x16_bf16 v[112:127], v[92:95], v[252:255], v[112:127]
    s_barrier
    v_mul_f32 v14, 0x3fb8aa3b, v6
    buffer_load_dwordx4 v1, s[4:7], s97 offen offset:2048 sc1  lds
    s_nop 3
    v_max3_f32 v8, v96, v97, v98
    v_max3_f32 v9, v104, v105, v106
    v_max3_f32 v8, v8, v99, v100
    v_max3_f32 v9, v9, v107, v108
    v_max3_f32 v8, v8, v101, v102
    v_max3_f32 v9, v9, v109, v110
    v_max_f32 v8, v8, v103
    v_max_f32 v9, v9, v111
    v_min3_f32 v10, v96, v97, v98
    v_min3_f32 v11, v104, v105, v106
    v_min3_f32 v10, v10, v99, v100
    v_min3_f32 v11, v11, v107, v108
    v_min3_f32 v10, v10, v101, v102
    v_min3_f32 v11, v11, v109, v110
    v_min_f32 v10, v10, v103
    v_min_f32 v11, v11, v111
    v_pk_mul_f32 v[112:113], v[112:113], v[6:7] op_sel_hi:[1,0]
    v_pk_mul_f32 v[114:115], v[114:115], v[6:7] op_sel_hi:[1,0]
    v_pk_mul_f32 v[116:117], v[116:117], v[6:7] op_sel_hi:[1,0]
    buffer_load_dwordx4 v1, s[4:7], s97 offen offset:3072 sc1  lds
    v_pk_mul_f32 v[118:119], v[118:119], v[6:7] op_sel_hi:[1,0]
    v_pk_mul_f32 v[120:121], v[120:121], v[6:7] op_sel_hi:[1,0]
    v_pk_mul_f32 v[122:123], v[122:123], v[6:7] op_sel_hi:[1,0]
    v_pk_mul_f32 v[124:125], v[124:125], v[6:7] op_sel_hi:[1,0]
    v_pk_mul_f32 v[126:127], v[126:127], v[6:7] op_sel_hi:[1,0]
    v_cvt_pk_bf16_f32 v112, v112, v113
    v_cvt_pk_bf16_f32 v113, v114, v115
    v_cvt_pk_bf16_f32 v114, v116, v117
    v_cvt_pk_bf16_f32 v115, v118, v119
    v_cvt_pk_bf16_f32 v116, v120, v121
    v_cvt_pk_bf16_f32 v117, v122, v123
    v_mfma_f32_32x32x16_bf16 v[48:63], v[112:115], a[240:243], v[48:63]
    v_cvt_pk_bf16_f32 v118, v124, v125
    v_cvt_pk_bf16_f32 v119, v126, v127
    v_permlane32_swap_b32 v8, v9
    v_permlane32_swap_b32 v10, v11
    v_max_f32 v8, v8, v9
    v_min_f32 v10, v10, v11
    v_mul_f32 v8, v8, v14
    v_mul_f32 v10, v10, v14
    v_mfma_f32_32x32x16_bf16 v[64:79], v[116:119], a[240:243], v[64:79]
    v_mov_b32 v9, v8
    v_mov_b32 v11, v10
    s_nop 0
    v_permlane32_swap_b32 v8, v9
    v_permlane32_swap_b32 v10, v11
    v_fma_f32 v16, v96, v14, -v8
    v_fma_f32 v17, v97, v14, -v8
    v_fma_f32 v18, v98, v14, -v8
    v_fma_f32 v19, v99, v14, -v8
    v_fma_f32 v20, v100, v14, -v8
    v_fma_f32 v21, v101, v14, -v8
    v_fma_f32 v22, v102, v14, -v8
    v_fma_f32 v23, v103, v14, -v8
    v_fma_f32 v24, -v96, v14, v10
    v_fma_f32 v25, -v97, v14, v10
    v_fma_f32 v26, -v98, v14, v10
    v_fma_f32 v27, -v99, v14, v10
    v_fma_f32 v28, -v100, v14, v10
    v_cvt_pk_bf16_f32 v80, v48, v49
    v_cvt_pk_bf16_f32 v81, v50, v51
    v_cvt_pk_bf16_f32 v82, v52, v53
    v_cvt_pk_bf16_f32 v83, v54, v55
    v_cvt_pk_bf16_f32 v84, v56, v57
    v_cvt_pk_bf16_f32 v85, v58, v59
    v_cvt_pk_bf16_f32 v86, v60, v61
    v_cvt_pk_bf16_f32 v87, v62, v63
    v_fma_f32 v29, -v101, v14, v10
    v_fma_f32 v30, -v102, v14, v10
    v_fma_f32 v31, -v103, v14, v10
    v_fma_f32 v32, v104, v14, -v9
    v_fma_f32 v33, v105, v14, -v9
    v_fma_f32 v34, v106, v14, -v9
    v_fma_f32 v35, v107, v14, -v9
    v_fma_f32 v36, v108, v14, -v9
    v_fma_f32 v37, v109, v14, -v9
    v_fma_f32 v38, v110, v14, -v9
    v_cvt_pk_bf16_f32 v88, v64, v65
    v_cvt_pk_bf16_f32 v89, v66, v67
    v_cvt_pk_bf16_f32 v90, v68, v69
    v_cvt_pk_bf16_f32 v91, v70, v71
    v_cvt_pk_bf16_f32 v92, v72, v73
    v_cvt_pk_bf16_f32 v93, v74, v75
    v_cvt_pk_bf16_f32 v94, v76, v77
    v_cvt_pk_bf16_f32 v95, v78, v79
    v_fma_f32 v39, v111, v14, -v9
    v_fma_f32 v40, -v104, v14, v11
    v_fma_f32 v41, -v105, v14, v11
    v_fma_f32 v42, -v106, v14, v11
    v_fma_f32 v43, -v107, v14, v11
    v_fma_f32 v44, -v108, v14, v11
    v_fma_f32 v45, -v109, v14, v11
    v_fma_f32 v46, -v110, v14, v11
    v_fma_f32 v47, -v111, v14, v11
    v_exp_f32 v16, v16
    v_exp_f32 v17, v17
    v_exp_f32 v18, v18
    v_exp_f32 v19, v19
    v_exp_f32 v20, v20
    v_exp_f32 v21, v21
    v_exp_f32 v22, v22
    v_exp_f32 v23, v23
    v_exp_f32 v24, v24
    v_exp_f32 v25, v25
    v_exp_f32 v26, v26
    v_exp_f32 v27, v27
    v_exp_f32 v28, v28
    v_exp_f32 v29, v29
    v_exp_f32 v30, v30
    v_exp_f32 v31, v31
    v_exp_f32 v32, v32
    v_exp_f32 v33, v33
    v_exp_f32 v34, v34
    v_exp_f32 v35, v35
    v_exp_f32 v36, v36
    v_exp_f32 v37, v37
    v_exp_f32 v38, v38
    v_exp_f32 v39, v39
    v_exp_f32 v40, v40
    v_exp_f32 v41, v41
    v_exp_f32 v42, v42
    v_exp_f32 v43, v43
    v_exp_f32 v44, v44
    v_exp_f32 v45, v45
    v_exp_f32 v46, v46
    v_exp_f32 v47, v47
    v_pk_add_f32 v[96:97], v[16:17], v[18:19]
    v_pk_add_f32 v[98:99], v[20:21], v[22:23]
WZ6:
    s_cbranch_execz WZRET
    v_pk_add_f32 v[100:101], v[24:25], v[26:27]
    v_pk_add_f32 v[102:103], v[28:29], v[30:31]
    v_pk_add_f32 v[104:105], v[32:33], v[34:35]
    v_pk_add_f32 v[106:107], v[36:37], v[38:39]
    v_pk_add_f32 v[108:109], v[40:41], v[42:43]
    v_pk_add_f32 v[110:111], v[44:45], v[46:47]
    v_pk_add_f32 v[96:97], v[96:97], v[98:99]
    v_pk_add_f32 v[100:101], v[100:101], v[102:103]
    v_pk_add_f32 v[104:105], v[104:105], v[106:107]
    v_pk_add_f32 v[108:109], v[108:109], v[110:111]
    v_add_f32 v8, v96, v97
    v_add_f32 v9, v104, v105
    v_add_f32 v10, v100, v101
    v_add_f32 v11, v108, v109
    v_permlane32_swap_b32 v8, v9
    s_nop 0
    v_permlane32_swap_b32 v10, v11
    v_add_f32 v8, v8, v9
    v_add_f32 v10, v10, v11
    v_rcp_f32 v8, v8
    v_rcp_f32 v10, v10
    v_mov_b32 v9, v8
    v_mov_b32 v11, v10
    s_nop 0
    v_permlane32_swap_b32 v8, v9
    v_permlane32_swap_b32 v10, v11
    v_pk_mul_f32 v[16:17], v[16:17], v[8:9] op_sel:[0,0] op_sel_hi:[1,0]
    v_pk_mul_f32 v[18:19], v[18:19], v[8:9] op_sel:[0,0] op_sel_hi:[1,0]
    v_pk_mul_f32 v[20:21], v[20:21], v[8:9] op_sel:[0,0] op_sel_hi:[1,0]
    v_pk_mul_f32 v[22:23], v[22:23], v[8:9] op_sel:[0,0] op_sel_hi:[1,0]
    v_pk_mul_f32 v[24:25], v[24:25], v[10:11] op_sel:[0,0] op_sel_hi:[1,0]
    v_pk_mul_f32 v[26:27], v[26:27], v[10:11] op_sel:[0,0] op_sel_hi:[1,0]
    v_pk_mul_f32 v[28:29], v[28:29], v[10:11] op_sel:[0,0] op_sel_hi:[1,0]
    v_pk_mul_f32 v[30:31], v[30:31], v[10:11] op_sel:[0,0] op_sel_hi:[1,0]
    v_pk_mul_f32 v[32:33], v[32:33], v[8:9] op_sel:[0,1] op_sel_hi:[1,1]
    v_pk_mul_f32 v[34:35], v[34:35], v[8:9] op_sel:[0,1] op_sel_hi:[1,1]
    v_pk_mul_f32 v[36:37], v[36:37], v[8:9] op_sel:[0,1] op_sel_hi:[1,1]
    v_pk_mul_f32 v[38:39], v[38:39], v[8:9] op_sel:[0,1] op_sel_hi:[1,1]
    v_pk_mul_f32 v[40:41], v[40:41], v[10:11] op_sel:[0,1] op_sel_hi:[1,1]
    v_pk_mul_f32 v[42:43], v[42:43], v[10:11] op_sel:[0,1] op_sel_hi:[1,1]
    v_pk_mul_f32 v[44:45], v[44:45], v[10:11] op_sel:[0,1] op_sel_hi:[1,1]
    v_pk_mul_f32 v[46:47], v[46:47], v[10:11] op_sel:[0,1] op_sel_hi:[1,1]
    v_cvt_pk_bf16_f32 v112, v16, v17
    v_cvt_pk_bf16_f32 v113, v18, v19
    v_cvt_pk_bf16_f32 v114, v20, v21
    v_cvt_pk_bf16_f32 v115, v22, v23
    v_cvt_pk_bf16_f32 v116, v24, v25
    v_cvt_pk_bf16_f32 v117, v26, v27
    v_mfma_f32_32x32x16_bf16 v[48:63], v[112:115], a[240:243], 0
    v_cvt_pk_bf16_f32 v118, v28, v29
    v_cvt_pk_bf16_f32 v119, v30, v31
    v_cvt_pk_bf16_f32 v120, v32, v33
    v_cvt_pk_bf16_f32 v121, v34, v35
    v_mfma_f32_32x32x16_bf16 v[48:63], v[116:119], a[244:247], v[48:63]
    v_cvt_pk_bf16_f32 v122, v36, v37
    v_cvt_pk_bf16_f32 v123, v38, v39
    v_cvt_pk_bf16_f32 v124, v40, v41
    v_cvt_pk_bf16_f32 v125, v42, v43
    v_mfma_f32_32x32x16_bf16 v[64:79], v[120:123], a[240:243], 0
    v_cvt_pk_bf16_f32 v126, v44, v45
    v_cvt_pk_bf16_f32 v127, v46, v47
    v_add_u32 v8, s84, v1
    s_mul_i32 s33, s30, -3584
    s_add_u32 s33, s33, s84
    v_add_u32 v9, s33, v2
    v_mfma_f32_32x32x16_bf16 v[64:79], v[124:127], a[244:247], v[64:79]
    v_cvt_pk_bf16_f32 v96, v48, v49
    v_cvt_pk_bf16_f32 v97, v50, v51
    v_cvt_pk_bf16_f32 v98, v52, v53
    v_cvt_pk_bf16_f32 v99, v54, v55
    v_cvt_pk_bf16_f32 v100, v56, v57
    v_cvt_pk_bf16_f32 v101, v58, v59
    v_mfma_f32_32x32x16_bf16 v[16:31], v[80:83], v[96:99], 0
    v_cvt_pk_bf16_f32 v102, v60, v61
    v_cvt_pk_bf16_f32 v103, v62, v63
    s_nop 1
    v_mfma_f32_32x32x16_bf16 v[16:31], v[84:87], v[100:103], v[16:31]
    v_cvt_pk_bf16_f32 v104, v64, v65
    v_cvt_pk_bf16_f32 v105, v66, v67
    v_cvt_pk_bf16_f32 v106, v68, v69
    v_cvt_pk_bf16_f32 v107, v70, v71
    v_cvt_pk_bf16_f32 v108, v72, v73
    v_cvt_pk_bf16_f32 v109, v74, v75
    v_mfma_f32_32x32x16_bf16 v[32:47], v[88:91], v[104:107], 0
    v_cvt_pk_bf16_f32 v110, v76, v77
    v_cvt_pk_bf16_f32 v111, v78, v79
    s_nop 1
    v_mfma_f32_32x32x16_bf16 v[32:47], v[92:95], v[108:111], v[32:47]
    ds_write_b128 v8, v[16:19] offset:0
    ds_write_b128 v8, v[20:23] offset:1024
    ds_write_b32 v9, v24 offset:16384
    s_nop 8
    ds_write_b128 v8, v[32:35] offset:2048
    ds_write_b128 v8, v[36:39] offset:3072
    ds_write_b32 v9, v40 offset:16640
    s_waitcnt vmcnt(0) lgkmcnt(0)
    s_barrier
    s_cmp_ge_u32 s30, 2
    s_cbranch_scc1 KV_Z1
    s_lshl_b32 s33, s30, 11
    v_add_u32 v8, s33, v4
    ds_read_b128 v[48:51], v8 offset:0
    ds_read_b128 v[52:55], v8 offset:1024
    ds_read_b128 v[56:59], v8 offset:4096
    ds_read_b128 v[60:63], v8 offset:5120
    ds_read_b128 v[64:67], v8 offset:8192
    ds_read_b128 v[68:71], v8 offset:9216
    ds_read_b128 v[72:75], v8 offset:12288
    ds_read_b128 v[76:79], v8 offset:13312
    s_waitcnt lgkmcnt(4)
    v_pk_add_f32 v[48:49], v[48:49], v[56:57]
    v_pk_add_f32 v[50:51], v[50:51], v[58:59]
    v_pk_add_f32 v[52:53], v[52:53], v[60:61]
    v_pk_add_f32 v[54:55], v[54:55], v[62:63]
    s_waitcnt lgkmcnt(2)
    v_pk_add_f32 v[48:49], v[48:49], v[64:65]
    v_pk_add_f32 v[50:51], v[50:51], v[66:67]
    v_pk_add_f32 v[52:53], v[52:53], v[68:69]
    v_pk_add_f32 v[54:55], v[54:55], v[70:71]
    s_waitcnt lgkmcnt(0)
    v_pk_add_f32 v[48:49], v[48:49], v[72:73]
    v_pk_add_f32 v[50:51], v[50:51], v[74:75]
    v_pk_add_f32 v[52:53], v[52:53], v[76:77]
    v_pk_add_f32 v[54:55], v[54:55], v[78:79]
    v_cvt_pk_bf16_f32 v56, v48, v49
    v_cvt_pk_bf16_f32 v57, v50, v51
    v_cvt_pk_bf16_f32 v58, v52, v53
    v_cvt_pk_bf16_f32 v59, v54, v55
    buffer_store_dwordx4 v[56:59], v1, s[4:7], s85 offen offset:0 sc1
    s_branch KV_DONE1
KV_Z1:
    s_cmp_eq_u32 s30, 3
    s_cbranch_scc1 KV_DONE1
    v_lshrrev_b32 v8, 5, v0
    v_lshlrev_b32 v8, 7, v8
    v_add_u32 v8, v8, v2
    v_add_u32 v8, s84, v8
    ds_read_b32 v48, v8 offset:8192
    ds_read_b32 v49, v8 offset:8704
    ds_read_b32 v50, v8 offset:9216
    ds_read_b32 v51, v8 offset:9728
    s_waitcnt lgkmcnt(0)
    v_add_f32 v48, v48, v49
    v_add_f32 v50, v50, v51
    v_add_f32 v48, v48, v50
    v_cvt_pk_bf16_f32 v49, v48, v48
    v_lshlrev_b32 v49, 16, v49
    v_sub_f32 v49, v48, v49
    v_cvt_pk_bf16_f32 v48, v48, v49
    buffer_store_dword v48, v2, s[4:7], s87 offen sc1
KV_DONE1:
    ds_read_b128 v[80:83], v5 offset:0
    ds_read_b128 v[84:87], v5 offset:1024
    ds_read_b128 v[88:91], v5 offset:2048
    s_waitcnt lgkmcnt(2)
    v_mfma_f32_32x32x16_bf16 v[96:111], v[80:83], v[128:131], 0
    ds_read_b128 v[92:95], v5 offset:3072
    s_xor_b32 s96, s81, 0x0
    buffer_load_dwordx4 v[128:131], v1, s[4:7], s96 offen offset:0 sc1
    s_waitcnt lgkmcnt(2)
    v_mfma_f32_32x32x16_bf16 v[96:111], v[84:87], v[132:135], v[96:111]
    ds_read_b128 v[80:83], v5 offset:4096
    s_waitcnt lgkmcnt(2)
    v_mfma_f32_32x32x16_bf16 v[96:111], v[88:91], v[136:139], v[96:111]
    ds_read_b128 v[84:87], v5 offset:5120
    s_waitcnt lgkmcnt(2)
    v_mfma_f32_32x32x16_bf16 v[96:111], v[92:95], v[140:143], v[96:111]
    ds_read_b128 v[88:91], v5 offset:6144
    buffer_load_dwordx4 v[132:135], v1, s[4:7], s96 offen offset:1024 sc1
    s_waitcnt lgkmcnt(2)
    v_mfma_f32_32x32x16_bf16 v[96:111], v[80:83], v[144:147], v[96:111]
    ds_read_b128 v[92:95], v5 offset:7168
    s_waitcnt lgkmcnt(2)
    v_mfma_f32_32x32x16_bf16 v[96:111], v[84:87], v[148:151], v[96:111]
    ds_read_b128 v[80:83], v5 offset:8192
    s_waitcnt lgkmcnt(2)
    v_mfma_f32_32x32x16_bf16 v[96:111], v[88:91], v[152:155], v[96:111]
    ds_read_b128 v[84:87], v5 offset:9216
    buffer_load_dwordx4 v[136:139], v1, s[4:7], s96 offen offset:2048 sc1
    s_waitcnt lgkmcnt(2)
    v_mfma_f32_32x32x16_bf16 v[96:111], v[92:95], v[156:159], v[96:111]
    ds_read_b128 v[88:91], v5 offset:10240
    s_waitcnt lgkmcnt(2)
    v_mfma_f32_32x32x16_bf16 v[96:111], v[80:83], v[160:163], v[96:111]
    ds_read_b128 v[92:95], v5 offset:11264
    s_waitcnt lgkmcnt(2)
    v_mfma_f32_32x32x16_bf16 v[96:111], v[84:87], v[164:167], v[96:111]
    ds_read_b128 v[80:83], v5 offset:12288
    buffer_load_dwordx4 v[140:143], v1, s[4:7], s96 offen offset:3072 sc1
    s_waitcnt lgkmcnt(2)
    v_mfma_f32_32x32x16_bf16 v[96:111], v[88:91], v[168:171], v[96:111]
    ds_read_b128 v[84:87], v5 offset:13312
    s_waitcnt lgkmcnt(2)
    v_mfma_f32_32x32x16_bf16 v[96:111], v[92:95], v[172:175], v[96:111]
    ds_read_b128 v[88:91], v5 offset:14336
    s_waitcnt lgkmcnt(2)
    v_mfma_f32_32x32x16_bf16 v[96:111], v[80:83], v[176:179], v[96:111]
    ds_read_b128 v[92:95], v5 offset:15360
    s_xor_b32 s96, s81, 0x1000
    buffer_load_dwordx4 v[144:147], v1, s[4:7], s96 offen offset:0 sc1
    s_waitcnt lgkmcnt(2)
    v_mfma_f32_32x32x16_bf16 v[96:111], v[84:87], v[180:183], v[96:111]
    ds_read_b128 v[80:83], v5 offset:16384
    s_waitcnt lgkmcnt(2)
    v_mfma_f32_32x32x16_bf16 v[96:111], v[88:91], v[184:187], v[96:111]
    ds_read_b128 v[84:87], v5 offset:17408
    s_waitcnt lgkmcnt(2)
    v_mfma_f32_32x32x16_bf16 v[96:111], v[92:95], v[188:191], v[96:111]
    ds_read_b128 v[88:91], v5 offset:18432
    buffer_load_dwordx4 v[148:151], v1, s[4:7], s96 offen offset:1024 sc1
    s_waitcnt lgkmcnt(2)
    v_mfma_f32_32x32x16_bf16 v[96:111], v[80:83], v[192:195], v[96:111]
    ds_read_b128 v[92:95], v5 offset:19456
    s_waitcnt lgkmcnt(2)
    v_mfma_f32_32x32x16_bf16 v[96:111], v[84:87], v[196:199], v[96:111]
    ds_read_b128 v[80:83], v5 offset:20480
    s_waitcnt lgkmcnt(2)
    v_mfma_f32_32x32x16_bf16 v[96:111], v[88:91], v[200:203], v[96:111]
    ds_read_b128 v[84:87], v5 offset:21504
    buffer_load_dwordx4 v[152:155], v1, s[4:7], s96 offen offset:2048 sc1
    s_waitcnt lgkmcnt(2)
    v_mfma_f32_32x32x16_bf16 v[96:111], v[92:95], v[204:207], v[96:111]
    ds_read_b128 v[88:91], v5 offset:22528
    s_waitcnt lgkmcnt(2)
    v_mfma_f32_32x32x16_bf16 v[96:111], v[80:83], v[208:211], v[96:111]
    ds_read_b128 v[92:95], v5 offset:23552
    s_waitcnt lgkmcnt(2)
    v_mfma_f32_32x32x16_bf16 v[96:111], v[84:87], v[212:215], v[96:111]
    ds_read_b128 v[80:83], v5 offset:24576
    buffer_load_dwordx4 v[156:159], v1, s[4:7], s96 offen offset:3072 sc1
    s_waitcnt lgkmcnt(2)
    v_mfma_f32_32x32x16_bf16 v[96:111], v[88:91], v[216:219], v[96:111]
    ds_read_b128 v[84:87], v5 offset:25600
    s_waitcnt lgkmcnt(2)
    v_mfma_f32_32x32x16_bf16 v[96:111], v[92:95], v[220:223], v[96:111]
    ds_read_b128 v[88:91], v5 offset:26624
    s_waitcnt lgkmcnt(2)
    v_mfma_f32_32x32x16_bf16 v[96:111], v[80:83], v[224:227], v[96:111]
    ds_read_b128 v[92:95], v5 offset:27648
    s_xor_b32 s96, s82, 0x0
    buffer_load_dwordx4 v[160:163], v1, s[4:7], s96 offen offset:0 sc1
    s_waitcnt lgkmcnt(2)
    v_mfma_f32_32x32x16_bf16 v[96:111], v[84:87], v[228:231], v[96:111]
    ds_read_b128 v[80:83], v5 offset:28672
    s_waitcnt lgkmcnt(2)
    v_mfma_f32_32x32x16_bf16 v[96:111], v[88:91], v[232:235], v[96:111]
    ds_read_b128 v[84:87], v5 offset:29696
    s_waitcnt lgkmcnt(2)
    v_mfma_f32_32x32x16_bf16 v[96:111], v[92:95], v[236:239], v[96:111]
    ds_read_b128 v[88:91], v5 offset:30720
    buffer_load_dwordx4 v[164:167], v1, s[4:7], s96 offen offset:1024 sc1
    s_waitcnt lgkmcnt(2)
    v_mfma_f32_32x32x16_bf16 v[96:111], v[80:83], v[240:243], v[96:111]
    ds_read_b128 v[92:95], v5 offset:31744
    s_waitcnt lgkmcnt(2)
    v_mfma_f32_32x32x16_bf16 v[96:111], v[84:87], v[244:247], v[96:111]
    s_waitcnt lgkmcnt(1)
    v_mfma_f32_32x32x16_bf16 v[96:111], v[88:91], v[248:251], v[96:111]
    s_waitcnt lgkmcnt(0)
    v_mfma_f32_32x32x16_bf16 v[96:111], v[92:95], v[252:255], v[96:111]
    s_barrier
    v_and_b32 v84, 31, v0
    v_lshlrev_b32 v84, 2, v84
    v_lshrrev_b32 v85, 5, v0
    v_lshl_add_u32 v84, v85, 10, v84
    s_lshl_b32 s33, s30, 11
    s_add_u32 s33, s33, 24576
    v_add_u32 v85, s33, v4
    s_nop 3
    v_max3_f32 v8, v96, v97, v98
    s_add_u32 s33, s31, 1
    v_mov_b32 v7, s33
    s_waitcnt vmcnt(10)
    s_mov_b64 exec, 1
    buffer_store_dword v7, off, s[4:7], s78 sc1
    s_mov_b64 exec, -1
    s_xor_b32 s98, s86, 0x0
    buffer_load_dwordx4 v[48:51], v1, s[4:7], s98 offen offset:0 sc1
    v_max3_f32 v9, v104, v105, v106
    v_max3_f32 v8, v8, v99, v100
    v_max3_f32 v9, v9, v107, v108
    v_max3_f32 v8, v8, v101, v102
    v_max3_f32 v9, v9, v109, v110
    v_max_f32 v8, v8, v103
    v_max_f32 v9, v9, v111
    v_min3_f32 v10, v96, v97, v98
    v_min3_f32 v11, v104, v105, v106
    v_min3_f32 v10, v10, v99, v100
    v_min3_f32 v11, v11, v107, v108
    v_min3_f32 v10, v10, v101, v102
    v_min3_f32 v11, v11, v109, v110
    v_min_f32 v10, v10, v103
    v_min_f32 v11, v11, v111
    v_permlane32_swap_b32 v8, v9
    buffer_load_dwordx4 v[52:55], v1, s[4:7], s98 offen offset:1024 sc1
    v_permlane32_swap_b32 v10, v11
    v_max_f32 v8, v8, v9
    v_min_f32 v10, v10, v11
    v_mul_f32 v8, v8, v14
    v_mul_f32 v10, v10, v14
    v_mov_b32 v9, v8
    v_mov_b32 v11, v10
    s_nop 0
    v_permlane32_swap_b32 v8, v9
    v_permlane32_swap_b32 v10, v11
    v_fma_f32 v16, v96, v14, -v8
    v_fma_f32 v17, v97, v14, -v8
    v_fma_f32 v18, v98, v14, -v8
    v_fma_f32 v19, v99, v14, -v8
    v_fma_f32 v20, v100, v14, -v8
    v_fma_f32 v21, v101, v14, -v8
    buffer_load_dwordx4 v[56:59], v1, s[4:7], s98 offen offset:2048 sc1
    v_fma_f32 v22, v102, v14, -v8
    v_fma_f32 v23, v103, v14, -v8
    v_fma_f32 v24, -v96, v14, v10
    v_fma_f32 v25, -v97, v14, v10
    v_fma_f32 v26, -v98, v14, v10
    v_fma_f32 v27, -v99, v14, v10
    v_fma_f32 v28, -v100, v14, v10
    v_fma_f32 v29, -v101, v14, v10
    v_fma_f32 v30, -v102, v14, v10
    v_fma_f32 v31, -v103, v14, v10
    v_fma_f32 v32, v104, v14, -v9
    v_fma_f32 v33, v105, v14, -v9
    v_fma_f32 v34, v106, v14, -v9
    v_fma_f32 v35, v107, v14, -v9
    v_fma_f32 v36, v108, v14, -v9
    v_fma_f32 v37, v109, v14, -v9
    buffer_load_dwordx4 v[60:63], v1, s[4:7], s98 offen offset:3072 sc1
    v_fma_f32 v38, v110, v14, -v9
    v_fma_f32 v39, v111, v14, -v9
    v_fma_f32 v40, -v104, v14, v11
    v_fma_f32 v41, -v105, v14, v11
    v_fma_f32 v42, -v106, v14, v11
    v_fma_f32 v43, -v107, v14, v11
    v_fma_f32 v44, -v108, v14, v11
    v_fma_f32 v45, -v109, v14, v11
    v_fma_f32 v46, -v110, v14, v11
    v_fma_f32 v47, -v111, v14, v11
    v_exp_f32 v16, v16
    v_exp_f32 v17, v17
    s_xor_b32 s98, s86, 0x1000
    buffer_load_dwordx4 v[64:67], v1, s[4:7], s98 offen offset:0 sc1
    buffer_load_dword v80, v84, s[4:7], s88 offen offset:0 sc1
    v_exp_f32 v18, v18
    v_exp_f32 v19, v19
    v_exp_f32 v20, v20
    v_exp_f32 v21, v21
    buffer_load_dwordx4 v[68:71], v1, s[4:7], s98 offen offset:1024 sc1
    buffer_load_dword v81, v84, s[4:7], s88 offen offset:256 sc1
    v_exp_f32 v22, v22
    v_exp_f32 v23, v23
    v_exp_f32 v24, v24
    v_exp_f32 v25, v25
    buffer_load_dwordx4 v[72:75], v1, s[4:7], s98 offen offset:2048 sc1
    buffer_load_dword v82, v84, s[4:7], s88 offen offset:512 sc1
    v_exp_f32 v26, v26
    v_exp_f32 v27, v27
    v_exp_f32 v28, v28
    v_exp_f32 v29, v29
    buffer_load_dwordx4 v[76:79], v1, s[4:7], s98 offen offset:3072 sc1
    buffer_load_dword v83, v84, s[4:7], s88 offen offset:768 sc1
    v_exp_f32 v30, v30
    v_exp_f32 v31, v31
    v_exp_f32 v32, v32
    v_exp_f32 v33, v33
    buffer_load_dwordx4 v[168:171], v1, s[4:7], s96 offen offset:2048 sc1
    v_exp_f32 v34, v34
    v_exp_f32 v35, v35
    v_exp_f32 v36, v36
    v_exp_f32 v37, v37
    buffer_load_dwordx4 v[172:175], v1, s[4:7], s96 offen offset:3072 sc1
    v_exp_f32 v38, v38
    v_exp_f32 v39, v39
    v_exp_f32 v40, v40
    v_exp_f32 v41, v41
    s_xor_b32 s96, s82, 0x1000
    buffer_load_dwordx4 v[176:179], v1, s[4:7], s96 offen offset:0 sc1
    v_exp_f32 v42, v42
    v_exp_f32 v43, v43
    v_exp_f32 v44, v44
    v_exp_f32 v45, v45
    buffer_load_dwordx4 v[180:183], v1, s[4:7], s96 offen offset:1024 sc1
    v_exp_f32 v46, v46
    v_exp_f32 v47, v47
    v_pk_add_f32 v[96:97], v[16:17], v[18:19]
    v_pk_add_f32 v[98:99], v[20:21], v[22:23]
    v_pk_add_f32 v[100:101], v[24:25], v[26:27]
    v_pk_add_f32 v[102:103], v[28:29], v[30:31]
    v_pk_add_f32 v[104:105], v[32:33], v[34:35]
    v_pk_add_f32 v[106:107], v[36:37], v[38:39]
    v_pk_add_f32 v[108:109], v[40:41], v[42:43]
    v_pk_add_f32 v[110:111], v[44:45], v[46:47]
    buffer_load_dwordx4 v[184:187], v1, s[4:7], s96 offen offset:2048 sc1
    v_pk_add_f32 v[96:97], v[96:97], v[98:99]
    v_pk_add_f32 v[100:101], v[100:101], v[102:103]
    v_pk_add_f32 v[104:105], v[104:105], v[106:107]
    v_pk_add_f32 v[108:109], v[108:109], v[110:111]
    v_add_f32 v8, v96, v97
    v_add_f32 v9, v104, v105
    v_add_f32 v10, v100, v101
    v_add_f32 v11, v108, v109
    v_permlane32_swap_b32 v8, v9
    s_nop 0
    v_permlane32_swap_b32 v10, v11
    v_add_f32 v8, v8, v9
    v_add_f32 v10, v10, v11
    v_rcp_f32 v8, v8
    buffer_load_dwordx4 v[188:191], v1, s[4:7], s96 offen offset:3072 sc1
    v_rcp_f32 v10, v10
    v_mov_b32 v9, v8
    v_mov_b32 v11, v10
    s_nop 0
    v_permlane32_swap_b32 v8, v9
    v_permlane32_swap_b32 v10, v11
    v_pk_mul_f32 v[16:17], v[16:17], v[8:9] op_sel:[0,0] op_sel_hi:[1,0]
    v_pk_mul_f32 v[18:19], v[18:19], v[8:9] op_sel:[0,0] op_sel_hi:[1,0]
    v_pk_mul_f32 v[20:21], v[20:21], v[8:9] op_sel:[0,0] op_sel_hi:[1,0]
    v_pk_mul_f32 v[22:23], v[22:23], v[8:9] op_sel:[0,0] op_sel_hi:[1,0]
    v_cvt_pk_bf16_f32 v112, v16, v17
    v_cvt_pk_bf16_f32 v113, v18, v19
    v_cvt_pk_bf16_f32 v114, v20, v21
    s_add_u32 s97, s80, 0x10000
    s_add_u32 m0, s41, 0x0
    s_nop 0
    buffer_load_dwordx4 v1, s[4:7], s97 offen offset:0 sc1  lds
    v_cvt_pk_bf16_f32 v115, v22, v23
    v_pk_mul_f32 v[24:25], v[24:25], v[10:11] op_sel:[0,0] op_sel_hi:[1,0]
    v_pk_mul_f32 v[26:27], v[26:27], v[10:11] op_sel:[0,0] op_sel_hi:[1,0]
    v_pk_mul_f32 v[28:29], v[28:29], v[10:11] op_sel:[0,0] op_sel_hi:[1,0]
    v_pk_mul_f32 v[30:31], v[30:31], v[10:11] op_sel:[0,0] op_sel_hi:[1,0]
    v_cvt_pk_bf16_f32 v116, v24, v25
    v_cvt_pk_bf16_f32 v117, v26, v27
    v_cvt_pk_bf16_f32 v118, v28, v29
    v_cvt_pk_bf16_f32 v119, v30, v31
    v_pk_mul_f32 v[32:33], v[32:33], v[8:9] op_sel:[0,1] op_sel_hi:[1,1]
    v_pk_mul_f32 v[34:35], v[34:35], v[8:9] op_sel:[0,1] op_sel_hi:[1,1]
    v_pk_mul_f32 v[36:37], v[36:37], v[8:9] op_sel:[0,1] op_sel_hi:[1,1]
    v_pk_mul_f32 v[38:39], v[38:39], v[8:9] op_sel:[0,1] op_sel_hi:[1,1]
    v_cvt_pk_bf16_f32 v120, v32, v33
    v_cvt_pk_bf16_f32 v121, v34, v35
    v_cvt_pk_bf16_f32 v122, v36, v37
    buffer_load_dwordx4 v1, s[4:7], s97 offen offset:1024 sc1  lds
    v_cvt_pk_bf16_f32 v123, v38, v39
    v_pk_mul_f32 v[40:41], v[40:41], v[10:11] op_sel:[0,1] op_sel_hi:[1,1]
    v_pk_mul_f32 v[42:43], v[42:43], v[10:11] op_sel:[0,1] op_sel_hi:[1,1]
    v_pk_mul_f32 v[44:45], v[44:45], v[10:11] op_sel:[0,1] op_sel_hi:[1,1]
    v_pk_mul_f32 v[46:47], v[46:47], v[10:11] op_sel:[0,1] op_sel_hi:[1,1]
    v_cvt_pk_bf16_f32 v124, v40, v41
    v_cvt_pk_bf16_f32 v125, v42, v43
    v_cvt_pk_bf16_f32 v126, v44, v45
    v_cvt_pk_bf16_f32 v127, v46, v47
    s_waitcnt vmcnt(19)
    v_mfma_f32_32x32x16_bf16 v[192:207], v[48:51], a[240:243], 0
    s_waitcnt vmcnt(18)
    v_mfma_f32_32x32x16_bf16 v[192:207], v[52:55], a[240:243], v[192:207]
    s_waitcnt vmcnt(17)
    v_mfma_f32_32x32x16_bf16 v[192:207], v[56:59], a[240:243], v[192:207]
    s_waitcnt vmcnt(16)
    v_mfma_f32_32x32x16_bf16 v[192:207], v[60:63], a[240:243], v[192:207]
    buffer_load_dwordx4 v1, s[4:7], s97 offen offset:2048 sc1  lds
    s_waitcnt vmcnt(16)
    v_mfma_f32_32x32x16_bf16 v[192:207], v[64:67], a[240:243], v[192:207]
    s_waitcnt vmcnt(14)
    v_mfma_f32_32x32x16_bf16 v[192:207], v[68:71], a[240:243], v[192:207]
    s_waitcnt vmcnt(12)
    v_mfma_f32_32x32x16_bf16 v[192:207], v[72:75], a[240:243], v[192:207]
    s_waitcnt vmcnt(10)
    v_mfma_f32_32x32x16_bf16 v[192:207], v[76:79], a[240:243], v[192:207]
    s_waitcnt vmcnt(9)
    v_mfma_f32_32x32x16_bf16 v[192:207], v[80:83], a[252:255], v[192:207]
    s_nop 11
    v_cvt_pk_bf16_f32 v208, v192, v193
    v_cvt_pk_bf16_f32 v209, v194, v195
    v_cvt_pk_bf16_f32 v210, v196, v197
    v_cvt_pk_bf16_f32 v211, v198, v199
    v_cvt_pk_bf16_f32 v212, v200, v201
    v_cvt_pk_bf16_f32 v213, v202, v203
    v_cvt_pk_bf16_f32 v214, v204, v205
    v_cvt_pk_bf16_f32 v215, v206, v207
    ds_write_b128 v85, v[208:211] offset:0
    ds_write_b128 v85, v[212:215] offset:1024
    v_pk_add_f32 v[192:193], v[192:193], v[200:201]
    v_pk_add_f32 v[194:195], v[194:195], v[202:203]
    v_pk_add_f32 v[196:197], v[196:197], v[204:205]
    v_pk_add_f32 v[198:199], v[198:199], v[206:207]
    v_pk_add_f32 v[192:193], v[192:193], v[196:197]
    v_pk_add_f32 v[194:195], v[194:195], v[198:199]
    v_pk_add_f32 v[192:193], v[192:193], v[194:195]
    v_cmp_u_f32 vcc, v192, v193
    s_cbranch_vccnz KV_RETRY1
KV_OK1:
    buffer_load_dwordx4 v1, s[4:7], s97 offen offset:3072 sc1  lds
    s_waitcnt lgkmcnt(0)
    s_barrier
    ds_read_b128 v[48:51], v4 offset:24576
    ds_read_b128 v[52:55], v4 offset:25600
    ds_read_b128 v[56:59], v4 offset:26624
    ds_read_b128 v[60:63], v4 offset:27648
    ds_read_b128 v[64:67], v4 offset:28672
    ds_read_b128 v[68:71], v4 offset:29696
    ds_read_b128 v[72:75], v4 offset:30720
    ds_read_b128 v[76:79], v4 offset:31744
    s_waitcnt lgkmcnt(7)
    v_mfma_f32_32x32x16_bf16 v[16:31], v[48:51], v[112:115], 0
    s_add_u32 s97, s49, 0x10000
    s_add_u32 m0, s41, 0x4000
    s_nop 0
    buffer_load_dwordx4 v1, s[4:7], s97 offen offset:0 sc1  lds
    s_waitcnt lgkmcnt(6)
    v_mfma_f32_32x32x16_bf16 v[16:31], v[52:55], v[116:119], v[16:31]
    buffer_load_dwordx4 v1, s[4:7], s97 offen offset:1024 sc1  lds
    s_waitcnt lgkmcnt(5)
    v_mfma_f32_32x32x16_bf16 v[16:31], v[56:59], v[112:115], v[16:31]
    s_waitcnt lgkmcnt(4)
    v_mfma_f32_32x32x16_bf16 v[16:31], v[60:63], v[116:119], v[16:31]
    s_waitcnt lgkmcnt(3)
    v_mfma_f32_32x32x16_bf16 v[32:47], v[64:67], v[120:123], 0
    s_waitcnt lgkmcnt(2)
    v_mfma_f32_32x32x16_bf16 v[32:47], v[68:71], v[124:127], v[32:47]
    s_waitcnt lgkmcnt(1)
    v_mfma_f32_32x32x16_bf16 v[32:47], v[72:75], v[120:123], v[32:47]
    v_add_f32 v24, 0x358637bd, v24
    v_rcp_f32 v24, v24
    s_nop 0
    v_mul_f32 v16, v16, v24
    v_mul_f32 v17, v17, v24
    v_mul_f32 v18, v18, v24
    v_mul_f32 v19, v19, v24
    s_waitcnt lgkmcnt(0)
    v_mfma_f32_32x32x16_bf16 v[32:47], v[76:79], v[124:127], v[32:47]
    v_mul_f32 v20, v20, v24
    v_mul_f32 v21, v21, v24
    v_mul_f32 v22, v22, v24
    v_mul_f32 v23, v23, v24
    v_cvt_pk_bf16_f32 v88, v16, v17
    v_cvt_pk_bf16_f32 v89, v18, v19
    v_cvt_pk_bf16_f32 v90, v20, v21
    v_cvt_pk_bf16_f32 v91, v22, v23
    buffer_store_dwordx4 v[88:91], v1, s[4:7], s89 offen offset:0 nt
    s_nop 2
    v_add_f32 v40, 0x358637bd, v40
    v_rcp_f32 v40, v40
    s_nop 0
    v_pk_mul_f32 v[32:33], v[32:33], v[40:41] op_sel_hi:[1,0]
    v_pk_mul_f32 v[34:35], v[34:35], v[40:41] op_sel_hi:[1,0]
    v_pk_mul_f32 v[36:37], v[36:37], v[40:41] op_sel_hi:[1,0]
    v_pk_mul_f32 v[38:39], v[38:39], v[40:41] op_sel_hi:[1,0]
    v_cvt_pk_bf16_f32 v92, v32, v33
    v_cvt_pk_bf16_f32 v93, v34, v35
    v_cvt_pk_bf16_f32 v94, v36, v37
    v_cvt_pk_bf16_f32 v95, v38, v39
    buffer_store_dwordx4 v[92:95], v1, s[4:7], s89 offen offset:1024 nt
    s_getpc_b64 s[34:35]
PC_52:
    s_and_b32 s33, s2, 0xf8
    s_lshl1_add_u32 s33, s30, s33
    v_lshrrev_b32 v112, 5, v0
    v_add_lshl_u32 v112, v112, s33, 7
    v_min_u32 v112, CODE_END-PC_52-4, v112
    v_mov_b32 v113, 0
    v_lshl_add_u64 v[112:113], v[112:113], 0, s[34:35]
    global_load_dword v13, v[112:113], off
    v_accvgpr_read_b32 v64, a224
    v_accvgpr_read_b32 v65, a225
    buffer_load_dwordx4 v1, s[4:7], s97 offen offset:2048 sc1  lds
    v_accvgpr_read_b32 v66, a226
    v_accvgpr_read_b32 v67, a227
    buffer_load_dwordx4 v1, s[4:7], s97 offen offset:3072 sc1  lds
    v_accvgpr_read_b32 v68, a228
    v_accvgpr_read_b32 v69, a229
    v_accvgpr_read_b32 v70, a230
    v_accvgpr_read_b32 v71, a231
    v_accvgpr_read_b32 v72, a232
    v_accvgpr_read_b32 v73, a233
    v_accvgpr_read_b32 v74, a234
    v_accvgpr_read_b32 v75, a235
    v_accvgpr_read_b32 v76, a236
    v_accvgpr_read_b32 v77, a237
    v_accvgpr_read_b32 v78, a238
    v_accvgpr_read_b32 v79, a239
    v_lshl_add_u32 v8, s68, 1, v4
    v_xor_b32 v9, 8192, v8
    v_xor_b32 v10, 16384, v8
    v_xor_b32 v11, 24576, v8
    s_add_u32 s33, s74, 2
    v_mov_b32 v7, s33
    s_cmp_lg_u32 s36, 0
    s_waitcnt vmcnt(3)
    s_mov_b64 exec, 1
    s_cbranch_scc1 SIGS_53
    buffer_store_dword v7, off, s[4:7], s76
SIGB_54:
    s_mov_b64 exec, -1
    s_barrier
    s_add_u32 s33, s74, 2
    s_mov_b32 s95, 0
    buffer_load_dword v7, v12, s[4:7], s75 offen sc1
POLL_55:
    buffer_load_dword v255, v12, s[4:7], s75 offen sc1
    s_add_u32 s95, s95, 1
    s_waitcnt vmcnt(1)
    v_cmp_gt_u32 vcc, s33, v7
    s_and_b64 vcc, vcc, s[60:61]
    s_cbranch_scc0 PDONE_56
    buffer_load_dword v7, v12, s[4:7], s75 offen sc1
    s_waitcnt vmcnt(1)
    v_cmp_gt_u32 vcc, s33, v255
    s_and_b64 vcc, vcc, s[60:61]
    s_cbranch_scc0 PDONE_56
    s_cmp_lt_u32 s95, 400000
    s_cbranch_scc1 POLL_55
PDONE_56:
    s_cmp_lg_u32 s36, 0
    s_cbranch_scc1 ACQS_57
ACQB_58:
    s_xor_b32 s96, s91, 0x0
    buffer_load_dwordx4 v[192:195], v1, s[4:7], s96 offen offset:0 sc1
    buffer_load_dwordx4 v[196:199], v1, s[4:7], s96 offen offset:1024 sc1
    buffer_load_dwordx4 v[200:203], v1, s[4:7], s96 offen offset:2048 sc1
    buffer_load_dwordx4 v[204:207], v1, s[4:7], s96 offen offset:3072 sc1
    s_xor_b32 s96, s91, 0x1000
    buffer_load_dwordx4 v[208:211], v1, s[4:7], s96 offen offset:0 sc1
    buffer_load_dwordx4 v[212:215], v1, s[4:7], s96 offen offset:1024 sc1
    s_waitcnt vmcnt(5)
    v_mfma_f32_32x32x16_bf16 v[32:47], v[128:131], v[192:195], 0
    buffer_load_dwordx4 v[216:219], v1, s[4:7], s96 offen offset:2048 sc1
    v_mfma_f32_32x32x16_bf16 v[48:63], v[160:163], v[192:195], 0
    s_waitcnt vmcnt(5)
    v_mfma_f32_32x32x16_bf16 v[32:47], v[132:135], v[196:199], v[32:47]
WZ7:
    s_cbranch_execz WZRET
    buffer_load_dwordx4 v[220:223], v1, s[4:7], s96 offen offset:3072 sc1
    v_mfma_f32_32x32x16_bf16 v[48:63], v[164:167], v[196:199], v[48:63]
    s_waitcnt vmcnt(5)
    v_mfma_f32_32x32x16_bf16 v[32:47], v[136:139], v[200:203], v[32:47]
    s_xor_b32 s96, s90, 0x0
    buffer_load_dwordx4 v[224:227], v1, s[4:7], s96 offen offset:0 sc1
    v_mfma_f32_32x32x16_bf16 v[48:63], v[168:171], v[200:203], v[48:63]
    s_waitcnt vmcnt(5)
    v_mfma_f32_32x32x16_bf16 v[32:47], v[140:143], v[204:207], v[32:47]
    buffer_load_dwordx4 v[228:231], v1, s[4:7], s96 offen offset:1024 sc1
    v_mfma_f32_32x32x16_bf16 v[48:63], v[172:175], v[204:207], v[48:63]
    s_waitcnt vmcnt(5)
    v_mfma_f32_32x32x16_bf16 v[32:47], v[144:147], v[208:211], v[32:47]
    buffer_load_dwordx4 v[232:235], v1, s[4:7], s96 offen offset:2048 sc1
    v_mfma_f32_32x32x16_bf16 v[48:63], v[176:179], v[208:211], v[48:63]
    s_waitcnt vmcnt(5)
    v_mfma_f32_32x32x16_bf16 v[32:47], v[148:151], v[212:215], v[32:47]
    buffer_load_dwordx4 v[236:239], v1, s[4:7], s96 offen offset:3072 sc1
    v_mfma_f32_32x32x16_bf16 v[48:63], v[180:183], v[212:215], v[48:63]
    s_waitcnt vmcnt(5)
    v_mfma_f32_32x32x16_bf16 v[32:47], v[152:155], v[216:219], v[32:47]
    s_xor_b32 s96, s90, 0x1000
    buffer_load_dwordx4 v[240:243], v1, s[4:7], s96 offen offset:0 sc1
    v_mfma_f32_32x32x16_bf16 v[48:63], v[184:187], v[216:219], v[48:63]
    s_waitcnt vmcnt(5)
    v_mfma_f32_32x32x16_bf16 v[32:47], v[156:159], v[220:223], v[32:47]
    buffer_load_dwordx4 v[244:247], v1, s[4:7], s96 offen offset:1024 sc1
    v_mfma_f32_32x32x16_bf16 v[48:63], v[188:191], v[220:223], v[48:63]
    s_waitcnt vmcnt(5)
    v_mfma_f32_32x32x16_bf16 v[16:31], v[160:163], v[224:227], 0
    buffer_load_dwordx4 v[248:251], v1, s[4:7], s96 offen offset:2048 sc1
    s_waitcnt vmcnt(5)
    v_mfma_f32_32x32x16_bf16 v[16:31], v[164:167], v[228:231], v[16:31]
    v_cvt_pk_bf16_f32 v32, v32, v33
    v_cvt_pk_bf16_f32 v33, v34, v35
    v_cvt_pk_bf16_f32 v34, v36, v37
    v_cvt_pk_bf16_f32 v35, v38, v39
    s_waitcnt vmcnt(4)
    v_mfma_f32_32x32x16_bf16 v[16:31], v[168:171], v[232:235], v[16:31]
    buffer_load_dwordx4 v[252:255], v1, s[4:7], s96 offen offset:3072 sc1
    s_add_u32 s97, s80, 0x18000
    s_add_u32 m0, s84, 0x8000
    s_nop 0
    buffer_load_dwordx4 v1, s[4:7], s97 offen offset:0 sc1  lds
    ds_write_b128 v10, v[32:35] offset:0
    v_cvt_pk_bf16_f32 v36, v40, v41
    v_cvt_pk_bf16_f32 v37, v42, v43
    v_cvt_pk_bf16_f32 v38, v44, v45
    v_cvt_pk_bf16_f32 v39, v46, v47
    s_waitcnt vmcnt(5)
    v_mfma_f32_32x32x16_bf16 v[16:31], v[172:175], v[236:239], v[16:31]
    ds_write_b128 v10, v[36:39] offset:1024
    v_cvt_pk_bf16_f32 v48, v48, v49
    v_cvt_pk_bf16_f32 v49, v50, v51
    v_cvt_pk_bf16_f32 v50, v52, v53
    v_cvt_pk_bf16_f32 v51, v54, v55
    s_waitcnt vmcnt(4)
    v_mfma_f32_32x32x16_bf16 v[16:31], v[176:179], v[240:243], v[16:31]
    buffer_load_dwordx4 v1, s[4:7], s97 offen offset:1024 sc1  lds
    ds_write_b128 v11, v[48:51] offset:2048
    v_cvt_pk_bf16_f32 v52, v56, v57
    v_cvt_pk_bf16_f32 v53, v58, v59
    v_cvt_pk_bf16_f32 v54, v60, v61
    v_cvt_pk_bf16_f32 v55, v62, v63
    s_waitcnt vmcnt(4)
    v_mfma_f32_32x32x16_bf16 v[16:31], v[180:183], v[244:247], v[16:31]
    ds_write_b128 v11, v[52:55] offset:3072
    s_waitcnt vmcnt(3)
    v_mfma_f32_32x32x16_bf16 v[16:31], v[184:187], v[248:251], v[16:31]
    buffer_load_dwordx4 v1, s[4:7], s97 offen offset:2048 sc1  lds
    s_waitcnt vmcnt(3)
    v_mfma_f32_32x32x16_bf16 v[16:31], v[188:191], v[252:255], v[16:31]
    v_mfma_f32_32x32x16_bf16 v[64:79], v[128:131], v[224:227], v[64:79]
    buffer_load_dwordx4 v1, s[4:7], s97 offen offset:3072 sc1  lds
    s_waitcnt lgkmcnt(0)
    s_barrier
    ds_read_b128 v[80:83], v8 offset:0
    ds_read_b128 v[84:87], v8 offset:1024
    v_mfma_f32_32x32x16_bf16 v[64:79], v[132:135], v[228:231], v[64:79]
    ds_read_b128 v[88:91], v8 offset:2048
    ds_read_b128 v[92:95], v8 offset:3072
    v_mfma_f32_32x32x16_bf16 v[64:79], v[136:139], v[232:235], v[64:79]
    s_add_u32 s97, s49, 0x18000
    s_add_u32 m0, s84, 0xc000
    s_nop 0
    buffer_load_dwordx4 v1, s[4:7], s97 offen offset:0 sc1  lds
    v_cvt_pk_bf16_f32 v16, v16, v17
    v_cvt_pk_bf16_f32 v17, v18, v19
    v_cvt_pk_bf16_f32 v18, v20, v21
    v_cvt_pk_bf16_f32 v19, v22, v23
    v_mfma_f32_32x32x16_bf16 v[64:79], v[140:143], v[236:239], v[64:79]
    ds_write_b128 v9, v[16:19] offset:4096
    v_cvt_pk_bf16_f32 v20, v24, v25
    v_cvt_pk_bf16_f32 v21, v26, v27
    v_cvt_pk_bf16_f32 v22, v28, v29
    v_cvt_pk_bf16_f32 v23, v30, v31
    v_mfma_f32_32x32x16_bf16 v[64:79], v[144:147], v[240:243], v[64:79]
    buffer_load_dwordx4 v1, s[4:7], s97 offen offset:1024 sc1  lds
    ds_write_b128 v9, v[20:23] offset:5120
    v_mfma_f32_32x32x16_bf16 v[64:79], v[148:151], v[244:247], v[64:79]
    v_mfma_f32_32x32x16_bf16 v[64:79], v[152:155], v[248:251], v[64:79]
    buffer_load_dwordx4 v1, s[4:7], s97 offen offset:2048 sc1  lds
    v_mfma_f32_32x32x16_bf16 v[64:79], v[156:159], v[252:255], v[64:79]
    s_waitcnt lgkmcnt(5)
    v_mfma_f32_32x32x16_bf16 v[64:79], a[240:243], v[80:83], v[64:79]
    buffer_load_dwordx4 v1, s[4:7], s97 offen offset:3072 sc1  lds
    s_waitcnt lgkmcnt(0)
    s_barrier
    ds_read_b128 v[96:99], v8 offset:4096
    ds_read_b128 v[100:103], v8 offset:5120
    v_mfma_f32_32x32x16_bf16 v[64:79], a[244:247], v[84:87], v[64:79]
    v_mfma_f32_32x32x16_bf16 v[64:79], a[240:243], v[88:91], v[64:79]
    v_mfma_f32_32x32x16_bf16 v[64:79], a[244:247], v[92:95], v[64:79]
    s_waitcnt lgkmcnt(1)
    v_mfma_f32_32x32x16_bf16 v[64:79], a[240:243], v[96:99], v[64:79]
    s_waitcnt lgkmcnt(0)
    v_mfma_f32_32x32x16_bf16 v[64:79], a[244:247], v[100:103], v[64:79]
    s_nop 11
    v_cvt_pk_bf16_f32 v80, v64, v65
    v_cvt_pk_bf16_f32 v81, v66, v67
    v_cvt_pk_bf16_f32 v82, v68, v69
    v_cvt_pk_bf16_f32 v83, v70, v71
    v_cvt_pk_bf16_f32 v84, v72, v73
    v_cvt_pk_bf16_f32 v85, v74, v75
    v_cvt_pk_bf16_f32 v86, v76, v77
    v_cvt_pk_bf16_f32 v87, v78, v79
    s_add_u32 s33, s70, 0x0
    buffer_store_dwordx4 v[80:83], v1, s[4:7], s33 offen offset:0 nt
    buffer_store_dwordx4 v[84:87], v1, s[4:7], s33 offen offset:1024 nt
    v_pk_add_f32 v[8:9], v[64:65], v[66:67]
    v_pk_mul_f32 v[10:11], v[64:65], v[64:65]
    v_pk_fma_f32 v[10:11], v[66:67], v[66:67], v[10:11]
    v_pk_add_f32 v[8:9], v[8:9], v[68:69]
    v_pk_fma_f32 v[10:11], v[68:69], v[68:69], v[10:11]
    v_pk_add_f32 v[8:9], v[8:9], v[70:71]
    v_pk_fma_f32 v[10:11], v[70:71], v[70:71], v[10:11]
    v_pk_add_f32 v[8:9], v[8:9], v[72:73]
    v_pk_fma_f32 v[10:11], v[72:73], v[72:73], v[10:11]
    v_pk_add_f32 v[8:9], v[8:9], v[74:75]
    v_pk_fma_f32 v[10:11], v[74:75], v[74:75], v[10:11]
    v_pk_add_f32 v[8:9], v[8:9], v[76:77]
    v_pk_fma_f32 v[10:11], v[76:77], v[76:77], v[10:11]
    v_pk_add_f32 v[8:9], v[8:9], v[78:79]
    v_pk_fma_f32 v[10:11], v[78:79], v[78:79], v[10:11]
    v_add_f32 v8, v8, v9
    v_add_f32 v10, v10, v11
    s_add_u32 s34, s71, 0x0
    s_nop 0
    v_permlane32_swap_b32 v8, v10
    v_add_f32 v8, v8, v10
    buffer_store_dword v8, v3, s[4:7], s34 offen nt
    v_accvgpr_write_b32 a224, v64
    v_accvgpr_write_b32 a225, v65
    v_accvgpr_write_b32 a226, v66
    v_accvgpr_write_b32 a227, v67
    v_accvgpr_write_b32 a228, v68
    v_accvgpr_write_b32 a229, v69
    v_accvgpr_write_b32 a230, v70
    v_accvgpr_write_b32 a231, v71
    v_accvgpr_write_b32 a232, v72
    v_accvgpr_write_b32 a233, v73
    v_accvgpr_write_b32 a234, v74
    v_accvgpr_write_b32 a235, v75
    v_accvgpr_write_b32 a236, v76
    v_accvgpr_write_b32 a237, v77
    v_accvgpr_write_b32 a238, v78
    v_accvgpr_write_b32 a239, v79
    s_add_u32 s33, s74, 3
    v_mov_b32 v7, s33
    s_cmp_lg_u32 s36, 0
    s_waitcnt vmcnt(0)
    s_mov_b64 exec, 1
    s_cbranch_scc1 SIGS_59
    buffer_store_dword v7, off, s[4:7], s62
SIGB_60:
    s_mov_b64 exec, -1
    s_and_b32 s58, s71, 0xfffff000
    s_add_u32 s33, s74, 3
    s_mov_b32 s95, 0
    buffer_load_dword v7, v12, s[4:7], s75 offen offset:64 sc1
POLL_61:
    buffer_load_dword v255, v12, s[4:7], s75 offen offset:64 sc1
    s_add_u32 s95, s95, 1
    s_waitcnt vmcnt(1)
    v_cmp_gt_u32 vcc, s33, v7
    s_and_b64 vcc, vcc, 0xffff
    s_cbranch_scc0 PDONE_62
    buffer_load_dword v7, v12, s[4:7], s75 offen offset:64 sc1
    s_waitcnt vmcnt(1)
    v_cmp_gt_u32 vcc, s33, v255
    s_and_b64 vcc, vcc, 0xffff
    s_cbranch_scc0 PDONE_62
    s_cmp_lt_u32 s95, 400000
    s_cbranch_scc1 POLL_61
PDONE_62:
    s_cmp_lg_u32 s36, 0
    s_cbranch_scc1 ACQS_63
ACQB_64:
    s_xor_b32 s96, s55, 0x0
    buffer_load_dwordx4 v[128:131], v1, s[4:7], s96 offen offset:0 sc1
    buffer_load_dwordx4 v[132:135], v1, s[4:7], s96 offen offset:1024 sc1
    buffer_load_dwordx4 v[136:139], v1, s[4:7], s96 offen offset:2048 sc1
    buffer_load_dwordx4 v[140:143], v1, s[4:7], s96 offen offset:3072 sc1
    s_xor_b32 s96, s55, 0x1000
    buffer_load_dwordx4 v[144:147], v1, s[4:7], s96 offen offset:0 sc1
    buffer_load_dwordx4 v[148:151], v1, s[4:7], s96 offen offset:1024 sc1
    s_barrier
    ds_read_b128 v[32:35], v1 offset:0
    ds_read_b128 v[36:39], v1 offset:32768
    ds_read_b128 v[40:43], v5 offset:0
    s_waitcnt vmcnt(5) lgkmcnt(2)
    v_mfma_f32_32x32x16_bf16 v[96:111], v[32:35], v[128:131], 0
    ds_read_b128 v[44:47], v1 offset:1024
    buffer_load_dwordx4 v[152:155], v1, s[4:7], s96 offen offset:2048 sc1
    s_waitcnt lgkmcnt(2)
    v_mfma_f32_32x32x16_bf16 v[112:127], v[36:39], v[128:131], 0
    ds_read_b128 v[32:35], v1 offset:33792
    s_waitcnt lgkmcnt(2)
    v_mfma_f32_32x32x16_bf16 v[80:95], v[40:43], v[128:131], 0
    ds_read_b128 v[36:39], v5 offset:1024
    buffer_load_dwordx4 v[156:159], v1, s[4:7], s96 offen offset:3072 sc1
    s_waitcnt vmcnt(6) lgkmcnt(2)
    v_mfma_f32_32x32x16_bf16 v[96:111], v[44:47], v[132:135], v[96:111]
    ds_read_b128 v[40:43], v1 offset:2048
    s_waitcnt lgkmcnt(2)
    v_mfma_f32_32x32x16_bf16 v[112:127], v[32:35], v[132:135], v[112:127]
    ds_read_b128 v[44:47], v1 offset:34816
    s_xor_b32 s96, s55, 0x2000
    buffer_load_dwordx4 v[160:163], v1, s[4:7], s96 offen offset:0 sc1
    s_waitcnt lgkmcnt(2)
    v_mfma_f32_32x32x16_bf16 v[80:95], v[36:39], v[132:135], v[80:95]
    ds_read_b128 v[32:35], v5 offset:2048
    s_waitcnt vmcnt(6) lgkmcnt(2)
    v_mfma_f32_32x32x16_bf16 v[96:111], v[40:43], v[136:139], v[96:111]
    ds_read_b128 v[36:39], v1 offset:3072
    buffer_load_dwordx4 v[164:167], v1, s[4:7], s96 offen offset:1024 sc1
    s_waitcnt lgkmcnt(2)
    v_mfma_f32_32x32x16_bf16 v[112:127], v[44:47], v[136:139], v[112:127]
    ds_read_b128 v[40:43], v1 offset:35840
    s_waitcnt lgkmcnt(2)
    v_mfma_f32_32x32x16_bf16 v[80:95], v[32:35], v[136:139], v[80:95]
    ds_read_b128 v[44:47], v5 offset:3072
    buffer_load_dwordx4 v[168:171], v1, s[4:7], s96 offen offset:2048 sc1
    s_waitcnt vmcnt(7) lgkmcnt(2)
    v_mfma_f32_32x32x16_bf16 v[96:111], v[36:39], v[140:143], v[96:111]
    ds_read_b128 v[32:35], v1 offset:4096
    s_waitcnt lgkmcnt(2)
    v_mfma_f32_32x32x16_bf16 v[112:127], v[40:43], v[140:143], v[112:127]
    ds_read_b128 v[36:39], v1 offset:36864
    buffer_load_dwordx4 v[172:175], v1, s[4:7], s96 offen offset:3072 sc1
    s_waitcnt lgkmcnt(2)
    v_mfma_f32_32x32x16_bf16 v[80:95], v[44:47], v[140:143], v[80:95]
    ds_read_b128 v[40:43], v5 offset:4096
    s_waitcnt vmcnt(7) lgkmcnt(2)
    v_mfma_f32_32x32x16_bf16 v[96:111], v[32:35], v[144:147], v[96:111]
    ds_read_b128 v[44:47], v1 offset:5120
    s_xor_b32 s96, s55, 0x3000
    buffer_load_dwordx4 v[176:179], v1, s[4:7], s96 offen offset:0 sc1
    s_waitcnt lgkmcnt(2)
    v_mfma_f32_32x32x16_bf16 v[112:127], v[36:39], v[144:147], v[112:127]
    ds_read_b128 v[32:35], v1 offset:37888
    s_waitcnt lgkmcnt(2)
    v_mfma_f32_32x32x16_bf16 v[80:95], v[40:43], v[144:147], v[80:95]
    ds_read_b128 v[36:39], v5 offset:5120
    buffer_load_dwordx4 v[180:183], v1, s[4:7], s96 offen offset:1024 sc1
    s_waitcnt vmcnt(8) lgkmcnt(2)
    v_mfma_f32_32x32x16_bf16 v[96:111], v[44:47], v[148:151], v[96:111]
    ds_read_b128 v[40:43], v1 offset:6144
    s_waitcnt lgkmcnt(2)
    v_mfma_f32_32x32x16_bf16 v[112:127], v[32:35], v[148:151], v[112:127]
    ds_read_b128 v[44:47], v1 offset:38912
    buffer_load_dwordx4 v[184:187], v1, s[4:7], s96 offen offset:2048 sc1
    s_waitcnt lgkmcnt(2)
    v_mfma_f32_32x32x16_bf16 v[80:95], v[36:39], v[148:151], v[80:95]
    ds_read_b128 v[32:35], v5 offset:6144
    s_waitcnt vmcnt(8) lgkmcnt(2)
    v_mfma_f32_32x32x16_bf16 v[96:111], v[40:43], v[152:155], v[96:111]
    ds_read_b128 v[36:39], v1 offset:7168
    buffer_load_dwordx4 v[188:191], v1, s[4:7], s96 offen offset:3072 sc1
    s_waitcnt lgkmcnt(2)
    v_mfma_f32_32x32x16_bf16 v[112:127], v[44:47], v[152:155], v[112:127]
    ds_read_b128 v[40:43], v1 offset:39936
    s_waitcnt lgkmcnt(2)
    v_mfma_f32_32x32x16_bf16 v[80:95], v[32:35], v[152:155], v[80:95]
    ds_read_b128 v[44:47], v5 offset:7168
    s_xor_b32 s96, s55, 0x4000
    buffer_load_dwordx4 v[192:195], v1, s[4:7], s96 offen offset:0 sc1
    s_waitcnt vmcnt(9) lgkmcnt(2)
    v_mfma_f32_32x32x16_bf16 v[96:111], v[36:39], v[156:159], v[96:111]
    ds_read_b128 v[32:35], v1 offset:8192
    s_waitcnt lgkmcnt(2)
    v_mfma_f32_32x32x16_bf16 v[112:127], v[40:43], v[156:159], v[112:127]
    ds_read_b128 v[36:39], v1 offset:40960
    buffer_load_dwordx4 v[196:199], v1, s[4:7], s96 offen offset:1024 sc1
    s_waitcnt lgkmcnt(2)
    v_mfma_f32_32x32x16_bf16 v[80:95], v[44:47], v[156:159], v[80:95]
    ds_read_b128 v[40:43], v5 offset:8192
    s_waitcnt vmcnt(9) lgkmcnt(2)
    v_mfma_f32_32x32x16_bf16 v[96:111], v[32:35], v[160:163], v[96:111]
    ds_read_b128 v[44:47], v1 offset:9216
    buffer_load_dwordx4 v[200:203], v1, s[4:7], s96 offen offset:2048 sc1
    s_waitcnt lgkmcnt(2)
    v_mfma_f32_32x32x16_bf16 v[112:127], v[36:39], v[160:163], v[112:127]
    ds_read_b128 v[32:35], v1 offset:41984
    s_waitcnt lgkmcnt(2)
    v_mfma_f32_32x32x16_bf16 v[80:95], v[40:43], v[160:163], v[80:95]
    ds_read_b128 v[36:39], v5 offset:9216
    buffer_load_dwordx4 v[204:207], v1, s[4:7], s96 offen offset:3072 sc1
    s_waitcnt vmcnt(10) lgkmcnt(2)
    v_mfma_f32_32x32x16_bf16 v[96:111], v[44:47], v[164:167], v[96:111]
    ds_read_b128 v[40:43], v1 offset:10240
    s_waitcnt lgkmcnt(2)
    v_mfma_f32_32x32x16_bf16 v[112:127], v[32:35], v[164:167], v[112:127]
    ds_read_b128 v[44:47], v1 offset:43008
    s_xor_b32 s96, s55, 0x5000
    buffer_load_dwordx4 v[208:211], v1, s[4:7], s96 offen offset:0 sc1
    s_waitcnt lgkmcnt(2)
    v_mfma_f32_32x32x16_bf16 v[80:95], v[36:39], v[164:167], v[80:95]
    ds_read_b128 v[32:35], v5 offset:10240
    s_waitcnt vmcnt(10) lgkmcnt(2)
    v_mfma_f32_32x32x16_bf16 v[96:111], v[40:43], v[168:171], v[96:111]
    ds_read_b128 v[36:39], v1 offset:11264
    buffer_load_dwordx4 v[212:215], v1, s[4:7], s96 offen offset:1024 sc1
    s_waitcnt lgkmcnt(2)
    v_mfma_f32_32x32x16_bf16 v[112:127], v[44:47], v[168:171], v[112:127]
    ds_read_b128 v[40:43], v1 offset:44032
    s_waitcnt lgkmcnt(2)
    v_mfma_f32_32x32x16_bf16 v[80:95], v[32:35], v[168:171], v[80:95]
    ds_read_b128 v[44:47], v5 offset:11264
    buffer_load_dwordx4 v[216:219], v1, s[4:7], s96 offen offset:2048 sc1
    s_waitcnt vmcnt(11) lgkmcnt(2)
    v_mfma_f32_32x32x16_bf16 v[96:111], v[36:39], v[172:175], v[96:111]
    ds_read_b128 v[32:35], v1 offset:12288
    s_waitcnt lgkmcnt(2)
    v_mfma_f32_32x32x16_bf16 v[112:127], v[40:43], v[172:175], v[112:127]
    ds_read_b128 v[36:39], v1 offset:45056
    buffer_load_dwordx4 v[220:223], v1, s[4:7], s96 offen offset:3072 sc1
    s_waitcnt lgkmcnt(2)
    v_mfma_f32_32x32x16_bf16 v[80:95], v[44:47], v[172:175], v[80:95]
    ds_read_b128 v[40:43], v5 offset:12288
    s_waitcnt vmcnt(11) lgkmcnt(2)
    v_mfma_f32_32x32x16_bf16 v[96:111], v[32:35], v[176:179], v[96:111]
    ds_read_b128 v[44:47], v1 offset:13312
    s_xor_b32 s96, s55, 0x6000
    buffer_load_dwordx4 v[224:227], v1, s[4:7], s96 offen offset:0 sc1
    s_waitcnt lgkmcnt(2)
    v_mfma_f32_32x32x16_bf16 v[112:127], v[36:39], v[176:179], v[112:127]
    ds_read_b128 v[32:35], v1 offset:46080
    s_waitcnt lgkmcnt(2)
    v_mfma_f32_32x32x16_bf16 v[80:95], v[40:43], v[176:179], v[80:95]
    ds_read_b128 v[36:39], v5 offset:13312
    buffer_load_dwordx4 v[228:231], v1, s[4:7], s96 offen offset:1024 sc1
    s_waitcnt vmcnt(12) lgkmcnt(2)
    v_mfma_f32_32x32x16_bf16 v[96:111], v[44:47], v[180:183], v[96:111]
    ds_read_b128 v[40:43], v1 offset:14336
    s_waitcnt lgkmcnt(2)
    v_mfma_f32_32x32x16_bf16 v[112:127], v[32:35], v[180:183], v[112:127]
    ds_read_b128 v[44:47], v1 offset:47104
    buffer_load_dwordx4 v[232:235], v1, s[4:7], s96 offen offset:2048 sc1
    s_waitcnt lgkmcnt(2)
    v_mfma_f32_32x32x16_bf16 v[80:95], v[36:39], v[180:183], v[80:95]
    ds_read_b128 v[32:35], v5 offset:14336
    s_waitcnt vmcnt(12) lgkmcnt(2)
    v_mfma_f32_32x32x16_bf16 v[96:111], v[40:43], v[184:187], v[96:111]
    ds_read_b128 v[36:39], v1 offset:15360
    buffer_load_dwordx4 v[236:239], v1, s[4:7], s96 offen offset:3072 sc1
    s_waitcnt lgkmcnt(2)
    v_mfma_f32_32x32x16_bf16 v[112:127], v[44:47], v[184:187], v[112:127]
    ds_read_b128 v[40:43], v1 offset:48128
    s_waitcnt lgkmcnt(2)
    v_mfma_f32_32x32x16_bf16 v[80:95], v[32:35], v[184:187], v[80:95]
    ds_read_b128 v[44:47], v5 offset:15360
    s_xor_b32 s96, s55, 0x7000
    buffer_load_dwordx4 v[240:243], v1, s[4:7], s96 offen offset:0 sc1
    s_waitcnt vmcnt(13) lgkmcnt(2)
    v_mfma_f32_32x32x16_bf16 v[96:111], v[36:39], v[188:191], v[96:111]
    ds_read_b128 v[32:35], v1 offset:16384
    s_waitcnt lgkmcnt(2)
    v_mfma_f32_32x32x16_bf16 v[112:127], v[40:43], v[188:191], v[112:127]
    ds_read_b128 v[36:39], v1 offset:49152
    buffer_load_dwordx4 v[244:247], v1, s[4:7], s96 offen offset:1024 sc1
    s_waitcnt lgkmcnt(2)
    v_mfma_f32_32x32x16_bf16 v[80:95], v[44:47], v[188:191], v[80:95]
    ds_read_b128 v[40:43], v5 offset:16384
    s_waitcnt vmcnt(13) lgkmcnt(2)
    v_mfma_f32_32x32x16_bf16 v[96:111], v[32:35], v[192:195], v[96:111]
    ds_read_b128 v[44:47], v1 offset:17408
    buffer_load_dwordx4 v[248:251], v1, s[4:7], s96 offen offset:2048 sc1
    s_waitcnt lgkmcnt(2)
    v_mfma_f32_32x32x16_bf16 v[112:127], v[36:39], v[192:195], v[112:127]
    ds_read_b128 v[32:35], v1 offset:50176
    s_waitcnt lgkmcnt(2)
    v_mfma_f32_32x32x16_bf16 v[80:95], v[40:43], v[192:195], v[80:95]
    ds_read_b128 v[36:39], v5 offset:17408
    buffer_load_dwordx4 v[252:255], v1, s[4:7], s96 offen offset:3072 sc1
    s_waitcnt vmcnt(14) lgkmcnt(2)
    v_mfma_f32_32x32x16_bf16 v[96:111], v[44:47], v[196:199], v[96:111]
    ds_read_b128 v[40:43], v1 offset:18432
    s_barrier
    s_waitcnt lgkmcnt(2)
    v_mfma_f32_32x32x16_bf16 v[112:127], v[32:35], v[196:199], v[112:127]
    ds_read_b128 v[44:47], v1 offset:51200
    s_add_u32 s97, s80, 0x20000
    s_add_u32 m0, s84, 0x0
    s_waitcnt lgkmcnt(2)
    v_mfma_f32_32x32x16_bf16 v[80:95], v[36:39], v[196:199], v[80:95]
    ds_read_b128 v[32:35], v5 offset:18432
    buffer_load_dwordx4 v1, s[4:7], s97 offen offset:0 sc1  lds
    s_waitcnt vmcnt(14) lgkmcnt(2)
    v_mfma_f32_32x32x16_bf16 v[96:111], v[40:43], v[200:203], v[96:111]
    ds_read_b128 v[36:39], v1 offset:19456
    s_waitcnt lgkmcnt(2)
    v_mfma_f32_32x32x16_bf16 v[112:127], v[44:47], v[200:203], v[112:127]
    ds_read_b128 v[40:43], v1 offset:52224
    s_waitcnt lgkmcnt(2)
    v_mfma_f32_32x32x16_bf16 v[80:95], v[32:35], v[200:203], v[80:95]
    ds_read_b128 v[44:47], v5 offset:19456
    buffer_load_dwordx4 v1, s[4:7], s97 offen offset:1024 sc1  lds
    s_waitcnt vmcnt(14) lgkmcnt(2)
    v_mfma_f32_32x32x16_bf16 v[96:111], v[36:39], v[204:207], v[96:111]
    ds_read_b128 v[32:35], v1 offset:20480
    s_waitcnt lgkmcnt(2)
    v_mfma_f32_32x32x16_bf16 v[112:127], v[40:43], v[204:207], v[112:127]
    ds_read_b128 v[36:39], v1 offset:53248
    s_waitcnt lgkmcnt(2)
    v_mfma_f32_32x32x16_bf16 v[80:95], v[44:47], v[204:207], v[80:95]
    ds_read_b128 v[40:43], v5 offset:20480
    s_waitcnt vmcnt(13) lgkmcnt(2)
    v_mfma_f32_32x32x16_bf16 v[96:111], v[32:35], v[208:211], v[96:111]
    ds_read_b128 v[44:47], v1 offset:21504
    buffer_load_dwordx4 v1, s[4:7], s97 offen offset:2048 sc1  lds
    s_waitcnt lgkmcnt(2)
    v_mfma_f32_32x32x16_bf16 v[112:127], v[36:39], v[208:211], v[112:127]
    ds_read_b128 v[32:35], v1 offset:54272
    s_waitcnt lgkmcnt(2)
    v_mfma_f32_32x32x16_bf16 v[80:95], v[40:43], v[208:211], v[80:95]
    ds_read_b128 v[36:39], v5 offset:21504
    s_waitcnt vmcnt(13) lgkmcnt(2)
    v_mfma_f32_32x32x16_bf16 v[96:111], v[44:47], v[212:215], v[96:111]
    ds_read_b128 v[40:43], v1 offset:22528
    buffer_load_dwordx4 v1, s[4:7], s97 offen offset:3072 sc1  lds
    s_waitcnt lgkmcnt(2)
    v_mfma_f32_32x32x16_bf16 v[112:127], v[32:35], v[212:215], v[112:127]
    ds_read_b128 v[44:47], v1 offset:55296
    s_waitcnt lgkmcnt(2)
    v_mfma_f32_32x32x16_bf16 v[80:95], v[36:39], v[212:215], v[80:95]
    ds_read_b128 v[32:35], v5 offset:22528
    s_waitcnt vmcnt(13) lgkmcnt(2)
    v_mfma_f32_32x32x16_bf16 v[96:111], v[40:43], v[216:219], v[96:111]
    ds_read_b128 v[36:39], v1 offset:23552
    s_add_u32 s97, s49, 0x20000
    s_add_u32 m0, s84, 0x4000
    s_waitcnt lgkmcnt(2)
    v_mfma_f32_32x32x16_bf16 v[112:127], v[44:47], v[216:219], v[112:127]
    ds_read_b128 v[40:43], v1 offset:56320
    buffer_load_dwordx4 v1, s[4:7], s97 offen offset:0 sc1  lds
    s_waitcnt lgkmcnt(2)
    v_mfma_f32_32x32x16_bf16 v[80:95], v[32:35], v[216:219], v[80:95]
    ds_read_b128 v[44:47], v5 offset:23552
    s_waitcnt vmcnt(13) lgkmcnt(2)
    v_mfma_f32_32x32x16_bf16 v[96:111], v[36:39], v[220:223], v[96:111]
    ds_read_b128 v[32:35], v1 offset:24576
    s_waitcnt lgkmcnt(2)
    v_mfma_f32_32x32x16_bf16 v[112:127], v[40:43], v[220:223], v[112:127]
    ds_read_b128 v[36:39], v1 offset:57344
    buffer_load_dwordx4 v1, s[4:7], s97 offen offset:1024 sc1  lds
    s_waitcnt lgkmcnt(2)
    v_mfma_f32_32x32x16_bf16 v[80:95], v[44:47], v[220:223], v[80:95]
    ds_read_b128 v[40:43], v5 offset:24576
    buffer_load_dwordx4 v[16:19], v1, s[4:7], s58 offen offset:0 sc1
    s_waitcnt vmcnt(14) lgkmcnt(2)
    v_mfma_f32_32x32x16_bf16 v[96:111], v[32:35], v[224:227], v[96:111]
    ds_read_b128 v[44:47], v1 offset:25600
    buffer_load_dwordx4 v[20:23], v1, s[4:7], s58 offen offset:1024 sc1
    s_waitcnt lgkmcnt(2)
    v_mfma_f32_32x32x16_bf16 v[112:127], v[36:39], v[224:227], v[112:127]
    ds_read_b128 v[32:35], v1 offset:58368
    buffer_load_dwordx4 v[24:27], v1, s[4:7], s58 offen offset:2048 sc1
    s_waitcnt lgkmcnt(2)
    v_mfma_f32_32x32x16_bf16 v[80:95], v[40:43], v[224:227], v[80:95]
    ds_read_b128 v[36:39], v5 offset:25600
    buffer_load_dwordx4 v1, s[4:7], s97 offen offset:2048 sc1  lds
    s_waitcnt vmcnt(16) lgkmcnt(2)
    v_mfma_f32_32x32x16_bf16 v[96:111], v[44:47], v[228:231], v[96:111]
    ds_read_b128 v[40:43], v1 offset:26624
    buffer_load_dwordx4 v[28:31], v1, s[4:7], s58 offen offset:3072 sc1
    s_waitcnt lgkmcnt(2)
    v_mfma_f32_32x32x16_bf16 v[112:127], v[32:35], v[228:231], v[112:127]
    ds_read_b128 v[44:47], v1 offset:59392
    s_waitcnt lgkmcnt(2)
    v_mfma_f32_32x32x16_bf16 v[80:95], v[36:39], v[228:231], v[80:95]
    ds_read_b128 v[32:35], v5 offset:26624
    buffer_load_dwordx4 v1, s[4:7], s97 offen offset:3072 sc1  lds
    s_waitcnt vmcnt(17) lgkmcnt(2)
    v_mfma_f32_32x32x16_bf16 v[96:111], v[40:43], v[232:235], v[96:111]
    ds_read_b128 v[36:39], v1 offset:27648
    s_waitcnt lgkmcnt(2)
    v_mfma_f32_32x32x16_bf16 v[112:127], v[44:47], v[232:235], v[112:127]
    ds_read_b128 v[40:43], v1 offset:60416
    s_waitcnt lgkmcnt(2)
    v_mfma_f32_32x32x16_bf16 v[80:95], v[32:35], v[232:235], v[80:95]
    ds_read_b128 v[44:47], v5 offset:27648
    s_add_u32 s97, s63, 0x0
    s_add_u32 m0, s83, 0x0
    s_waitcnt vmcnt(16) lgkmcnt(2)
    v_mfma_f32_32x32x16_bf16 v[96:111], v[36:39], v[236:239], v[96:111]
    ds_read_b128 v[32:35], v1 offset:28672
    buffer_load_dwordx4 v1, s[4:7], s97 offen offset:0 sc1  lds
    s_waitcnt lgkmcnt(2)
    v_mfma_f32_32x32x16_bf16 v[112:127], v[40:43], v[236:239], v[112:127]
    ds_read_b128 v[36:39], v1 offset:61440
    s_waitcnt lgkmcnt(2)
    v_mfma_f32_32x32x16_bf16 v[80:95], v[44:47], v[236:239], v[80:95]
    ds_read_b128 v[40:43], v5 offset:28672
    s_waitcnt vmcnt(16) lgkmcnt(2)
    v_mfma_f32_32x32x16_bf16 v[96:111], v[32:35], v[240:243], v[96:111]
    ds_read_b128 v[44:47], v1 offset:29696
    buffer_load_dwordx4 v1, s[4:7], s97 offen offset:1024 sc1  lds
    s_waitcnt lgkmcnt(2)
    v_mfma_f32_32x32x16_bf16 v[112:127], v[36:39], v[240:243], v[112:127]
    ds_read_b128 v[32:35], v1 offset:62464
    s_waitcnt lgkmcnt(2)
    v_mfma_f32_32x32x16_bf16 v[80:95], v[40:43], v[240:243], v[80:95]
    ds_read_b128 v[36:39], v5 offset:29696
    s_waitcnt vmcnt(16) lgkmcnt(2)
    v_mfma_f32_32x32x16_bf16 v[96:111], v[44:47], v[244:247], v[96:111]
    ds_read_b128 v[40:43], v1 offset:30720
    s_waitcnt lgkmcnt(2)
    v_mfma_f32_32x32x16_bf16 v[112:127], v[32:35], v[244:247], v[112:127]
    ds_read_b128 v[44:47], v1 offset:63488
    buffer_load_dwordx4 v1, s[4:7], s97 offen offset:2048 sc1  lds
    s_waitcnt lgkmcnt(2)
    v_mfma_f32_32x32x16_bf16 v[80:95], v[36:39], v[244:247], v[80:95]
    ds_read_b128 v[32:35], v5 offset:30720
    s_waitcnt vmcnt(16) lgkmcnt(2)
    v_mfma_f32_32x32x16_bf16 v[96:111], v[40:43], v[248:251], v[96:111]
    ds_read_b128 v[36:39], v1 offset:31744
    s_waitcnt lgkmcnt(2)
    v_mfma_f32_32x32x16_bf16 v[112:127], v[44:47], v[248:251], v[112:127]
    ds_read_b128 v[40:43], v1 offset:64512
    buffer_load_dwordx4 v1, s[4:7], s97 offen offset:3072 sc1  lds
    s_waitcnt lgkmcnt(2)
    v_mfma_f32_32x32x16_bf16 v[80:95], v[32:35], v[248:251], v[80:95]
    ds_read_b128 v[44:47], v5 offset:31744
    s_waitcnt vmcnt(16) lgkmcnt(2)
    v_mfma_f32_32x32x16_bf16 v[96:111], v[36:39], v[252:255], v[96:111]
    ds_read_b128 v[32:35], v4 offset:32768
    s_waitcnt lgkmcnt(2)
    v_mfma_f32_32x32x16_bf16 v[112:127], v[40:43], v[252:255], v[112:127]
    ds_read_b128 v[36:39], v4 offset:33792
    s_add_u32 s97, s63, 0x8000
    s_add_u32 m0, s83, 0x8000
    s_waitcnt lgkmcnt(2)
    v_mfma_f32_32x32x16_bf16 v[80:95], v[44:47], v[252:255], v[80:95]
    ds_read_b128 v[40:43], v4 offset:34816
    buffer_load_dwordx4 v1, s[4:7], s97 offen offset:0 sc1  lds
    s_waitcnt lgkmcnt(2)
    v_mfma_f32_32x32x16_bf16 v[48:63], v[32:35], v[128:131], 0
    ds_read_b128 v[44:47], v4 offset:35840
    v_max_f32 v96, 0, v96
    v_max_f32 v97, 0, v97
    v_max_f32 v98, 0, v98
    s_waitcnt lgkmcnt(2)
    v_mfma_f32_32x32x16_bf16 v[48:63], v[36:39], v[132:135], v[48:63]
    ds_read_b128 v[32:35], v4 offset:36864
    s_barrier
    v_max_f32 v99, 0, v99
    v_max_f32 v100, 0, v100
    v_max_f32 v101, 0, v101
    s_waitcnt lgkmcnt(2)
    v_mfma_f32_32x32x16_bf16 v[48:63], v[40:43], v[136:139], v[48:63]
    ds_read_b128 v[36:39], v4 offset:37888
    buffer_load_dwordx4 v1, s[4:7], s97 offen offset:1024 sc1  lds
    v_max_f32 v102, 0, v102
    s_waitcnt lgkmcnt(2)
    v_mfma_f32_32x32x16_bf16 v[48:63], v[44:47], v[140:143], v[48:63]
    ds_read_b128 v[40:43], v4 offset:38912
    v_max_f32 v103, 0, v103
    v_mul_f32 v96, v96, v104
    v_mul_f32 v97, v97, v105
    s_waitcnt lgkmcnt(2)
    v_mfma_f32_32x32x16_bf16 v[48:63], v[32:35], v[144:147], v[48:63]
    ds_read_b128 v[44:47], v4 offset:39936
    v_mul_f32 v98, v98, v106
    v_mul_f32 v99, v99, v107
    v_mul_f32 v100, v100, v108
    s_waitcnt lgkmcnt(2)
    v_mfma_f32_32x32x16_bf16 v[48:63], v[36:39], v[148:151], v[48:63]
    ds_read_b128 v[32:35], v4 offset:40960
    v_mul_f32 v101, v101, v109
    v_mul_f32 v102, v102, v110
    v_mul_f32 v103, v103, v111
    s_waitcnt lgkmcnt(2)
    v_mfma_f32_32x32x16_bf16 v[48:63], v[40:43], v[152:155], v[48:63]
    ds_read_b128 v[36:39], v4 offset:41984
    buffer_load_dwordx4 v1, s[4:7], s97 offen offset:2048 sc1  lds
    v_cvt_pk_bf16_f32 v104, v96, v97
    s_waitcnt lgkmcnt(2)
    v_mfma_f32_32x32x16_bf16 v[48:63], v[44:47], v[156:159], v[48:63]
    ds_read_b128 v[40:43], v4 offset:43008
    v_cvt_pk_bf16_f32 v105, v98, v99
    v_cvt_pk_bf16_f32 v106, v100, v101
    v_cvt_pk_bf16_f32 v107, v102, v103
    s_waitcnt lgkmcnt(2)
    v_mfma_f32_32x32x16_bf16 v[48:63], v[32:35], v[160:163], v[48:63]
WZ8:
    s_cbranch_execz WZRET
    ds_read_b128 v[44:47], v4 offset:44032
    s_add_u32 s59, s92, 32768
    buffer_store_dwordx4 v[104:107], v1, s[4:7], s59 offen offset:0 sc1
    s_waitcnt lgkmcnt(2)
    v_mfma_f32_32x32x16_bf16 v[48:63], v[36:39], v[164:167], v[48:63]
    ds_read_b128 v[32:35], v4 offset:45056
    buffer_load_dwordx4 v1, s[4:7], s97 offen offset:3072 sc1  lds
    v_max_f32 v112, 0, v112
    s_waitcnt lgkmcnt(2)
    v_mfma_f32_32x32x16_bf16 v[48:63], v[40:43], v[168:171], v[48:63]
    ds_read_b128 v[36:39], v4 offset:46080
    v_max_f32 v113, 0, v113
    v_max_f32 v114, 0, v114
    v_max_f32 v115, 0, v115
    s_waitcnt lgkmcnt(2)
    v_mfma_f32_32x32x16_bf16 v[48:63], v[44:47], v[172:175], v[48:63]
    ds_read_b128 v[40:43], v4 offset:47104
    v_max_f32 v116, 0, v116
    v_max_f32 v117, 0, v117
    v_max_f32 v118, 0, v118
    s_waitcnt lgkmcnt(2)
    v_mfma_f32_32x32x16_bf16 v[48:63], v[32:35], v[176:179], v[48:63]
    ds_read_b128 v[44:47], v4 offset:48128
    s_add_u32 s97, s99, 0x0
    s_add_u32 m0, s83, 0x4000
    v_max_f32 v119, 0, v119
    v_mul_f32 v112, v112, v120
    s_waitcnt lgkmcnt(2)
    v_mfma_f32_32x32x16_bf16 v[48:63], v[36:39], v[180:183], v[48:63]
    ds_read_b128 v[32:35], v4 offset:49152
    buffer_load_dwordx4 v1, s[4:7], s97 offen offset:0 sc1  lds
    v_mul_f32 v113, v113, v121
    s_waitcnt lgkmcnt(2)
    v_mfma_f32_32x32x16_bf16 v[48:63], v[40:43], v[184:187], v[48:63]
    ds_read_b128 v[36:39], v4 offset:50176
    v_mul_f32 v114, v114, v122
    v_mul_f32 v115, v115, v123
    v_mul_f32 v116, v116, v124
    s_waitcnt lgkmcnt(2)
    v_mfma_f32_32x32x16_bf16 v[48:63], v[44:47], v[188:191], v[48:63]
    ds_read_b128 v[40:43], v4 offset:51200
    v_mul_f32 v117, v117, v125
    v_mul_f32 v118, v118, v126
    v_mul_f32 v119, v119, v127
    s_waitcnt lgkmcnt(2)
    v_mfma_f32_32x32x16_bf16 v[48:63], v[32:35], v[192:195], v[48:63]
    ds_read_b128 v[44:47], v4 offset:52224
    buffer_load_dwordx4 v1, s[4:7], s97 offen offset:1024 sc1  lds
    v_cvt_pk_bf16_f32 v120, v112, v113
    s_waitcnt lgkmcnt(2)
    v_mfma_f32_32x32x16_bf16 v[48:63], v[36:39], v[196:199], v[48:63]
    ds_read_b128 v[32:35], v4 offset:53248
    v_cvt_pk_bf16_f32 v121, v114, v115
    v_cvt_pk_bf16_f32 v122, v116, v117
    v_cvt_pk_bf16_f32 v123, v118, v119
    s_waitcnt lgkmcnt(2)
    v_mfma_f32_32x32x16_bf16 v[48:63], v[40:43], v[200:203], v[48:63]
    ds_read_b128 v[36:39], v4 offset:54272
    s_add_u32 s59, s92, 49152
    buffer_store_dwordx4 v[120:123], v1, s[4:7], s59 offen offset:0 sc1
    s_waitcnt lgkmcnt(2)
    v_mfma_f32_32x32x16_bf16 v[48:63], v[44:47], v[204:207], v[48:63]
    ds_read_b128 v[40:43], v4 offset:55296
    v_max_f32 v80, 0, v80
    v_max_f32 v81, 0, v81
    v_max_f32 v82, 0, v82
    s_waitcnt lgkmcnt(2)
    v_mfma_f32_32x32x16_bf16 v[48:63], v[32:35], v[208:211], v[48:63]
    ds_read_b128 v[44:47], v4 offset:56320
    buffer_load_dwordx4 v1, s[4:7], s97 offen offset:2048 sc1  lds
    v_max_f32 v83, 0, v83
    s_waitcnt lgkmcnt(2)
    v_mfma_f32_32x32x16_bf16 v[48:63], v[36:39], v[212:215], v[48:63]
    ds_read_b128 v[32:35], v4 offset:57344
    v_max_f32 v84, 0, v84
    v_max_f32 v85, 0, v85
    v_max_f32 v86, 0, v86
    s_waitcnt lgkmcnt(2)
    v_mfma_f32_32x32x16_bf16 v[48:63], v[40:43], v[216:219], v[48:63]
    ds_read_b128 v[36:39], v4 offset:58368
    v_max_f32 v87, 0, v87
    v_mul_f32 v80, v80, v88
    v_mul_f32 v81, v81, v89
    s_waitcnt lgkmcnt(2)
    v_mfma_f32_32x32x16_bf16 v[48:63], v[44:47], v[220:223], v[48:63]
    ds_read_b128 v[40:43], v4 offset:59392
    buffer_load_dwordx4 v1, s[4:7], s97 offen offset:3072 sc1  lds
    v_mul_f32 v82, v82, v90
    s_waitcnt lgkmcnt(2)
    v_mfma_f32_32x32x16_bf16 v[48:63], v[32:35], v[224:227], v[48:63]
    ds_read_b128 v[44:47], v4 offset:60416
    v_mul_f32 v83, v83, v91
    v_mul_f32 v84, v84, v92
    v_mul_f32 v85, v85, v93
    s_waitcnt lgkmcnt(2)
    v_mfma_f32_32x32x16_bf16 v[48:63], v[36:39], v[228:231], v[48:63]
    ds_read_b128 v[32:35], v4 offset:61440
    v_mul_f32 v86, v86, v94
    v_mul_f32 v87, v87, v95
    v_cvt_pk_bf16_f32 v88, v80, v81
    s_waitcnt lgkmcnt(2)
    v_mfma_f32_32x32x16_bf16 v[48:63], v[40:43], v[232:235], v[48:63]
    ds_read_b128 v[36:39], v4 offset:62464
    s_add_u32 s97, s99, 0x8000
    s_add_u32 m0, s83, 0xc000
    v_cvt_pk_bf16_f32 v89, v82, v83
    v_cvt_pk_bf16_f32 v90, v84, v85
    s_waitcnt lgkmcnt(2)
    v_mfma_f32_32x32x16_bf16 v[48:63], v[44:47], v[236:239], v[48:63]
    ds_read_b128 v[40:43], v4 offset:63488
    buffer_load_dwordx4 v1, s[4:7], s97 offen offset:0 sc1  lds
    v_cvt_pk_bf16_f32 v91, v86, v87
    s_waitcnt lgkmcnt(2)
    v_mfma_f32_32x32x16_bf16 v[48:63], v[32:35], v[240:243], v[48:63]
    ds_read_b128 v[44:47], v4 offset:64512
    s_add_u32 s59, s92, 65536
    buffer_store_dwordx4 v[88:91], v1, s[4:7], s59 offen offset:0 sc1
    s_waitcnt lgkmcnt(2)
    v_mfma_f32_32x32x16_bf16 v[48:63], v[36:39], v[244:247], v[48:63]
    s_waitcnt vmcnt(16)
    s_barrier
    ds_read_b128 v[32:35], v4 offset:0
    s_waitcnt lgkmcnt(2)
    v_mfma_f32_32x32x16_bf16 v[48:63], v[40:43], v[248:251], v[48:63]
    ds_read_b128 v[36:39], v4 offset:1024
    buffer_load_dwordx4 v1, s[4:7], s97 offen offset:1024 sc1  lds
    s_waitcnt lgkmcnt(2)
    v_mfma_f32_32x32x16_bf16 v[48:63], v[44:47], v[252:255], v[48:63]
    ds_read_b128 v[40:43], v4 offset:2048
    s_waitcnt lgkmcnt(2)
    v_mfma_f32_32x32x16_bf16 v[64:79], v[32:35], v[128:131], 0
    ds_read_b128 v[44:47], v4 offset:3072
    s_waitcnt lgkmcnt(2)
    v_mfma_f32_32x32x16_bf16 v[64:79], v[36:39], v[132:135], v[64:79]
    ds_read_b128 v[32:35], v4 offset:4096
    s_nop 1
    v_max_f32 v48, 0, v48
    v_max_f32 v49, 0, v49
    v_max_f32 v50, 0, v50
    s_waitcnt lgkmcnt(2)
    v_mfma_f32_32x32x16_bf16 v[64:79], v[40:43], v[136:139], v[64:79]
    ds_read_b128 v[36:39], v4 offset:5120
    buffer_load_dwordx4 v1, s[4:7], s97 offen offset:2048 sc1  lds
    v_max_f32 v51, 0, v51
    s_waitcnt lgkmcnt(2)
    v_mfma_f32_32x32x16_bf16 v[64:79], v[44:47], v[140:143], v[64:79]
    ds_read_b128 v[40:43], v4 offset:6144
    v_max_f32 v52, 0, v52
    v_max_f32 v53, 0, v53
    v_max_f32 v54, 0, v54
    s_waitcnt lgkmcnt(2)
    v_mfma_f32_32x32x16_bf16 v[64:79], v[32:35], v[144:147], v[64:79]
    ds_read_b128 v[44:47], v4 offset:7168
    v_max_f32 v55, 0, v55
    v_mul_f32 v48, v48, v56
    v_mul_f32 v49, v49, v57
    s_waitcnt lgkmcnt(2)
    v_mfma_f32_32x32x16_bf16 v[64:79], v[36:39], v[148:151], v[64:79]
    ds_read_b128 v[32:35], v4 offset:8192
    buffer_load_dwordx4 v1, s[4:7], s97 offen offset:3072 sc1  lds
    v_mul_f32 v50, v50, v58
    s_waitcnt lgkmcnt(2)
    v_mfma_f32_32x32x16_bf16 v[64:79], v[40:43], v[152:155], v[64:79]
    ds_read_b128 v[36:39], v4 offset:9216
    v_mul_f32 v51, v51, v59
    v_mul_f32 v52, v52, v60
    v_mul_f32 v53, v53, v61
    s_waitcnt lgkmcnt(2)
    v_mfma_f32_32x32x16_bf16 v[64:79], v[44:47], v[156:159], v[64:79]
    ds_read_b128 v[40:43], v4 offset:10240
    v_mul_f32 v54, v54, v62
    v_mul_f32 v55, v55, v63
    v_cvt_pk_bf16_f32 v56, v48, v49
    s_waitcnt lgkmcnt(2)
    v_mfma_f32_32x32x16_bf16 v[64:79], v[32:35], v[160:163], v[64:79]
    ds_read_b128 v[44:47], v4 offset:11264
    v_cvt_pk_bf16_f32 v57, v50, v51
    v_cvt_pk_bf16_f32 v58, v52, v53
    v_cvt_pk_bf16_f32 v59, v54, v55
    s_waitcnt lgkmcnt(2)
    v_mfma_f32_32x32x16_bf16 v[64:79], v[36:39], v[164:167], v[64:79]
    ds_read_b128 v[32:35], v4 offset:12288
    s_add_u32 s59, s92, 81920
    buffer_store_dwordx4 v[56:59], v1, s[4:7], s59 offen offset:0 sc1
    s_waitcnt lgkmcnt(2)
    v_mfma_f32_32x32x16_bf16 v[64:79], v[40:43], v[168:171], v[64:79]
    ds_read_b128 v[36:39], v4 offset:13312
    v_add_f32 v16, v16, v24
    v_add_f32 v17, v17, v25
    s_waitcnt lgkmcnt(2)
    v_mfma_f32_32x32x16_bf16 v[64:79], v[44:47], v[172:175], v[64:79]
    ds_read_b128 v[40:43], v4 offset:14336
    v_add_f32 v18, v18, v26
    v_add_f32 v19, v19, v27
    v_add_f32 v20, v20, v28
    s_waitcnt lgkmcnt(2)
    v_mfma_f32_32x32x16_bf16 v[64:79], v[32:35], v[176:179], v[64:79]
    ds_read_b128 v[44:47], v4 offset:15360
    v_add_f32 v21, v21, v29
    v_add_f32 v22, v22, v30
    v_add_f32 v23, v23, v31
    s_waitcnt lgkmcnt(2)
    v_mfma_f32_32x32x16_bf16 v[64:79], v[36:39], v[180:183], v[64:79]
    ds_read_b128 v[32:35], v4 offset:16384
    v_add_f32 v16, v16, v20
    v_add_f32 v17, v17, v21
    v_add_f32 v18, v18, v22
    s_waitcnt lgkmcnt(2)
    v_mfma_f32_32x32x16_bf16 v[64:79], v[40:43], v[184:187], v[64:79]
    ds_read_b128 v[36:39], v4 offset:17408
    v_add_f32 v19, v19, v23
    s_waitcnt lgkmcnt(2)
    v_mfma_f32_32x32x16_bf16 v[64:79], v[44:47], v[188:191], v[64:79]
    ds_read_b128 v[40:43], v4 offset:18432
    v_permlane32_swap_b32 v16, v18
    s_waitcnt lgkmcnt(2)
    v_mfma_f32_32x32x16_bf16 v[64:79], v[32:35], v[192:195], v[64:79]
    ds_read_b128 v[44:47], v4 offset:19456
    v_permlane32_swap_b32 v17, v19
    s_waitcnt lgkmcnt(2)
    v_mfma_f32_32x32x16_bf16 v[64:79], v[36:39], v[196:199], v[64:79]
    ds_read_b128 v[32:35], v4 offset:20480
    v_add_f32 v16, v16, v18
    s_waitcnt lgkmcnt(2)
    v_mfma_f32_32x32x16_bf16 v[64:79], v[40:43], v[200:203], v[64:79]
    ds_read_b128 v[36:39], v4 offset:21504
    v_add_f32 v17, v17, v19
    s_waitcnt lgkmcnt(2)
    v_mfma_f32_32x32x16_bf16 v[64:79], v[44:47], v[204:207], v[64:79]
    ds_read_b128 v[40:43], v4 offset:22528
    v_permlane16_swap_b32 v16, v17
    s_waitcnt lgkmcnt(2)
    v_mfma_f32_32x32x16_bf16 v[64:79], v[32:35], v[208:211], v[64:79]
    ds_read_b128 v[44:47], v4 offset:23552
    v_add_f32 v16, v16, v17
    s_waitcnt lgkmcnt(2)
    v_mfma_f32_32x32x16_bf16 v[64:79], v[36:39], v[212:215], v[64:79]
    ds_read_b128 v[32:35], v4 offset:24576
    v_mul_f32 v16, 0x3b000000, v16
    s_waitcnt lgkmcnt(2)
    v_mfma_f32_32x32x16_bf16 v[64:79], v[40:43], v[216:219], v[64:79]
    ds_read_b128 v[36:39], v4 offset:25600
    v_mov_b32 v17, v16
    s_waitcnt lgkmcnt(2)
    v_mfma_f32_32x32x16_bf16 v[64:79], v[44:47], v[220:223], v[64:79]
    ds_read_b128 v[40:43], v4 offset:26624
    v_permlane32_swap_b32 v16, v17
    s_waitcnt lgkmcnt(2)
    v_mfma_f32_32x32x16_bf16 v[64:79], v[32:35], v[224:227], v[64:79]
    ds_read_b128 v[44:47], v4 offset:27648
    v_fma_f32 v17, -v16, v16, v17
    s_waitcnt lgkmcnt(2)
    v_mfma_f32_32x32x16_bf16 v[64:79], v[36:39], v[228:231], v[64:79]
    ds_read_b128 v[32:35], v4 offset:28672
    v_max_f32 v17, 0, v17
    s_waitcnt lgkmcnt(2)
    v_mfma_f32_32x32x16_bf16 v[64:79], v[40:43], v[232:235], v[64:79]
    ds_read_b128 v[36:39], v4 offset:29696
    v_add_f32 v17, 0x3727c5ac, v17
    s_waitcnt lgkmcnt(2)
    v_mfma_f32_32x32x16_bf16 v[64:79], v[44:47], v[236:239], v[64:79]
    ds_read_b128 v[40:43], v4 offset:30720
    v_rsq_f32 v6, v17
    s_waitcnt lgkmcnt(2)
    v_mfma_f32_32x32x16_bf16 v[64:79], v[32:35], v[240:243], v[64:79]
    ds_read_b128 v[44:47], v4 offset:31744
    v_mul_f32 v6, v6, v6
    s_waitcnt lgkmcnt(2)
    v_mfma_f32_32x32x16_bf16 v[64:79], v[36:39], v[244:247], v[64:79]
    s_waitcnt vmcnt(6)
    s_barrier
    ds_read_b128 v[32:35], v1 offset:0
    s_waitcnt lgkmcnt(2)
    v_mfma_f32_32x32x16_bf16 v[64:79], v[40:43], v[248:251], v[64:79]
    ds_read_b128 v[36:39], v1 offset:1024
    s_waitcnt lgkmcnt(2)
    v_mfma_f32_32x32x16_bf16 v[64:79], v[44:47], v[252:255], v[64:79]
    ds_read_b128 v[40:43], v1 offset:2048
    s_waitcnt lgkmcnt(2)
    v_mfma_f32_32x32x16_bf16 v[96:111], v[32:35], v[128:131], 0
    ds_read_b128 v[44:47], v1 offset:3072
    s_waitcnt lgkmcnt(2)
    v_mfma_f32_32x32x16_bf16 v[96:111], v[36:39], v[132:135], v[96:111]
    ds_read_b128 v[32:35], v1 offset:4096
    s_nop 1
    v_max_f32 v64, 0, v64
    v_max_f32 v65, 0, v65
    v_max_f32 v66, 0, v66
    s_waitcnt lgkmcnt(2)
    v_mfma_f32_32x32x16_bf16 v[96:111], v[40:43], v[136:139], v[96:111]
    ds_read_b128 v[36:39], v1 offset:5120
    v_max_f32 v67, 0, v67
    v_max_f32 v68, 0, v68
    v_max_f32 v69, 0, v69
    s_waitcnt lgkmcnt(2)
    v_mfma_f32_32x32x16_bf16 v[96:111], v[44:47], v[140:143], v[96:111]
    ds_read_b128 v[40:43], v1 offset:6144
    s_add_u32 s33, s74, 4
    v_mov_b32 v14, s33
    v_max_f32 v70, 0, v70
    v_max_f32 v71, 0, v71
    s_waitcnt lgkmcnt(2)
    v_mfma_f32_32x32x16_bf16 v[96:111], v[32:35], v[144:147], v[96:111]
    ds_read_b128 v[44:47], v1 offset:7168
    s_cmp_lg_u32 s36, 0
    s_waitcnt vmcnt(4)
    s_mov_b64 exec, 1
    s_cbranch_scc1 SIGS_66
    buffer_store_dword v14, off, s[4:7], s76
SIGB_67:
    s_mov_b64 exec, -1
    s_waitcnt lgkmcnt(2)
    v_mfma_f32_32x32x16_bf16 v[96:111], v[36:39], v[148:151], v[96:111]
    ds_read_b128 v[32:35], v1 offset:8192
    v_mul_f32 v64, v64, v72
    v_mul_f32 v65, v65, v73
    v_mul_f32 v66, v66, v74
    s_waitcnt lgkmcnt(2)
    v_mfma_f32_32x32x16_bf16 v[96:111], v[40:43], v[152:155], v[96:111]
    ds_read_b128 v[36:39], v1 offset:9216
    v_mul_f32 v67, v67, v75
    v_mul_f32 v68, v68, v76
    v_mul_f32 v69, v69, v77
    s_waitcnt lgkmcnt(2)
    v_mfma_f32_32x32x16_bf16 v[96:111], v[44:47], v[156:159], v[96:111]
    ds_read_b128 v[40:43], v1 offset:10240
    v_mul_f32 v70, v70, v78
    v_mul_f32 v71, v71, v79
    v_cvt_pk_bf16_f32 v72, v64, v65
    s_waitcnt lgkmcnt(2)
    v_mfma_f32_32x32x16_bf16 v[96:111], v[32:35], v[160:163], v[96:111]
    ds_read_b128 v[44:47], v1 offset:11264
    v_cvt_pk_bf16_f32 v73, v66, v67
    v_cvt_pk_bf16_f32 v74, v68, v69
    v_cvt_pk_bf16_f32 v75, v70, v71
    s_waitcnt lgkmcnt(2)
    v_mfma_f32_32x32x16_bf16 v[96:111], v[36:39], v[164:167], v[96:111]
    ds_read_b128 v[32:35], v1 offset:12288
    s_add_u32 s59, s92, 98304
    buffer_store_dwordx4 v[72:75], v1, s[4:7], s59 offen offset:0 sc1
    s_waitcnt lgkmcnt(2)
    v_mfma_f32_32x32x16_bf16 v[96:111], v[40:43], v[168:171], v[96:111]
    ds_read_b128 v[36:39], v1 offset:13312
    s_waitcnt lgkmcnt(2)
    v_mfma_f32_32x32x16_bf16 v[96:111], v[44:47], v[172:175], v[96:111]
    ds_read_b128 v[40:43], v1 offset:14336
    s_waitcnt lgkmcnt(2)
    v_mfma_f32_32x32x16_bf16 v[96:111], v[32:35], v[176:179], v[96:111]
    ds_read_b128 v[44:47], v1 offset:15360
    s_waitcnt lgkmcnt(2)
    v_mfma_f32_32x32x16_bf16 v[96:111], v[36:39], v[180:183], v[96:111]
    ds_read_b128 v[32:35], v1 offset:16384
    s_waitcnt lgkmcnt(2)
    v_mfma_f32_32x32x16_bf16 v[96:111], v[40:43], v[184:187], v[96:111]
    ds_read_b128 v[36:39], v1 offset:17408
    s_waitcnt lgkmcnt(2)
    v_mfma_f32_32x32x16_bf16 v[96:111], v[44:47], v[188:191], v[96:111]
    ds_read_b128 v[40:43], v1 offset:18432
    s_waitcnt lgkmcnt(2)
    v_mfma_f32_32x32x16_bf16 v[96:111], v[32:35], v[192:195], v[96:111]
    ds_read_b128 v[44:47], v1 offset:19456
    s_waitcnt lgkmcnt(2)
    v_mfma_f32_32x32x16_bf16 v[96:111], v[36:39], v[196:199], v[96:111]
    ds_read_b128 v[32:35], v1 offset:20480
    s_waitcnt lgkmcnt(2)
    v_mfma_f32_32x32x16_bf16 v[96:111], v[40:43], v[200:203], v[96:111]
    ds_read_b128 v[36:39], v1 offset:21504
    s_waitcnt lgkmcnt(2)
    v_mfma_f32_32x32x16_bf16 v[96:111], v[44:47], v[204:207], v[96:111]
    ds_read_b128 v[40:43], v1 offset:22528
    s_waitcnt lgkmcnt(2)
    v_mfma_f32_32x32x16_bf16 v[96:111], v[32:35], v[208:211], v[96:111]
    ds_read_b128 v[44:47], v1 offset:23552
    s_waitcnt lgkmcnt(2)
    v_mfma_f32_32x32x16_bf16 v[96:111], v[36:39], v[212:215], v[96:111]
    ds_read_b128 v[32:35], v1 offset:24576
    s_waitcnt lgkmcnt(2)
    v_mfma_f32_32x32x16_bf16 v[96:111], v[40:43], v[216:219], v[96:111]
    ds_read_b128 v[36:39], v1 offset:25600
    buffer_load_dword v7, v12, s[4:7], s75 offen sc1
    s_waitcnt lgkmcnt(2)
    v_mfma_f32_32x32x16_bf16 v[96:111], v[44:47], v[220:223], v[96:111]
    ds_read_b128 v[40:43], v1 offset:26624
    s_waitcnt lgkmcnt(2)
    v_mfma_f32_32x32x16_bf16 v[96:111], v[32:35], v[224:227], v[96:111]
    ds_read_b128 v[44:47], v1 offset:27648
    s_waitcnt lgkmcnt(2)
    v_mfma_f32_32x32x16_bf16 v[96:111], v[36:39], v[228:231], v[96:111]
    ds_read_b128 v[32:35], v1 offset:28672
    s_waitcnt lgkmcnt(2)
    v_mfma_f32_32x32x16_bf16 v[96:111], v[40:43], v[232:235], v[96:111]
    ds_read_b128 v[36:39], v1 offset:29696
    s_waitcnt lgkmcnt(2)
    v_mfma_f32_32x32x16_bf16 v[96:111], v[44:47], v[236:239], v[96:111]
    ds_read_b128 v[40:43], v1 offset:30720
    s_waitcnt lgkmcnt(2)
    v_mfma_f32_32x32x16_bf16 v[96:111], v[32:35], v[240:243], v[96:111]
    ds_read_b128 v[44:47], v1 offset:31744
    s_waitcnt lgkmcnt(2)
    v_mfma_f32_32x32x16_bf16 v[96:111], v[36:39], v[244:247], v[96:111]
    s_waitcnt vmcnt(4)
    s_barrier
    ds_read_b128 v[32:35], v1 offset:32768
    s_add_u32 s33, s74, 5
    v_mov_b32 v14, s33
    s_waitcnt lgkmcnt(2)
    v_mfma_f32_32x32x16_bf16 v[96:111], v[40:43], v[248:251], v[96:111]
    ds_read_b128 v[36:39], v1 offset:33792
    s_cmp_lg_u32 s36, 0
    s_waitcnt vmcnt(1)
    s_mov_b64 exec, 1
    s_cbranch_scc1 SIGS_68
    buffer_store_dword v14, off, s[4:7], s76
SIGB_69:
    s_mov_b64 exec, -1
    s_waitcnt lgkmcnt(2)
    v_mfma_f32_32x32x16_bf16 v[96:111], v[44:47], v[252:255], v[96:111]
    ds_read_b128 v[40:43], v1 offset:34816
    s_waitcnt lgkmcnt(2)
    v_mfma_f32_32x32x16_bf16 v[112:127], v[32:35], v[128:131], 0
    ds_read_b128 v[44:47], v1 offset:35840
    s_add_u32 s33, s74, 4
    s_waitcnt vmcnt(1)
    v_cmp_gt_u32 vcc, s33, v7
    s_and_b64 vcc, vcc, s[60:61]
    s_or_b64 vcc, vcc, s[36:37]
    s_cbranch_scc1 PFS_70
PFB_71:
    s_add_u32 s98, s94, 32768
    s_waitcnt lgkmcnt(2)
    v_mfma_f32_32x32x16_bf16 v[112:127], v[36:39], v[132:135], v[112:127]
    ds_read_b128 v[32:35], v1 offset:36864
    buffer_load_dwordx4 v[128:131], v1, s[4:7], s98 offen offset:0 sc1
    v_max_f32 v96, 0, v96
    v_max_f32 v97, 0, v97
    s_waitcnt lgkmcnt(2)
    v_mfma_f32_32x32x16_bf16 v[112:127], v[40:43], v[136:139], v[112:127]
    ds_read_b128 v[36:39], v1 offset:37888
    s_add_u32 s96, s93, 32768
    v_max_f32 v98, 0, v98
    v_max_f32 v99, 0, v99
    v_max_f32 v100, 0, v100
    s_waitcnt lgkmcnt(2)
    v_mfma_f32_32x32x16_bf16 v[112:127], v[44:47], v[140:143], v[112:127]
    ds_read_b128 v[40:43], v1 offset:38912
    buffer_load_dwordx4 v[132:135], v1, s[4:7], s96 offen offset:0 sc1
    v_max_f32 v101, 0, v101
    v_max_f32 v102, 0, v102
    s_waitcnt lgkmcnt(2)
    v_mfma_f32_32x32x16_bf16 v[112:127], v[32:35], v[144:147], v[112:127]
    ds_read_b128 v[44:47], v1 offset:39936
    v_max_f32 v103, 0, v103
    v_mul_f32 v96, v96, v104
    v_mul_f32 v97, v97, v105
    s_waitcnt lgkmcnt(2)
    v_mfma_f32_32x32x16_bf16 v[112:127], v[36:39], v[148:151], v[112:127]
    ds_read_b128 v[32:35], v1 offset:40960
    buffer_load_dwordx4 v[136:139], v1, s[4:7], s98 offen offset:1024 sc1
    v_mul_f32 v98, v98, v106
    v_mul_f32 v99, v99, v107
    s_waitcnt lgkmcnt(2)
    v_mfma_f32_32x32x16_bf16 v[112:127], v[40:43], v[152:155], v[112:127]
    ds_read_b128 v[36:39], v1 offset:41984
    v_mul_f32 v100, v100, v108
    v_mul_f32 v101, v101, v109
    v_mul_f32 v102, v102, v110
    s_waitcnt lgkmcnt(2)
    v_mfma_f32_32x32x16_bf16 v[112:127], v[44:47], v[156:159], v[112:127]
    ds_read_b128 v[40:43], v1 offset:43008
    buffer_load_dwordx4 v[140:143], v1, s[4:7], s96 offen offset:1024 sc1
    v_mul_f32 v103, v103, v111
    v_cvt_pk_bf16_f32 v104, v96, v97
    s_waitcnt lgkmcnt(2)
    v_mfma_f32_32x32x16_bf16 v[112:127], v[32:35], v[160:163], v[112:127]
    ds_read_b128 v[44:47], v1 offset:44032
    v_cvt_pk_bf16_f32 v105, v98, v99
    v_cvt_pk_bf16_f32 v106, v100, v101
    v_cvt_pk_bf16_f32 v107, v102, v103
    s_waitcnt lgkmcnt(2)
    v_mfma_f32_32x32x16_bf16 v[112:127], v[36:39], v[164:167], v[112:127]
    ds_read_b128 v[32:35], v1 offset:45056
    buffer_load_dwordx4 v[144:147], v1, s[4:7], s98 offen offset:2048 sc1
    s_add_u32 s59, s92, 0
    s_waitcnt lgkmcnt(2)
    v_mfma_f32_32x32x16_bf16 v[112:127], v[40:43], v[168:171], v[112:127]
    ds_read_b128 v[36:39], v1 offset:46080
    buffer_store_dwordx4 v[104:107], v1, s[4:7], s59 offen offset:0 nt
    s_waitcnt lgkmcnt(2)
    v_mfma_f32_32x32x16_bf16 v[112:127], v[44:47], v[172:175], v[112:127]
    ds_read_b128 v[40:43], v1 offset:47104
    buffer_load_dwordx4 v[148:151], v1, s[4:7], s96 offen offset:2048 sc1
    s_waitcnt lgkmcnt(2)
    v_mfma_f32_32x32x16_bf16 v[112:127], v[32:35], v[176:179], v[112:127]
    ds_read_b128 v[44:47], v1 offset:48128
    s_waitcnt lgkmcnt(2)
    v_mfma_f32_32x32x16_bf16 v[112:127], v[36:39], v[180:183], v[112:127]
    ds_read_b128 v[32:35], v1 offset:49152
    s_waitcnt lgkmcnt(2)
    v_mfma_f32_32x32x16_bf16 v[112:127], v[40:43], v[184:187], v[112:127]
    ds_read_b128 v[36:39], v1 offset:50176
    buffer_load_dwordx4 v[152:155], v1, s[4:7], s98 offen offset:3072 sc1
    s_waitcnt lgkmcnt(2)
    v_mfma_f32_32x32x16_bf16 v[112:127], v[44:47], v[188:191], v[112:127]
    ds_read_b128 v[40:43], v1 offset:51200
    s_waitcnt lgkmcnt(2)
    v_mfma_f32_32x32x16_bf16 v[112:127], v[32:35], v[192:195], v[112:127]
    ds_read_b128 v[44:47], v1 offset:52224
    buffer_load_dwordx4 v[156:159], v1, s[4:7], s96 offen offset:3072 sc1
    s_waitcnt lgkmcnt(2)
    v_mfma_f32_32x32x16_bf16 v[112:127], v[36:39], v[196:199], v[112:127]
    ds_read_b128 v[32:35], v1 offset:53248
    s_add_u32 s98, s94, 49152
    s_waitcnt lgkmcnt(2)
    v_mfma_f32_32x32x16_bf16 v[112:127], v[40:43], v[200:203], v[112:127]
    ds_read_b128 v[36:39], v1 offset:54272
    buffer_load_dwordx4 v[160:163], v1, s[4:7], s98 offen offset:0 sc1
    s_waitcnt lgkmcnt(2)
    v_mfma_f32_32x32x16_bf16 v[112:127], v[44:47], v[204:207], v[112:127]
    ds_read_b128 v[40:43], v1 offset:55296
    s_add_u32 s96, s93, 49152
    s_waitcnt lgkmcnt(2)
    v_mfma_f32_32x32x16_bf16 v[112:127], v[32:35], v[208:211], v[112:127]
    ds_read_b128 v[44:47], v1 offset:56320
    buffer_load_dword v7, v12, s[4:7], s75 offen sc1
    buffer_load_dwordx4 v[164:167], v1, s[4:7], s96 offen offset:0 sc1
    s_waitcnt lgkmcnt(2)
    v_mfma_f32_32x32x16_bf16 v[112:127], v[36:39], v[212:215], v[112:127]
    ds_read_b128 v[32:35], v1 offset:57344
    s_waitcnt lgkmcnt(2)
    v_mfma_f32_32x32x16_bf16 v[112:127], v[40:43], v[216:219], v[112:127]
    ds_read_b128 v[36:39], v1 offset:58368
    buffer_load_dwordx4 v[168:171], v1, s[4:7], s98 offen offset:1024 sc1
    s_waitcnt lgkmcnt(2)
    v_mfma_f32_32x32x16_bf16 v[112:127], v[44:47], v[220:223], v[112:127]
    ds_read_b128 v[40:43], v1 offset:59392
    s_waitcnt lgkmcnt(2)
    v_mfma_f32_32x32x16_bf16 v[112:127], v[32:35], v[224:227], v[112:127]
    ds_read_b128 v[44:47], v1 offset:60416
    s_waitcnt lgkmcnt(2)
    v_mfma_f32_32x32x16_bf16 v[112:127], v[36:39], v[228:231], v[112:127]
    ds_read_b128 v[32:35], v1 offset:61440
    buffer_load_dwordx4 v[172:175], v1, s[4:7], s96 offen offset:1024 sc1
    s_waitcnt lgkmcnt(2)
    v_mfma_f32_32x32x16_bf16 v[112:127], v[40:43], v[232:235], v[112:127]
    ds_read_b128 v[36:39], v1 offset:62464
    s_waitcnt lgkmcnt(2)
    v_mfma_f32_32x32x16_bf16 v[112:127], v[44:47], v[236:239], v[112:127]
    ds_read_b128 v[40:43], v1 offset:63488
    buffer_load_dwordx4 v[176:179], v1, s[4:7], s98 offen offset:2048 sc1
    s_waitcnt lgkmcnt(2)
    v_mfma_f32_32x32x16_bf16 v[112:127], v[32:35], v[240:243], v[112:127]
    ds_read_b128 v[44:47], v1 offset:64512
    s_waitcnt lgkmcnt(2)
    v_mfma_f32_32x32x16_bf16 v[112:127], v[36:39], v[244:247], v[112:127]
    buffer_load_dwordx4 v[180:183], v1, s[4:7], s96 offen offset:2048 sc1
    s_waitcnt lgkmcnt(1)
    v_mfma_f32_32x32x16_bf16 v[112:127], v[40:43], v[248:251], v[112:127]
    s_waitcnt lgkmcnt(0)
    v_mfma_f32_32x32x16_bf16 v[112:127], v[44:47], v[252:255], v[112:127]
    buffer_load_dwordx4 v[184:187], v1, s[4:7], s98 offen offset:3072 sc1
    s_waitcnt vmcnt(16)
    v_mfma_f32_32x32x16_bf16 v[32:47], a[20:23], v[128:131], 0
    v_mfma_f32_32x32x16_bf16 v[48:63], a[132:135], v[128:131], 0
    buffer_load_dwordx4 v[188:191], v1, s[4:7], s96 offen offset:3072 sc1
    s_nop 1
    v_max_f32 v112, 0, v112
    v_max_f32 v113, 0, v113
    v_max_f32 v114, 0, v114
    s_waitcnt vmcnt(16)
    v_mfma_f32_32x32x16_bf16 v[16:31], a[132:135], v[132:135], 0
    v_max_f32 v115, 0, v115
    v_max_f32 v116, 0, v116
    v_max_f32 v117, 0, v117
    v_max_f32 v118, 0, v118
    v_max_f32 v119, 0, v119
    v_mfma_f32_32x32x16_bf16 v[64:79], a[20:23], v[132:135], 0
    s_add_u32 s98, s94, 65536
    v_mul_f32 v112, v112, v120
    v_mul_f32 v113, v113, v121
    v_mul_f32 v114, v114, v122
    v_mul_f32 v115, v115, v123
    s_waitcnt vmcnt(15)
    v_mfma_f32_32x32x16_bf16 v[32:47], a[48:51], v[136:139], v[32:47]
    buffer_load_dwordx4 v[192:195], v1, s[4:7], s98 offen offset:0 sc1
    v_mul_f32 v116, v116, v124
    v_mul_f32 v117, v117, v125
    v_mul_f32 v118, v118, v126
    v_mfma_f32_32x32x16_bf16 v[48:63], a[160:163], v[136:139], v[48:63]
    s_add_u32 s33, s74, 6
    v_mov_b32 v14, s33
    v_mul_f32 v119, v119, v127
    v_cvt_pk_bf16_f32 v120, v112, v113
    v_cvt_pk_bf16_f32 v121, v114, v115
    s_waitcnt vmcnt(15)
    v_mfma_f32_32x32x16_bf16 v[16:31], a[160:163], v[140:143], v[16:31]
    s_cmp_lg_u32 s36, 0
    s_waitcnt vmcnt(13)
    s_mov_b64 exec, 1
    s_cbranch_scc1 SIGS_74
    buffer_store_dword v14, off, s[4:7], s76
SIGB_75:
    s_mov_b64 exec, -1
    s_add_u32 s96, s93, 65536
    v_mfma_f32_32x32x16_bf16 v[64:79], a[48:51], v[140:143], v[64:79]
    buffer_load_dwordx4 v[196:199], v1, s[4:7], s96 offen offset:0 sc1
    v_cvt_pk_bf16_f32 v122, v116, v117
    v_cvt_pk_bf16_f32 v123, v118, v119
    s_add_u32 s59, s92, 16384
    v_mfma_f32_32x32x16_bf16 v[32:47], a[76:79], v[144:147], v[32:47]
    buffer_store_dwordx4 v[120:123], v1, s[4:7], s59 offen offset:0 nt
    v_mfma_f32_32x32x16_bf16 v[48:63], a[188:191], v[144:147], v[48:63]
    buffer_load_dwordx4 v[200:203], v1, s[4:7], s98 offen offset:1024 sc1
    s_waitcnt vmcnt(16)
    v_mfma_f32_32x32x16_bf16 v[16:31], a[188:191], v[148:151], v[16:31]
    v_mfma_f32_32x32x16_bf16 v[64:79], a[76:79], v[148:151], v[64:79]
    buffer_load_dwordx4 v[204:207], v1, s[4:7], s96 offen offset:1024 sc1
    s_waitcnt vmcnt(16)
    v_mfma_f32_32x32x16_bf16 v[32:47], a[104:107], v[152:155], v[32:47]
    s_add_u32 s33, s74, 5
    s_waitcnt vmcnt(13)
    v_cmp_gt_u32 vcc, s33, v7
    s_and_b64 vcc, vcc, s[60:61]
    s_or_b64 vcc, vcc, s[36:37]
    s_cbranch_scc1 PFS_76
PFB_77:
    v_mfma_f32_32x32x16_bf16 v[48:63], a[216:219], v[152:155], v[48:63]
    buffer_load_dwordx4 v[208:211], v1, s[4:7], s98 offen offset:2048 sc1
    v_mfma_f32_32x32x16_bf16 v[16:31], a[216:219], v[156:159], v[16:31]
    v_mfma_f32_32x32x16_bf16 v[64:79], a[104:107], v[156:159], v[64:79]
    v_mfma_f32_32x32x16_bf16 v[32:47], a[24:27], v[160:163], v[32:47]
    buffer_load_dwordx4 v[212:215], v1, s[4:7], s96 offen offset:2048 sc1
    v_lshl_add_u32 v8, s68, 1, v5
    v_xor_b32 v9, 8192, v8
    v_xor_b32 v10, 16384, v8
    v_mfma_f32_32x32x16_bf16 v[48:63], a[136:139], v[160:163], v[48:63]
    v_xor_b32 v11, 24576, v8
    v_accvgpr_read_b32 v112, a224
    v_accvgpr_read_b32 v113, a225
    s_waitcnt vmcnt(14)
    v_mfma_f32_32x32x16_bf16 v[16:31], a[136:139], v[164:167], v[16:31]
    buffer_load_dwordx4 v[216:219], v1, s[4:7], s98 offen offset:3072 sc1
    v_accvgpr_read_b32 v114, a226
    v_accvgpr_read_b32 v115, a227
    v_accvgpr_read_b32 v116, a228
    v_mfma_f32_32x32x16_bf16 v[64:79], a[24:27], v[164:167], v[64:79]
    v_accvgpr_read_b32 v117, a229
    v_accvgpr_read_b32 v118, a230
    v_accvgpr_read_b32 v119, a231
    s_waitcnt vmcnt(14)
    v_mfma_f32_32x32x16_bf16 v[32:47], a[52:55], v[168:171], v[32:47]
    buffer_load_dwordx4 v[220:223], v1, s[4:7], s96 offen offset:3072 sc1
    v_accvgpr_read_b32 v120, a232
    v_accvgpr_read_b32 v121, a233
    v_accvgpr_read_b32 v122, a234
    v_mfma_f32_32x32x16_bf16 v[48:63], a[164:167], v[168:171], v[48:63]
    s_add_u32 s33, s74, 7
    v_mov_b32 v14, s33
    v_accvgpr_read_b32 v123, a235
    v_accvgpr_read_b32 v124, a236
    v_accvgpr_read_b32 v125, a237
    s_waitcnt vmcnt(14)
    v_mfma_f32_32x32x16_bf16 v[16:31], a[164:167], v[172:175], v[16:31]
    s_cmp_lg_u32 s36, 0
    s_waitcnt vmcnt(6)
WZ9:
    s_cbranch_execz WZRET
    s_mov_b64 exec, 1
    s_cbranch_scc1 SIGS_80
    buffer_store_dword v14, off, s[4:7], s76
SIGB_81:
    s_mov_b64 exec, -1
    s_add_u32 s98, s94, 81920
    v_mfma_f32_32x32x16_bf16 v[64:79], a[52:55], v[172:175], v[64:79]
    buffer_load_dwordx4 v[224:227], v1, s[4:7], s98 offen offset:0 sc1
    v_accvgpr_read_b32 v126, a238
    v_accvgpr_read_b32 v127, a239
    v_mfma_f32_32x32x16_bf16 v[32:47], a[80:83], v[176:179], v[32:47]
    s_add_u32 s96, s93, 81920
    v_mfma_f32_32x32x16_bf16 v[48:63], a[192:195], v[176:179], v[48:63]
    buffer_load_dwordx4 v[228:231], v1, s[4:7], s96 offen offset:0 sc1
    v_mfma_f32_32x32x16_bf16 v[16:31], a[192:195], v[180:183], v[16:31]
    v_mfma_f32_32x32x16_bf16 v[64:79], a[80:83], v[180:183], v[64:79]
    v_mfma_f32_32x32x16_bf16 v[32:47], a[108:111], v[184:187], v[32:47]
    buffer_load_dword v7, v12, s[4:7], s75 offen sc1
    buffer_load_dwordx4 v[232:235], v1, s[4:7], s98 offen offset:1024 sc1
    v_mfma_f32_32x32x16_bf16 v[48:63], a[220:223], v[184:187], v[48:63]
    v_mfma_f32_32x32x16_bf16 v[16:31], a[220:223], v[188:191], v[16:31]
    buffer_load_dwordx4 v[236:239], v1, s[4:7], s96 offen offset:1024 sc1
    v_mfma_f32_32x32x16_bf16 v[64:79], a[108:111], v[188:191], v[64:79]
    v_mfma_f32_32x32x16_bf16 v[32:47], a[8:11], v[192:195], v[32:47]
    buffer_load_dwordx4 v[240:243], v1, s[4:7], s98 offen offset:2048 sc1
    v_mfma_f32_32x32x16_bf16 v[48:63], a[120:123], v[192:195], v[48:63]
    v_mfma_f32_32x32x16_bf16 v[16:31], a[120:123], v[196:199], v[16:31]
    buffer_load_dwordx4 v[244:247], v1, s[4:7], s96 offen offset:2048 sc1
    v_mfma_f32_32x32x16_bf16 v[64:79], a[8:11], v[196:199], v[64:79]
    s_waitcnt vmcnt(13)
    v_mfma_f32_32x32x16_bf16 v[32:47], a[36:39], v[200:203], v[32:47]
    buffer_load_dwordx4 v[248:251], v1, s[4:7], s98 offen offset:3072 sc1
    v_mfma_f32_32x32x16_bf16 v[48:63], a[148:151], v[200:203], v[48:63]
    s_waitcnt vmcnt(13)
    v_mfma_f32_32x32x16_bf16 v[16:31], a[148:151], v[204:207], v[16:31]
    v_mfma_f32_32x32x16_bf16 v[64:79], a[36:39], v[204:207], v[64:79]
    buffer_load_dwordx4 v[252:255], v1, s[4:7], s96 offen offset:3072 sc1
    s_waitcnt vmcnt(13)
    v_mfma_f32_32x32x16_bf16 v[32:47], a[64:67], v[208:211], v[32:47]
    s_add_u32 s98, s94, 98304
    v_mfma_f32_32x32x16_bf16 v[48:63], a[176:179], v[208:211], v[48:63]
    buffer_load_dwordx4 v[128:131], v1, s[4:7], s98 offen offset:0 sc1
    s_waitcnt vmcnt(13)
    v_mfma_f32_32x32x16_bf16 v[16:31], a[176:179], v[212:215], v[16:31]
    s_add_u32 s96, s93, 98304
    v_mfma_f32_32x32x16_bf16 v[64:79], a[64:67], v[212:215], v[64:79]
    buffer_load_dwordx4 v[132:135], v1, s[4:7], s96 offen offset:0 sc1
    s_waitcnt vmcnt(13)
    v_mfma_f32_32x32x16_bf16 v[32:47], a[92:95], v[216:219], v[32:47]
    v_mfma_f32_32x32x16_bf16 v[48:63], a[204:207], v[216:219], v[48:63]
    buffer_load_dwordx4 v[136:139], v1, s[4:7], s98 offen offset:1024 sc1
    s_waitcnt vmcnt(13)
    v_mfma_f32_32x32x16_bf16 v[16:31], a[204:207], v[220:223], v[16:31]
    v_mfma_f32_32x32x16_bf16 v[64:79], a[92:95], v[220:223], v[64:79]
    buffer_load_dwordx4 v[140:143], v1, s[4:7], s96 offen offset:1024 sc1
    s_waitcnt vmcnt(12)
    v_mfma_f32_32x32x16_bf16 v[32:47], a[12:15], v[224:227], v[32:47]
    s_add_u32 s33, s74, 6
    s_waitcnt vmcnt(10)
    v_cmp_gt_u32 vcc, s33, v7
    s_and_b64 vcc, vcc, s[60:61]
    s_or_b64 vcc, vcc, s[36:37]
    s_cbranch_scc1 PFS_82
PFB_83:
    v_mfma_f32_32x32x16_bf16 v[48:63], a[124:127], v[224:227], v[48:63]
    v_mfma_f32_32x32x16_bf16 v[16:31], a[124:127], v[228:231], v[16:31]
    buffer_load_dwordx4 v[144:147], v1, s[4:7], s98 offen offset:2048 sc1
    v_mfma_f32_32x32x16_bf16 v[64:79], a[12:15], v[228:231], v[64:79]
    s_waitcnt vmcnt(10)
    v_mfma_f32_32x32x16_bf16 v[32:47], a[40:43], v[232:235], v[32:47]
    buffer_load_dwordx4 v[148:151], v1, s[4:7], s96 offen offset:2048 sc1
    v_mfma_f32_32x32x16_bf16 v[48:63], a[152:155], v[232:235], v[48:63]
    buffer_load_dword v7, v12, s[4:7], s75 offen sc1
    s_waitcnt vmcnt(11)
    v_mfma_f32_32x32x16_bf16 v[16:31], a[152:155], v[236:239], v[16:31]
    buffer_load_dwordx4 v[152:155], v1, s[4:7], s98 offen offset:3072 sc1
    v_mfma_f32_32x32x16_bf16 v[64:79], a[40:43], v[236:239], v[64:79]
    s_waitcnt vmcnt(11)
    v_mfma_f32_32x32x16_bf16 v[32:47], a[68:71], v[240:243], v[32:47]
    buffer_load_dwordx4 v[156:159], v1, s[4:7], s96 offen offset:3072 sc1
    v_mfma_f32_32x32x16_bf16 v[48:63], a[180:183], v[240:243], v[48:63]
    s_add_u32 s98, s94, 0
    s_waitcnt vmcnt(11)
    v_mfma_f32_32x32x16_bf16 v[16:31], a[180:183], v[244:247], v[16:31]
    buffer_load_dwordx4 v[160:163], v1, s[4:7], s98 offen offset:0 sc1
    v_mfma_f32_32x32x16_bf16 v[64:79], a[68:71], v[244:247], v[64:79]
    s_waitcnt vmcnt(11)
    v_mfma_f32_32x32x16_bf16 v[32:47], a[96:99], v[248:251], v[32:47]
    v_mfma_f32_32x32x16_bf16 v[48:63], a[208:211], v[248:251], v[48:63]
    buffer_load_dwordx4 v[164:167], v1, s[4:7], s98 offen offset:1024 sc1
    s_waitcnt vmcnt(11)
    v_mfma_f32_32x32x16_bf16 v[16:31], a[208:211], v[252:255], v[16:31]
    v_mfma_f32_32x32x16_bf16 v[64:79], a[96:99], v[252:255], v[64:79]
    buffer_load_dwordx4 v[168:171], v1, s[4:7], s98 offen offset:2048 sc1
    s_waitcnt vmcnt(11)
    v_mfma_f32_32x32x16_bf16 v[32:47], a[16:19], v[128:131], v[32:47]
    s_add_u32 s33, s74, 7
    s_waitcnt vmcnt(5)
    v_cmp_gt_u32 vcc, s33, v7
    s_and_b64 vcc, vcc, s[60:61]
    s_or_b64 vcc, vcc, s[36:37]
    s_cbranch_scc1 PFS_86
PFB_87:
    v_mfma_f32_32x32x16_bf16 v[48:63], a[128:131], v[128:131], v[48:63]
    buffer_load_dwordx4 v[172:175], v1, s[4:7], s98 offen offset:3072 sc1
    v_mfma_f32_32x32x16_bf16 v[16:31], a[128:131], v[132:135], v[16:31]
    s_add_u32 s96, s93, 0
    v_mfma_f32_32x32x16_bf16 v[64:79], a[16:19], v[132:135], v[64:79]
    buffer_load_dwordx4 v[176:179], v1, s[4:7], s96 offen offset:0 sc1
    v_mfma_f32_32x32x16_bf16 v[32:47], a[44:47], v[136:139], v[32:47]
    v_mfma_f32_32x32x16_bf16 v[48:63], a[156:159], v[136:139], v[48:63]
    buffer_load_dwordx4 v[180:183], v1, s[4:7], s96 offen offset:1024 sc1
    v_mfma_f32_32x32x16_bf16 v[16:31], a[156:159], v[140:143], v[16:31]
    v_mfma_f32_32x32x16_bf16 v[64:79], a[44:47], v[140:143], v[64:79]
    v_mfma_f32_32x32x16_bf16 v[32:47], a[72:75], v[144:147], v[32:47]
    buffer_load_dwordx4 v[184:187], v1, s[4:7], s96 offen offset:2048 sc1
    v_mfma_f32_32x32x16_bf16 v[48:63], a[184:187], v[144:147], v[48:63]
    v_mfma_f32_32x32x16_bf16 v[16:31], a[184:187], v[148:151], v[16:31]
    buffer_load_dwordx4 v[188:191], v1, s[4:7], s96 offen offset:3072 sc1
    v_mfma_f32_32x32x16_bf16 v[64:79], a[72:75], v[148:151], v[64:79]
    s_add_u32 s98, s94, 16384
    s_waitcnt vmcnt(9)
    v_mfma_f32_32x32x16_bf16 v[32:47], a[100:103], v[152:155], v[32:47]
    buffer_load_dwordx4 v[192:195], v1, s[4:7], s98 offen offset:0 sc1
    v_mfma_f32_32x32x16_bf16 v[48:63], a[212:215], v[152:155], v[48:63]
    s_waitcnt vmcnt(9)
    v_mfma_f32_32x32x16_bf16 v[16:31], a[212:215], v[156:159], v[16:31]
    buffer_load_dwordx4 v[196:199], v1, s[4:7], s98 offen offset:1024 sc1
    v_mfma_f32_32x32x16_bf16 v[64:79], a[100:103], v[156:159], v[64:79]
    s_waitcnt vmcnt(9)
    v_mfma_f32_32x32x16_bf16 v[32:47], a[0:3], v[160:163], v[32:47]
    buffer_load_dwordx4 v[200:203], v1, s[4:7], s98 offen offset:2048 sc1
    v_mfma_f32_32x32x16_bf16 v[48:63], a[112:115], v[160:163], v[48:63]
    s_waitcnt vmcnt(9)
    v_mfma_f32_32x32x16_bf16 v[32:47], a[28:31], v[164:167], v[32:47]
    v_mfma_f32_32x32x16_bf16 v[48:63], a[140:143], v[164:167], v[48:63]
    buffer_load_dwordx4 v[204:207], v1, s[4:7], s98 offen offset:3072 sc1
    s_waitcnt vmcnt(9)
    v_mfma_f32_32x32x16_bf16 v[32:47], a[56:59], v[168:171], v[32:47]
    s_add_u32 s96, s93, 16384
    v_mfma_f32_32x32x16_bf16 v[48:63], a[168:171], v[168:171], v[48:63]
    buffer_load_dwordx4 v[208:211], v1, s[4:7], s96 offen offset:0 sc1
    s_waitcnt vmcnt(9)
    v_mfma_f32_32x32x16_bf16 v[32:47], a[84:87], v[172:175], v[32:47]
    v_mfma_f32_32x32x16_bf16 v[48:63], a[196:199], v[172:175], v[48:63]
    buffer_load_dwordx4 v[212:215], v1, s[4:7], s96 offen offset:1024 sc1
    s_waitcnt vmcnt(5)
    v_mfma_f32_32x32x16_bf16 v[32:47], a[4:7], v[192:195], v[32:47]
    s_waitcnt vmcnt(4)
    v_mfma_f32_32x32x16_bf16 v[32:47], a[32:35], v[196:199], v[32:47]
    buffer_load_dwordx4 v[216:219], v1, s[4:7], s96 offen offset:2048 sc1
    s_waitcnt vmcnt(4)
    v_mfma_f32_32x32x16_bf16 v[32:47], a[60:63], v[200:203], v[32:47]
    s_waitcnt vmcnt(3)
    v_mfma_f32_32x32x16_bf16 v[32:47], a[88:91], v[204:207], v[32:47]
    buffer_load_dwordx4 v[220:223], v1, s[4:7], s96 offen offset:3072 sc1
    v_mfma_f32_32x32x16_bf16 v[48:63], a[116:119], v[192:195], v[48:63]
    v_mfma_f32_32x32x16_bf16 v[48:63], a[144:147], v[196:199], v[48:63]
    v_mfma_f32_32x32x16_bf16 v[48:63], a[172:175], v[200:203], v[48:63]
    v_cvt_pk_bf16_f32 v32, v32, v33
    v_cvt_pk_bf16_f32 v33, v34, v35
    v_cvt_pk_bf16_f32 v34, v36, v37
    v_cvt_pk_bf16_f32 v35, v38, v39
    v_mfma_f32_32x32x16_bf16 v[48:63], a[200:203], v[204:207], v[48:63]
    ds_write_b128 v10, v[32:35] offset:0
    v_cvt_pk_bf16_f32 v36, v40, v41
    v_cvt_pk_bf16_f32 v37, v42, v43
    v_cvt_pk_bf16_f32 v38, v44, v45
    v_cvt_pk_bf16_f32 v39, v46, v47
    v_mfma_f32_32x32x16_bf16 v[16:31], a[112:115], v[176:179], v[16:31]
    ds_write_b128 v10, v[36:39] offset:1024
    v_mfma_f32_32x32x16_bf16 v[16:31], a[140:143], v[180:183], v[16:31]
    v_mfma_f32_32x32x16_bf16 v[16:31], a[168:171], v[184:187], v[16:31]
    v_cvt_pk_bf16_f32 v48, v48, v49
    v_cvt_pk_bf16_f32 v49, v50, v51
    v_cvt_pk_bf16_f32 v50, v52, v53
    v_cvt_pk_bf16_f32 v51, v54, v55
    v_mfma_f32_32x32x16_bf16 v[16:31], a[196:199], v[188:191], v[16:31]
    ds_write_b128 v11, v[48:51] offset:2048
    v_cvt_pk_bf16_f32 v52, v56, v57
    v_cvt_pk_bf16_f32 v53, v58, v59
    v_cvt_pk_bf16_f32 v54, v60, v61
    v_cvt_pk_bf16_f32 v55, v62, v63
    s_waitcnt vmcnt(3)
    v_mfma_f32_32x32x16_bf16 v[16:31], a[116:119], v[208:211], v[16:31]
    ds_write_b128 v11, v[52:55] offset:3072
    s_waitcnt vmcnt(2)
    v_mfma_f32_32x32x16_bf16 v[16:31], a[144:147], v[212:215], v[16:31]
    s_waitcnt vmcnt(1)
    v_mfma_f32_32x32x16_bf16 v[16:31], a[172:175], v[216:219], v[16:31]
    s_waitcnt vmcnt(0)
    v_mfma_f32_32x32x16_bf16 v[16:31], a[200:203], v[220:223], v[16:31]
    v_mfma_f32_32x32x16_bf16 v[64:79], a[0:3], v[176:179], v[64:79]
    s_waitcnt lgkmcnt(0)
    s_barrier
    ds_read_b128 v[80:83], v8 offset:0
    ds_read_b128 v[84:87], v8 offset:1024
    v_mfma_f32_32x32x16_bf16 v[64:79], a[28:31], v[180:183], v[64:79]
    ds_read_b128 v[88:91], v8 offset:2048
    ds_read_b128 v[92:95], v8 offset:3072
    v_mfma_f32_32x32x16_bf16 v[64:79], a[56:59], v[184:187], v[64:79]
    v_cvt_pk_bf16_f32 v16, v16, v17
    v_cvt_pk_bf16_f32 v17, v18, v19
    v_cvt_pk_bf16_f32 v18, v20, v21
    v_cvt_pk_bf16_f32 v19, v22, v23
    v_mfma_f32_32x32x16_bf16 v[64:79], a[84:87], v[188:191], v[64:79]
    ds_write_b128 v9, v[16:19] offset:4096
    v_cvt_pk_bf16_f32 v20, v24, v25
    v_cvt_pk_bf16_f32 v21, v26, v27
    v_cvt_pk_bf16_f32 v22, v28, v29
    v_cvt_pk_bf16_f32 v23, v30, v31
    v_mfma_f32_32x32x16_bf16 v[64:79], a[4:7], v[208:211], v[64:79]
    ds_write_b128 v9, v[20:23] offset:5120
    v_mfma_f32_32x32x16_bf16 v[64:79], a[32:35], v[212:215], v[64:79]
    v_mfma_f32_32x32x16_bf16 v[64:79], a[60:63], v[216:219], v[64:79]
    v_mfma_f32_32x32x16_bf16 v[64:79], a[88:91], v[220:223], v[64:79]
    s_waitcnt lgkmcnt(5)
    v_mfma_f32_32x32x16_bf16 v[64:79], a[240:243], v[80:83], v[64:79]
    s_waitcnt lgkmcnt(0)
    s_barrier
    ds_read_b128 v[96:99], v8 offset:4096
    ds_read_b128 v[100:103], v8 offset:5120
    v_mfma_f32_32x32x16_bf16 v[64:79], a[244:247], v[84:87], v[64:79]
    v_mfma_f32_32x32x16_bf16 v[64:79], a[240:243], v[88:91], v[64:79]
    v_mfma_f32_32x32x16_bf16 v[64:79], a[244:247], v[92:95], v[64:79]
    s_waitcnt lgkmcnt(1)
    v_mfma_f32_32x32x16_bf16 v[64:79], a[240:243], v[96:99], v[64:79]
    s_waitcnt lgkmcnt(0)
    v_mfma_f32_32x32x16_bf16 v[64:79], a[244:247], v[100:103], v[64:79]
    s_nop 11
    v_pk_fma_f32 v[64:65], v[64:65], v[6:7], v[112:113] op_sel_hi:[1,0,1]
    v_pk_fma_f32 v[66:67], v[66:67], v[6:7], v[114:115] op_sel_hi:[1,0,1]
    v_pk_fma_f32 v[68:69], v[68:69], v[6:7], v[116:117] op_sel_hi:[1,0,1]
    v_pk_fma_f32 v[70:71], v[70:71], v[6:7], v[118:119] op_sel_hi:[1,0,1]
    v_pk_fma_f32 v[72:73], v[72:73], v[6:7], v[120:121] op_sel_hi:[1,0,1]
    v_pk_fma_f32 v[74:75], v[74:75], v[6:7], v[122:123] op_sel_hi:[1,0,1]
    v_pk_fma_f32 v[76:77], v[76:77], v[6:7], v[124:125] op_sel_hi:[1,0,1]
    v_pk_fma_f32 v[78:79], v[78:79], v[6:7], v[126:127] op_sel_hi:[1,0,1]
    v_cvt_pk_bf16_f32 v80, v64, v65
    v_cvt_pk_bf16_f32 v81, v66, v67
    v_cvt_pk_bf16_f32 v82, v68, v69
    v_cvt_pk_bf16_f32 v83, v70, v71
    v_cvt_pk_bf16_f32 v84, v72, v73
    v_cvt_pk_bf16_f32 v85, v74, v75
    v_cvt_pk_bf16_f32 v86, v76, v77
    v_cvt_pk_bf16_f32 v87, v78, v79
    v_and_b32 v8, 31, v0
    v_lshlrev_b32 v8, 10, v8
    v_lshrrev_b32 v9, 5, v0
    v_lshl_add_u32 v8, v9, 4, v8
    v_permlane32_swap_b32 v80, v82
    v_permlane32_swap_b32 v81, v83
    v_permlane32_swap_b32 v84, v86
    v_permlane32_swap_b32 v85, v87
    buffer_store_dwordx4 v[80:83], v8, s[12:15], s69 offen offset:0
    buffer_store_dwordx4 v[84:87], v8, s[12:15], s69 offen offset:32
FIN:
    s_waitcnt vmcnt(0)
END:
    s_endpgm
GO_SPIN:
    s_mov_b32 s35, 0
GO_LP:
    buffer_load_dword v7, v2, s[16:19], 0 offen sc1
    s_add_u32 s35, s35, 1
    s_waitcnt vmcnt(0)
    v_cmp_eq_u32 vcc, 0, v7
    s_and_b64 vcc, vcc, 0xff
    s_cbranch_scc0 GO_OK
    s_cmp_lt_u32 s35, 400000
    s_cbranch_scc1 GO_LP
    s_branch GO_OK
P0_SPIN:
    s_mov_b32 s33, 1
    s_mov_b32 s95, 0
    s_mov_b64 exec, s[38:39]
POLL_2:
    buffer_load_dword v7, v13, s[4:7], 0 offen sc1
    s_add_u32 s95, s95, 1
    s_waitcnt vmcnt(0)
    v_cmp_ne_u32 s[36:37], s40, v7
    v_cmp_gt_u32 vcc, s33, v7
    s_and_b64 vcc, vcc, s[38:39]
    s_cbranch_scc0 PDONE_3
    s_cmp_lt_u32 s95, 400000
    s_cbranch_scc1 POLL_2
PDONE_3:
    s_mov_b64 exec, -1
    s_waitcnt vmcnt(0)
    s_branch P0_OK
KV_RETRY0:
    s_mov_b32 s95, 0
    s_mov_b32 s34, 0
    s_add_u32 s33, s31, 1
    v_lshrrev_b32 v14, 2, v0
    v_lshlrev_b32 v14, 7, v14
    v_and_b32 v7, 3, v0
    v_lshl_add_u32 v14, v7, 2, v14
    v_add_u32 v14, s77, v14
KV_LOOP0:
    s_xor_b32 s98, s86, 0x0
    buffer_load_dwordx4 v[48:51], v1, s[4:7], s98 offen offset:0 sc1
    buffer_load_dwordx4 v[52:55], v1, s[4:7], s98 offen offset:1024 sc1
    buffer_load_dwordx4 v[56:59], v1, s[4:7], s98 offen offset:2048 sc1
    buffer_load_dwordx4 v[60:63], v1, s[4:7], s98 offen offset:3072 sc1
    s_xor_b32 s98, s86, 0x1000
    buffer_load_dwordx4 v[64:67], v1, s[4:7], s98 offen offset:0 sc1
    buffer_load_dwordx4 v[68:71], v1, s[4:7], s98 offen offset:1024 sc1
    buffer_load_dwordx4 v[72:75], v1, s[4:7], s98 offen offset:2048 sc1
    buffer_load_dwordx4 v[76:79], v1, s[4:7], s98 offen offset:3072 sc1
    buffer_load_dword v80, v84, s[4:7], s88 offen offset:0 sc1
    buffer_load_dword v81, v84, s[4:7], s88 offen offset:256 sc1
    buffer_load_dword v82, v84, s[4:7], s88 offen offset:512 sc1
    buffer_load_dword v83, v84, s[4:7], s88 offen offset:768 sc1
    buffer_load_dword v7, v14, s[4:7], 0 offen sc1
    s_waitcnt vmcnt(12)
    v_mfma_f32_32x32x16_bf16 v[192:207], v[48:51], a[240:243], 0
    s_waitcnt vmcnt(11)
    v_mfma_f32_32x32x16_bf16 v[192:207], v[52:55], a[240:243], v[192:207]
    s_waitcnt vmcnt(10)
    v_mfma_f32_32x32x16_bf16 v[192:207], v[56:59], a[240:243], v[192:207]
    s_waitcnt vmcnt(9)
    v_mfma_f32_32x32x16_bf16 v[192:207], v[60:63], a[240:243], v[192:207]
    s_waitcnt vmcnt(8)
    v_mfma_f32_32x32x16_bf16 v[192:207], v[64:67], a[240:243], v[192:207]
    s_waitcnt vmcnt(7)
    v_mfma_f32_32x32x16_bf16 v[192:207], v[68:71], a[240:243], v[192:207]
    s_waitcnt vmcnt(6)
    v_mfma_f32_32x32x16_bf16 v[192:207], v[72:75], a[240:243], v[192:207]
    s_waitcnt vmcnt(5)
    v_mfma_f32_32x32x16_bf16 v[192:207], v[76:79], a[240:243], v[192:207]
    s_waitcnt vmcnt(1)
    v_mfma_f32_32x32x16_bf16 v[192:207], v[80:83], a[252:255], v[192:207]
    s_nop 11
    v_cvt_pk_bf16_f32 v208, v192, v193
    v_cvt_pk_bf16_f32 v209, v194, v195
    v_cvt_pk_bf16_f32 v210, v196, v197
    v_cvt_pk_bf16_f32 v211, v198, v199
    v_cvt_pk_bf16_f32 v212, v200, v201
    v_cvt_pk_bf16_f32 v213, v202, v203
    v_cvt_pk_bf16_f32 v214, v204, v205
    v_cvt_pk_bf16_f32 v215, v206, v207
    ds_write_b128 v85, v[208:211] offset:0
    ds_write_b128 v85, v[212:215] offset:1024
    v_pk_add_f32 v[192:193], v[192:193], v[200:201]
    v_pk_add_f32 v[194:195], v[194:195], v[202:203]
    v_pk_add_f32 v[196:197], v[196:197], v[204:205]
    v_pk_add_f32 v[198:199], v[198:199], v[206:207]
    v_pk_add_f32 v[192:193], v[192:193], v[196:197]
    v_pk_add_f32 v[194:195], v[194:195], v[198:199]
    v_pk_add_f32 v[192:193], v[192:193], v[194:195]
    v_cmp_u_f32 vcc, v192, v193
    s_waitcnt vmcnt(0)
    s_cbranch_vccz KV_OK0
    s_cmp_lg_u32 s34, 0
    s_cbranch_scc1 KV_OK0
    v_cmp_gt_u32 vcc, s33, v7
    s_and_b64 vcc, vcc, s[64:65]
    s_cselect_b32 s34, 0, 1
    s_add_u32 s95, s95, 1
    s_cmp_lt_u32 s95, 400000
    s_cbranch_scc1 KV_LOOP0
    s_branch KV_OK0
SIGS_7:
    s_waitcnt vmcnt(0)
    buffer_wbl2 sc1
    s_waitcnt vmcnt(0)
    buffer_store_dword v7, off, s[4:7], s76 sc1
    s_nop 15
    s_branch SIGB_8
ACQS_11:
    s_waitcnt vmcnt(0)
    buffer_inv sc1
    s_waitcnt vmcnt(0)
    s_branch ACQB_12
SIGS_13:
    s_waitcnt vmcnt(0)
    buffer_wbl2 sc1
    s_waitcnt vmcnt(0)
    buffer_store_dword v7, off, s[4:7], s62 sc1
    s_nop 15
    s_branch SIGB_14
ACQS_17:
    s_waitcnt vmcnt(0)
    buffer_inv sc1
    s_waitcnt vmcnt(0)
    s_branch ACQB_18
SIGS_20:
    s_waitcnt vmcnt(0)
    buffer_wbl2 sc1
    s_waitcnt vmcnt(0)
    buffer_store_dword v14, off, s[4:7], s76 sc1
    s_nop 15
    s_branch SIGB_21
SIGS_22:
    s_waitcnt vmcnt(0)
    buffer_wbl2 sc1
    s_waitcnt vmcnt(0)
    buffer_store_dword v14, off, s[4:7], s76 sc1
    s_nop 15
    s_branch SIGB_23
PFS_24:
    s_mov_b32 s95, 0
PFL_26:
    buffer_load_dword v7, v12, s[4:7], s75 offen sc1
    s_add_u32 s95, s95, 1
    s_waitcnt vmcnt(0)
    v_cmp_gt_u32 vcc, s33, v7
    s_and_b64 vcc, vcc, s[60:61]
    s_cbranch_scc0 PFD_27
    s_cmp_lt_u32 s95, 400000
    s_cbranch_scc1 PFL_26
PFD_27:
    s_nop 15
    s_cmp_eq_u32 s36, 0
    s_cbranch_scc1 PFB_25
    buffer_inv sc1
    s_waitcnt vmcnt(0)
    s_branch PFB_25
SIGS_28:
    s_waitcnt vmcnt(0)
    buffer_wbl2 sc1
    s_waitcnt vmcnt(0)
    buffer_store_dword v14, off, s[4:7], s76 sc1
    s_nop 15
    s_branch SIGB_29
PFS_30:
    s_mov_b32 s95, 0
PFL_32:
    buffer_load_dword v7, v12, s[4:7], s75 offen sc1
    s_add_u32 s95, s95, 1
    s_waitcnt vmcnt(0)
    v_cmp_gt_u32 vcc, s33, v7
    s_and_b64 vcc, vcc, s[60:61]
    s_cbranch_scc0 PFD_33
    s_cmp_lt_u32 s95, 400000
    s_cbranch_scc1 PFL_32
PFD_33:
    s_nop 15
    s_cmp_eq_u32 s36, 0
    s_cbranch_scc1 PFB_31
    buffer_inv sc1
    s_waitcnt vmcnt(0)
    s_branch PFB_31
SIGS_34:
    s_waitcnt vmcnt(0)
    buffer_wbl2 sc1
    s_waitcnt vmcnt(0)
    buffer_store_dword v14, off, s[4:7], s76 sc1
    s_nop 15
    s_branch SIGB_35
PFS_36:
    s_mov_b32 s95, 0
PFL_38:
    buffer_load_dword v7, v12, s[4:7], s75 offen sc1
    s_add_u32 s95, s95, 1
    s_waitcnt vmcnt(0)
    v_cmp_gt_u32 vcc, s33, v7
    s_and_b64 vcc, vcc, s[60:61]
    s_cbranch_scc0 PFD_39
    s_cmp_lt_u32 s95, 400000
    s_cbranch_scc1 PFL_38
PFD_39:
    s_nop 15
    s_cmp_eq_u32 s36, 0
    s_cbranch_scc1 PFB_37
    buffer_inv sc1
    s_waitcnt vmcnt(0)
    s_branch PFB_37
PFS_40:
    s_mov_b32 s95, 0
PFL_42:
    buffer_load_dword v7, v12, s[4:7], s75 offen sc1
    s_add_u32 s95, s95, 1
    s_waitcnt vmcnt(0)
    v_cmp_gt_u32 vcc, s33, v7
    s_and_b64 vcc, vcc, s[60:61]
    s_cbranch_scc0 PFD_43
    s_cmp_lt_u32 s95, 400000
    s_cbranch_scc1 PFL_42
PFD_43:
    s_nop 15
    s_cmp_eq_u32 s36, 0
    s_cbranch_scc1 PFB_41
    buffer_inv sc1
    s_waitcnt vmcnt(0)
    s_branch PFB_41
SIGS_44:
    s_waitcnt vmcnt(0)
    buffer_wbl2 sc1
    s_waitcnt vmcnt(0)
    buffer_store_dword v7, off, s[4:7], s62 sc1
    s_nop 15
    s_branch SIGB_45
ACQS_48:
    s_waitcnt vmcnt(0)
    buffer_inv sc1
    s_waitcnt vmcnt(0)
    s_branch ACQB_49
KV_RETRY1:
    s_mov_b32 s95, 0
    s_mov_b32 s34, 0
    s_add_u32 s33, s31, 1
    v_lshrrev_b32 v14, 2, v0
    v_lshlrev_b32 v14, 7, v14
    v_and_b32 v7, 3, v0
    v_lshl_add_u32 v14, v7, 2, v14
    v_add_u32 v14, s77, v14
KV_LOOP1:
    s_xor_b32 s98, s86, 0x0
    buffer_load_dwordx4 v[48:51], v1, s[4:7], s98 offen offset:0 sc1
    buffer_load_dwordx4 v[52:55], v1, s[4:7], s98 offen offset:1024 sc1
    buffer_load_dwordx4 v[56:59], v1, s[4:7], s98 offen offset:2048 sc1
    buffer_load_dwordx4 v[60:63], v1, s[4:7], s98 offen offset:3072 sc1
    s_xor_b32 s98, s86, 0x1000
    buffer_load_dwordx4 v[64:67], v1, s[4:7], s98 offen offset:0 sc1
    buffer_load_dwordx4 v[68:71], v1, s[4:7], s98 offen offset:1024 sc1
    buffer_load_dwordx4 v[72:75], v1, s[4:7], s98 offen offset:2048 sc1
    buffer_load_dwordx4 v[76:79], v1, s[4:7], s98 offen offset:3072 sc1
    buffer_load_dword v80, v84, s[4:7], s88 offen offset:0 sc1
    buffer_load_dword v81, v84, s[4:7], s88 offen offset:256 sc1
    buffer_load_dword v82, v84, s[4:7], s88 offen offset:512 sc1
    buffer_load_dword v83, v84, s[4:7], s88 offen offset:768 sc1
    buffer_load_dword v7, v14, s[4:7], 0 offen sc1
    s_waitcnt vmcnt(12)
    v_mfma_f32_32x32x16_bf16 v[192:207], v[48:51], a[240:243], 0
    s_waitcnt vmcnt(11)
    v_mfma_f32_32x32x16_bf16 v[192:207], v[52:55], a[240:243], v[192:207]
    s_waitcnt vmcnt(10)
    v_mfma_f32_32x32x16_bf16 v[192:207], v[56:59], a[240:243], v[192:207]
    s_waitcnt vmcnt(9)
    v_mfma_f32_32x32x16_bf16 v[192:207], v[60:63], a[240:243], v[192:207]
    s_waitcnt vmcnt(8)
    v_mfma_f32_32x32x16_bf16 v[192:207], v[64:67], a[240:243], v[192:207]
    s_waitcnt vmcnt(7)
    v_mfma_f32_32x32x16_bf16 v[192:207], v[68:71], a[240:243], v[192:207]
    s_waitcnt vmcnt(6)
    v_mfma_f32_32x32x16_bf16 v[192:207], v[72:75], a[240:243], v[192:207]
    s_waitcnt vmcnt(5)
    v_mfma_f32_32x32x16_bf16 v[192:207], v[76:79], a[240:243], v[192:207]
    s_waitcnt vmcnt(1)
    v_mfma_f32_32x32x16_bf16 v[192:207], v[80:83], a[252:255], v[192:207]
    s_nop 11
    v_cvt_pk_bf16_f32 v208, v192, v193
    v_cvt_pk_bf16_f32 v209, v194, v195
    v_cvt_pk_bf16_f32 v210, v196, v197
    v_cvt_pk_bf16_f32 v211, v198, v199
    v_cvt_pk_bf16_f32 v212, v200, v201
    v_cvt_pk_bf16_f32 v213, v202, v203
    v_cvt_pk_bf16_f32 v214, v204, v205
    v_cvt_pk_bf16_f32 v215, v206, v207
    ds_write_b128 v85, v[208:211] offset:0
    ds_write_b128 v85, v[212:215] offset:1024
    v_pk_add_f32 v[192:193], v[192:193], v[200:201]
    v_pk_add_f32 v[194:195], v[194:195], v[202:203]
    v_pk_add_f32 v[196:197], v[196:197], v[204:205]
    v_pk_add_f32 v[198:199], v[198:199], v[206:207]
    v_pk_add_f32 v[192:193], v[192:193], v[196:197]
    v_pk_add_f32 v[194:195], v[194:195], v[198:199]
    v_pk_add_f32 v[192:193], v[192:193], v[194:195]
    v_cmp_u_f32 vcc, v192, v193
    s_waitcnt vmcnt(0)
    s_cbranch_vccz KV_OK1
    s_cmp_lg_u32 s34, 0
    s_cbranch_scc1 KV_OK1
    v_cmp_gt_u32 vcc, s33, v7
    s_and_b64 vcc, vcc, s[64:65]
    s_cselect_b32 s34, 0, 1
    s_add_u32 s95, s95, 1
    s_cmp_lt_u32 s95, 400000
    s_cbranch_scc1 KV_LOOP1
    s_branch KV_OK1
SIGS_53:
    s_waitcnt vmcnt(0)
    buffer_wbl2 sc1
    s_waitcnt vmcnt(0)
    buffer_store_dword v7, off, s[4:7], s76 sc1
    s_nop 15
    s_branch SIGB_54
ACQS_57:
    s_waitcnt vmcnt(0)
    buffer_inv sc1
    s_waitcnt vmcnt(0)
    s_branch ACQB_58
SIGS_59:
    s_waitcnt vmcnt(0)
    buffer_wbl2 sc1
    s_waitcnt vmcnt(0)
    buffer_store_dword v7, off, s[4:7], s62 sc1
    s_nop 15
    s_branch SIGB_60
ACQS_63:
    s_waitcnt vmcnt(0)
    buffer_inv sc1
    s_waitcnt vmcnt(0)
    s_branch ACQB_64
SIGS_66:
    s_waitcnt vmcnt(0)
    buffer_wbl2 sc1
    s_waitcnt vmcnt(0)
    buffer_store_dword v14, off, s[4:7], s76 sc1
    s_nop 15
    s_branch SIGB_67
SIGS_68:
    s_waitcnt vmcnt(0)
    buffer_wbl2 sc1
    s_waitcnt vmcnt(0)
    buffer_store_dword v14, off, s[4:7], s76 sc1
    s_nop 15
    s_branch SIGB_69
PFS_70:
    s_mov_b32 s95, 0
PFL_72:
    buffer_load_dword v7, v12, s[4:7], s75 offen sc1
    s_add_u32 s95, s95, 1
    s_waitcnt vmcnt(0)
    v_cmp_gt_u32 vcc, s33, v7
    s_and_b64 vcc, vcc, s[60:61]
    s_cbranch_scc0 PFD_73
    s_cmp_lt_u32 s95, 400000
    s_cbranch_scc1 PFL_72
PFD_73:
    s_nop 15
    s_cmp_eq_u32 s36, 0
    s_cbranch_scc1 PFB_71
    buffer_inv sc1
    s_waitcnt vmcnt(0)
    s_branch PFB_71
SIGS_74:
    s_waitcnt vmcnt(0)
    buffer_wbl2 sc1
    s_waitcnt vmcnt(0)
    buffer_store_dword v14, off, s[4:7], s76 sc1
    s_nop 15
    s_branch SIGB_75
PFS_76:
    s_mov_b32 s95, 0
PFL_78:
    buffer_load_dword v7, v12, s[4:7], s75 offen sc1
    s_add_u32 s95, s95, 1
    s_waitcnt vmcnt(0)
    v_cmp_gt_u32 vcc, s33, v7
    s_and_b64 vcc, vcc, s[60:61]
    s_cbranch_scc0 PFD_79
    s_cmp_lt_u32 s95, 400000
    s_cbranch_scc1 PFL_78
PFD_79:
    s_nop 15
    s_cmp_eq_u32 s36, 0
    s_cbranch_scc1 PFB_77
    buffer_inv sc1
    s_waitcnt vmcnt(0)
    s_branch PFB_77
SIGS_80:
    s_waitcnt vmcnt(0)
    buffer_wbl2 sc1
    s_waitcnt vmcnt(0)
    buffer_store_dword v14, off, s[4:7], s76 sc1
    s_nop 15
    s_branch SIGB_81
PFS_82:
    s_mov_b32 s95, 0
PFL_84:
    buffer_load_dword v7, v12, s[4:7], s75 offen sc1
    s_add_u32 s95, s95, 1
    s_waitcnt vmcnt(0)
    v_cmp_gt_u32 vcc, s33, v7
    s_and_b64 vcc, vcc, s[60:61]
    s_cbranch_scc0 PFD_85
    s_cmp_lt_u32 s95, 400000
    s_cbranch_scc1 PFL_84
PFD_85:
    s_nop 15
    s_cmp_eq_u32 s36, 0
    s_cbranch_scc1 PFB_83
    buffer_inv sc1
    s_waitcnt vmcnt(0)
    s_branch PFB_83
PFS_86:
    s_mov_b32 s95, 0
PFL_88:
    buffer_load_dword v7, v12, s[4:7], s75 offen sc1
    s_add_u32 s95, s95, 1
    s_waitcnt vmcnt(0)
    v_cmp_gt_u32 vcc, s33, v7
    s_and_b64 vcc, vcc, s[60:61]
    s_cbranch_scc0 PFD_89
    s_cmp_lt_u32 s95, 400000
    s_cbranch_scc1 PFL_88
PFD_89:
    s_nop 15
    s_cmp_eq_u32 s36, 0
    s_cbranch_scc1 PFB_87
    buffer_inv sc1
    s_waitcnt vmcnt(0)
    s_branch PFB_87
CODE_END:
.section .rodata,"a"
.p2align 6
.amdhsa_kernel interleave_layers__linear_kernel_hedgehog__glu_gated_reglu__prompt_kernel
  .amdhsa_next_free_vgpr 512
  .amdhsa_next_free_sgpr 102
  .amdhsa_accum_offset 256
  .amdhsa_group_segment_fixed_size 0
  .amdhsa_kernarg_size 88
  .amdhsa_user_sgpr_count 2
  .amdhsa_user_sgpr_kernarg_segment_ptr 1
  .amdhsa_system_sgpr_workgroup_id_x 1
.end_amdhsa_kernel
```
